```python
import torch

def _softmax(x, axis=-1):
    return torch.softmax(x, dim=axis)
def _gelu(x):
    return torch.nn.functional.gelu(x, approximate="tanh")
def _silu(x):
    return torch.nn.functional.silu(x)
def _sigmoid(x):
    return torch.sigmoid(x)
def _layernorm(x, axis=-1, eps=1e-5):
    m = x.mean(dim=axis, keepdim=True)
    v = x.var(dim=axis, keepdim=True, unbiased=False)
    return (x - m) / torch.sqrt(v + eps)
def _scatter_add(tgt, idx, src, axis=0):
    return tgt.clone().index_add_(axis, idx, src)
def _segment_sum(src, seg, n):
    out = torch.zeros((n,) + src.shape[1:], dtype=src.dtype)
    return out.index_add_(0, seg, src)
def _pad(x, pw):
    flat = tuple(v for pair in reversed(pw) for v in pair)
    return torch.nn.functional.pad(x, flat)

kernel_name = 'standalone__gqa_softmax__near_ridge'

def setup_inputs():

    _w = (lambda a: (lambda t: t.to(torch.bfloat16) if t.is_floating_point() else t)(torch.as_tensor(a)))
    B, Hq, Hkv, Sq, Sk, D = 32, 32, 8, 368, 512, 128
    return {
        "q": _w((lambda *s: torch.randn(*s, dtype=torch.bfloat16) * 0.8)(B, Hq, Sq, D)),
        "k": _w((lambda *s: torch.randn(*s, dtype=torch.bfloat16) * 0.8)(B, Hkv, Sk, D)),
        "v": _w((lambda *s: torch.randn(*s, dtype=torch.bfloat16) * 0.05)(B, Hkv, Sk, D)),
    }

def reference(q, k, v):
    B, Hq, Sq, D = q.shape
    Hkv = k.shape[1]
    rep = Hq // Hkv
    k = (lambda x, n, axis: torch.repeat_interleave(x, n, dim=axis))(k, rep, axis=1)
    v = (lambda x, n, axis: torch.repeat_interleave(x, n, dim=axis))(v, rep, axis=1)
    scale = D ** -0.5
    scores = torch.einsum("bhqd,bhkd->bhqk", q, k) * scale
    p = _softmax(scores, axis=-1)
    return torch.einsum("bhqk,bhkd->bhqd", p, v)
```

```asm
; @launch grid=(256,1,1) block=(256,1,1) lds=163840
.amdgcn_target "amdgcn-amd-amdhsa--gfx950"
.text
.globl standalone__gqa_softmax__near_ridge_kernel
.p2align 12
.p2align 8
.type standalone__gqa_softmax__near_ridge_kernel,@function
standalone__gqa_softmax__near_ridge_kernel:
    s_cmp_ge_u32 s2, 0x100
    s_cbranch_scc0 L_go
    s_endpgm
L_go:
    s_load_dwordx4 s[4:7], s[0:1], 0
    s_load_dwordx4 s[24:27], s[0:1], 16
    v_lshrrev_b32 v13, 6, v0
    v_and_b32 v0, 63, v0
    v_readfirstlane_b32 s28, v13
    v_lshlrev_b32 v1, 4, v0
    v_and_b32 v14, 15, v0
    v_lshrrev_b32 v15, 4, v0
    v_and_b32 v16, 3, v0
    v_lshlrev_b32 v9, 8, v16
    v_lshlrev_b32 v2, 4, v16
    v_and_b32 v16, 4, v0
    v_lshl_add_u32 v9, v16, 9, v9
    v_lshl_add_u32 v2, v16, 8, v2
    v_lshrrev_b32 v16, 3, v0
    v_lshl_add_u32 v9, v16, 4, v9
    v_and_b32 v16, 8, v0
    v_lshl_add_u32 v2, v16, 3, v2
    v_lshl_add_u32 v2, v15, 7, v2
    s_mul_i32 s34, s2, 0x5c000
    s_lshl_b32 s37, s2, 17
    s_mov_b32 s10, 0x5c000
    s_mov_b32 s11, 0x20000
    s_mov_b32 s14, 0x20000
    s_mov_b32 s15, 0x20000
    s_mov_b32 s18, 0x20000
    s_mov_b32 s19, 0x20000
    s_mov_b32 s22, 0x5c000
    s_mov_b32 s23, 0x20000
    s_waitcnt lgkmcnt(0)
    s_add_u32 s12, s6, s37
    s_addc_u32 s13, s7, 0
    s_add_u32 s8, s4, s34
    s_addc_u32 s9, s5, 0
    s_add_u32 s16, s24, s37
    s_addc_u32 s17, s25, 0
    s_add_u32 s20, s26, s34
    s_addc_u32 s21, s27, 0
    v_lshlrev_b32 v13, 8, v14
    v_lshl_add_u32 v13, v15, 4, v13
    s_lshr_b32 s34, s28, 1
    s_lshl_b32 s34, s34, 12
    s_and_b32 s37, s28, 1
    s_lshl_b32 s37, s37, 7
    s_add_u32 s34, s34, s37
    v_add_u32 v9, s34, v9
    s_lshl_b32 s34, s28, 6
    v_add_u32 v10, s34, v13
    s_lshl_b32 s26, s28, 15
    s_sub_u32 s25, s26, s34
    s_mov_b32 s29, 0
    s_lshl_b32 s24, s28, 11
    s_lshl_b32 s27, s28, 13
    s_add_u32 m0, s24, 0
    s_mov_b32 s29, 0x0
    buffer_load_dwordx4 v9, s[8:11], s29 offen lds
    buffer_load_dwordx4 v9, s[8:11], s29 offen offset:1024 lds
    buffer_load_dwordx4 a[0:3], v10, s[12:15], s25 offen offset:0
    s_getpc_b64 s[38:39]
L_pc:
    s_add_u32 s38, s38, L_s0-L_pc
    s_addc_u32 s39, s39, 0
    v_min_u32 v116, 13, v0
    v_lshlrev_b32 v116, 12, v116
    v_add_co_u32 v116, vcc, s38, v116
    v_mov_b32 v117, s39
    s_nop 1
    v_addc_co_u32 v117, vcc, 0, v117, vcc
    global_load_dword v120, v[116:117], off
    v_lshlrev_b32 v21, 2, v15
    v_xor_b32 v21, v14, v21
    v_lshlrev_b32 v21, 4, v21
    v_lshl_add_u32 v21, v15, 8, v21
    s_add_u32 m0, s27, 98304
    s_nop 0
    buffer_load_dwordx4 v21, s[16:19], s26 offen offset:0 lds
    buffer_load_dwordx4 a[4:7], v10, s[12:15], s25 offen offset:64
    buffer_load_dwordx4 a[8:11], v10, s[12:15], s25 offen offset:128
    buffer_load_dwordx4 a[12:15], v10, s[12:15], s25 offen offset:192
    s_add_u32 s25, s25, 0x1000
    buffer_load_dwordx4 a[16:19], v10, s[12:15], s25 offen offset:0
    s_add_u32 s37, s27, 32768
    v_add_u32 v3, s37, v1
    s_add_u32 s34, s27, 8192
    s_and_b32 s34, s34, 0x7fff
    s_add_u32 s37, s34, 32768
    v_add_u32 v4, s37, v1
    s_add_u32 s34, s27, 16384
    s_and_b32 s34, s34, 0x7fff
    s_add_u32 s37, s34, 32768
    v_add_u32 v5, s37, v1
    s_add_u32 s34, s27, 24576
    s_and_b32 s34, s34, 0x7fff
    s_add_u32 s37, s34, 32768
    v_add_u32 v6, s37, v1
    v_and_b32 v8, 1, v15
    v_lshlrev_b32 v8, 13, v8
    v_lshl_add_u32 v8, v14, 4, v8
    v_add_u32 v8, 69632, v8
    v_lshrrev_b32 v13, 1, v15
    v_lshl_add_u32 v8, v13, 8, v8
    v_add_u32 v7, s28, v15
    v_and_b32 v7, 3, v7
    v_lshl_add_u32 v7, v7, 2, v8
    v_and_b32 v16, 10, v14
    v_cmp_eq_u32 vcc, 0, v16
    v_mov_b32 v23, 0x3f803f80
    v_lshlrev_b32 v13, 3, v13
    v_cndmask_b32 v24, 0, v23, vcc
    v_cmp_eq_u32 vcc, v13, v16
    v_mov_b32 v25, v24
    v_mov_b64 v[26:27], v[24:25]
    v_cndmask_b32 v28, 0, v23, vcc
    v_and_b32 v16, 1, v14
    v_mov_b32 v29, v28
    v_mul_u32_u24 v16, 0xaaaa, v16
    v_mov_b64 v[30:31], v[28:29]
    v_add_u32 v23, 0x4444, v16
    v_mov_b64 v[148:149], 0
    v_mov_b64 v[152:153], 0
    v_mov_b64 v[156:157], 0
    v_mov_b64 v[160:161], 0
    v_mov_b64 v[224:225], 0
    v_mov_b64 v[228:229], 0
    v_mov_b64 v[196:197], 0
    v_mov_b32 v11, 0
    s_mov_b32 s31, 0xffffe000
    s_mov_b32 s32, 0xfffff000
    s_mov_b32 s4, 0x3e0293ee
    s_mov_b32 s5, 0x3e0293ee
    s_mov_b32 s36, 0xffff0000
    s_mov_b32 s35, 0x07060302
    s_add_u32 s30, s24, 8192
    v_lshrrev_b32 v22, 2, v0
    v_and_b32 v16, 3, v22
    v_xor_b32 v16, s28, v16
    v_lshlrev_b32 v16, 6, v16
    v_lshl_add_u32 v22, v22, 8, v16
    v_and_b32 v16, 3, v0
    v_lshl_add_u32 v22, v16, 4, v22
    v_lshrrev_b32 v13, 2, v14
    v_cmp_eq_u32 vcc, v13, v15
    v_and_b32 v13, 1, v14
    v_lshlrev_b32 v13, 4, v13
    s_mov_b32 s34, 0x3e03
    s_mov_b32 s37, 0xb9d8
    v_lshlrev_b32 v16, v13, s34
    v_lshlrev_b32 v13, v13, s37
    v_cndmask_b32 v16, 0, v16, vcc
    v_cndmask_b32 v13, 0, v13, vcc
    v_and_b32 v15, 2, v14
    v_cmp_eq_u32 vcc, 0, v15
    s_nop 1
    v_cndmask_b32 v88, 0, v16, vcc
    v_cndmask_b32 v89, v16, 0, vcc
    v_cndmask_b32 v90, 0, v13, vcc
    v_cndmask_b32 v91, v13, 0, vcc
    s_add_u32 s34, s27, 0
    s_and_b32 s34, s34, 0x7fff
    s_add_u32 s34, s34, 98304
    v_add_u32 v13, s34, v22
    s_add_u32 s34, s27, 8192
    s_and_b32 s34, s34, 0x7fff
    s_add_u32 s34, s34, 98304
    v_add_u32 v14, s34, v22
    s_add_u32 s34, s27, 16384
    s_and_b32 s34, s34, 0x7fff
    s_add_u32 s34, s34, 98304
    v_add_u32 v15, s34, v22
    s_add_u32 s34, s27, 24576
    s_and_b32 s34, s34, 0x7fff
    s_add_u32 s34, s34, 98304
    v_add_u32 v16, s34, v22
    s_mov_b64 exec, 0
    s_cmp_eq_u32 s28, 0
    s_cbranch_scc1 L_sB
    s_cmp_eq_u32 s28, 1
    s_cbranch_scc1 L_s0
    s_cmp_eq_u32 s28, 2
    s_cbranch_scc1 L_s7
    s_branch L_s1
L_cep:
    s_mov_b64 exec, -1
    buffer_load_dwordx4 a[20:23], v10, s[12:15], s25 offen offset:64
    buffer_load_dwordx4 a[24:27], v10, s[12:15], s25 offen offset:128
    s_waitcnt vmcnt(9)
    s_barrier
    ds_read_b128 v[32:35], v2 offset:0
    ds_read_b128 v[36:39], v2 offset:512
    ds_read_b128 v[40:43], v2 offset:2048
    ds_read_b128 v[44:47], v2 offset:2560
    ds_read_b128 v[48:51], v2 offset:4096
    ds_read_b128 v[52:55], v2 offset:4608
    ds_read_b128 v[56:59], v2 offset:6144
    ds_read_b128 v[60:63], v2 offset:6656
    buffer_load_dwordx4 a[28:31], v10, s[12:15], s25 offen offset:192
    s_waitcnt vmcnt(9)
    v_accvgpr_read_b32 v201, a0
    v_accvgpr_read_b32 v203, a1
    v_accvgpr_read_b32 v205, a2
    v_accvgpr_read_b32 v207, a3
    v_lshlrev_b32 v200, 16, v201
    v_lshlrev_b32 v202, 16, v203
    v_lshlrev_b32 v204, 16, v205
    v_lshlrev_b32 v206, 16, v207
    v_and_b32 v201, s36, v201
    v_and_b32 v203, s36, v203
    v_and_b32 v205, s36, v205
    v_and_b32 v207, s36, v207
    v_pk_mul_f32 v[200:201], v[200:201], s[4:5]
    v_pk_mul_f32 v[202:203], v[202:203], s[4:5]
    v_pk_mul_f32 v[204:205], v[204:205], s[4:5]
    v_pk_mul_f32 v[206:207], v[206:207], s[4:5]
    v_cvt_pk_bf16_f32 v200, v200, v201
    v_cvt_pk_bf16_f32 v202, v202, v203
    v_cvt_pk_bf16_f32 v204, v204, v205
    v_cvt_pk_bf16_f32 v206, v206, v207
    v_accvgpr_write_b32 a0, v200
    v_accvgpr_write_b32 a1, v202
    v_accvgpr_write_b32 a2, v204
    v_accvgpr_write_b32 a3, v206
    s_add_u32 m0, s24, 8192
    s_mov_b32 s29, 0x2000
    buffer_load_dwordx4 v9, s[8:11], s29 offen lds
    buffer_load_dwordx4 v9, s[8:11], s29 offen offset:1024 lds
    s_waitcnt vmcnt(8)
    v_accvgpr_read_b32 v201, a4
    v_accvgpr_read_b32 v203, a5
    v_accvgpr_read_b32 v205, a6
    v_accvgpr_read_b32 v207, a7
    v_lshlrev_b32 v200, 16, v201
    v_lshlrev_b32 v202, 16, v203
    v_lshlrev_b32 v204, 16, v205
    v_lshlrev_b32 v206, 16, v207
    v_and_b32 v201, s36, v201
    v_and_b32 v203, s36, v203
    v_and_b32 v205, s36, v205
    v_and_b32 v207, s36, v207
    v_pk_mul_f32 v[200:201], v[200:201], s[4:5]
    v_pk_mul_f32 v[202:203], v[202:203], s[4:5]
    v_pk_mul_f32 v[204:205], v[204:205], s[4:5]
    v_pk_mul_f32 v[206:207], v[206:207], s[4:5]
    v_cvt_pk_bf16_f32 v200, v200, v201
    v_cvt_pk_bf16_f32 v202, v202, v203
    v_cvt_pk_bf16_f32 v204, v204, v205
    v_cvt_pk_bf16_f32 v206, v206, v207
    v_accvgpr_write_b32 a4, v200
    v_accvgpr_write_b32 a5, v202
    v_accvgpr_write_b32 a6, v204
    v_accvgpr_write_b32 a7, v206
    s_add_u32 m0, s24, 32768
    s_mov_b32 s29, 0x4000
    buffer_load_dwordx4 v9, s[8:11], s29 offen lds
    s_waitcnt vmcnt(8)
    v_accvgpr_read_b32 v201, a8
    v_accvgpr_read_b32 v203, a9
    v_accvgpr_read_b32 v205, a10
    v_accvgpr_read_b32 v207, a11
    v_lshlrev_b32 v200, 16, v201
    v_lshlrev_b32 v202, 16, v203
    v_lshlrev_b32 v204, 16, v205
    v_lshlrev_b32 v206, 16, v207
    v_and_b32 v201, s36, v201
    v_and_b32 v203, s36, v203
    v_and_b32 v205, s36, v205
    v_and_b32 v207, s36, v207
    v_pk_mul_f32 v[200:201], v[200:201], s[4:5]
    v_pk_mul_f32 v[202:203], v[202:203], s[4:5]
    v_pk_mul_f32 v[204:205], v[204:205], s[4:5]
    v_pk_mul_f32 v[206:207], v[206:207], s[4:5]
    v_cvt_pk_bf16_f32 v200, v200, v201
    v_cvt_pk_bf16_f32 v202, v202, v203
    v_cvt_pk_bf16_f32 v204, v204, v205
    v_cvt_pk_bf16_f32 v206, v206, v207
    v_accvgpr_write_b32 a8, v200
    v_accvgpr_write_b32 a9, v202
    v_accvgpr_write_b32 a10, v204
    v_accvgpr_write_b32 a11, v206
    buffer_load_dwordx4 v9, s[8:11], s29 offen offset:1024 lds
    s_mov_b64 exec, 0
    s_cmp_eq_u32 s28, 0
    s_cbranch_scc1 L_s8
    s_cmp_eq_u32 s28, 1
    s_cbranch_scc1 L_s2
    s_cmp_eq_u32 s28, 2
    s_cbranch_scc1 L_s9
    s_branch L_s3
L_cek3:
    s_mov_b64 exec, -1
    s_waitcnt vmcnt(8)
    v_accvgpr_read_b32 v201, a12
    v_accvgpr_read_b32 v203, a13
    v_accvgpr_read_b32 v205, a14
    v_accvgpr_read_b32 v207, a15
    s_add_u32 m0, s24, 40960
    s_mov_b32 s29, 0x6000
    buffer_load_dwordx4 v9, s[8:11], s29 offen lds
    v_lshlrev_b32 v200, 16, v201
    v_lshlrev_b32 v202, 16, v203
    v_lshlrev_b32 v204, 16, v205
    v_lshlrev_b32 v206, 16, v207
    buffer_load_dwordx4 v9, s[8:11], s29 offen offset:1024 lds
    v_and_b32 v201, s36, v201
    v_and_b32 v203, s36, v203
    v_and_b32 v205, s36, v205
    v_and_b32 v207, s36, v207
    v_pk_mul_f32 v[200:201], v[200:201], s[4:5]
    v_pk_mul_f32 v[202:203], v[202:203], s[4:5]
    v_pk_mul_f32 v[204:205], v[204:205], s[4:5]
    v_pk_mul_f32 v[206:207], v[206:207], s[4:5]
    v_cvt_pk_bf16_f32 v200, v200, v201
    v_cvt_pk_bf16_f32 v202, v202, v203
    v_cvt_pk_bf16_f32 v204, v204, v205
    v_cvt_pk_bf16_f32 v206, v206, v207
    v_accvgpr_write_b32 a12, v200
    v_accvgpr_write_b32 a13, v202
    v_accvgpr_write_b32 a14, v204
    v_accvgpr_write_b32 a15, v206
    s_waitcnt vmcnt(9)
    v_accvgpr_read_b32 v201, a16
    v_accvgpr_read_b32 v203, a17
    v_accvgpr_read_b32 v205, a18
    v_accvgpr_read_b32 v207, a19
    v_lshlrev_b32 v200, 16, v201
    v_lshlrev_b32 v202, 16, v203
    v_lshlrev_b32 v204, 16, v205
    v_lshlrev_b32 v206, 16, v207
    v_and_b32 v201, s36, v201
    v_and_b32 v203, s36, v203
    v_and_b32 v205, s36, v205
    v_and_b32 v207, s36, v207
    v_pk_mul_f32 v[200:201], v[200:201], s[4:5]
    v_pk_mul_f32 v[202:203], v[202:203], s[4:5]
    v_pk_mul_f32 v[204:205], v[204:205], s[4:5]
    v_pk_mul_f32 v[206:207], v[206:207], s[4:5]
    v_cvt_pk_bf16_f32 v200, v200, v201
    v_cvt_pk_bf16_f32 v202, v202, v203
    v_cvt_pk_bf16_f32 v204, v204, v205
    v_cvt_pk_bf16_f32 v206, v206, v207
    v_accvgpr_write_b32 a16, v200
    v_accvgpr_write_b32 a17, v202
    v_accvgpr_write_b32 a18, v204
    v_accvgpr_write_b32 a19, v206
    s_waitcnt vmcnt(8)
    v_accvgpr_read_b32 v201, a20
    v_accvgpr_read_b32 v203, a21
    v_accvgpr_read_b32 v205, a22
    v_accvgpr_read_b32 v207, a23
    v_lshlrev_b32 v200, 16, v201
    v_lshlrev_b32 v202, 16, v203
    v_lshlrev_b32 v204, 16, v205
    v_lshlrev_b32 v206, 16, v207
    v_and_b32 v201, s36, v201
    v_and_b32 v203, s36, v203
    v_and_b32 v205, s36, v205
    v_and_b32 v207, s36, v207
    v_pk_mul_f32 v[200:201], v[200:201], s[4:5]
    v_pk_mul_f32 v[202:203], v[202:203], s[4:5]
    v_pk_mul_f32 v[204:205], v[204:205], s[4:5]
    v_pk_mul_f32 v[206:207], v[206:207], s[4:5]
    v_cvt_pk_bf16_f32 v200, v200, v201
    v_cvt_pk_bf16_f32 v202, v202, v203
    v_cvt_pk_bf16_f32 v204, v204, v205
    v_cvt_pk_bf16_f32 v206, v206, v207
    v_accvgpr_write_b32 a20, v200
    v_accvgpr_write_b32 a21, v202
    v_accvgpr_write_b32 a22, v204
    v_accvgpr_write_b32 a23, v206
    s_add_u32 m0, s24, 49152
    s_mov_b32 s29, 0x8000
    buffer_load_dwordx4 v9, s[8:11], s29 offen lds
    s_waitcnt vmcnt(8)
    v_accvgpr_read_b32 v201, a24
    v_accvgpr_read_b32 v203, a25
    v_accvgpr_read_b32 v205, a26
    v_accvgpr_read_b32 v207, a27
    v_lshlrev_b32 v200, 16, v201
    v_lshlrev_b32 v202, 16, v203
    v_lshlrev_b32 v204, 16, v205
    v_lshlrev_b32 v206, 16, v207
    v_and_b32 v201, s36, v201
    v_and_b32 v203, s36, v203
    v_and_b32 v205, s36, v205
    v_and_b32 v207, s36, v207
    v_pk_mul_f32 v[200:201], v[200:201], s[4:5]
    v_pk_mul_f32 v[202:203], v[202:203], s[4:5]
    v_pk_mul_f32 v[204:205], v[204:205], s[4:5]
    v_pk_mul_f32 v[206:207], v[206:207], s[4:5]
    v_cvt_pk_bf16_f32 v200, v200, v201
    v_cvt_pk_bf16_f32 v202, v202, v203
    v_cvt_pk_bf16_f32 v204, v204, v205
    v_cvt_pk_bf16_f32 v206, v206, v207
    v_accvgpr_write_b32 a24, v200
    v_accvgpr_write_b32 a25, v202
    v_accvgpr_write_b32 a26, v204
    v_accvgpr_write_b32 a27, v206
    buffer_load_dwordx4 v9, s[8:11], s29 offen offset:1024 lds
    s_waitcnt vmcnt(8)
    v_accvgpr_read_b32 v201, a28
    v_accvgpr_read_b32 v203, a29
    v_accvgpr_read_b32 v205, a30
    v_accvgpr_read_b32 v207, a31
    v_lshlrev_b32 v200, 16, v201
    v_lshlrev_b32 v202, 16, v203
    v_lshlrev_b32 v204, 16, v205
    v_lshlrev_b32 v206, 16, v207
    v_and_b32 v201, s36, v201
    v_and_b32 v203, s36, v203
    v_and_b32 v205, s36, v205
    v_and_b32 v207, s36, v207
    v_pk_mul_f32 v[200:201], v[200:201], s[4:5]
    v_pk_mul_f32 v[202:203], v[202:203], s[4:5]
    v_pk_mul_f32 v[204:205], v[204:205], s[4:5]
    v_pk_mul_f32 v[206:207], v[206:207], s[4:5]
    v_cvt_pk_bf16_f32 v200, v200, v201
    v_cvt_pk_bf16_f32 v202, v202, v203
    v_cvt_pk_bf16_f32 v204, v204, v205
    v_cvt_pk_bf16_f32 v206, v206, v207
    v_accvgpr_write_b32 a28, v200
    v_accvgpr_write_b32 a29, v202
    v_accvgpr_write_b32 a30, v204
    v_accvgpr_write_b32 a31, v206
    s_waitcnt lgkmcnt(0)
    s_cmp_ge_u32 s28, 2
    s_cbranch_scc1 L_copyB
    v_mfma_f32_16x16x32_bf16 v[64:67], a[0:3], v[32:35], 0
    v_mfma_f32_16x16x32_bf16 v[64:67], a[4:7], v[36:39], v[64:67]
    v_mfma_f32_16x16x32_bf16 v[64:67], a[8:11], v[40:43], v[64:67]
    v_mfma_f32_16x16x32_bf16 v[64:67], a[12:15], v[44:47], v[64:67]
    v_mfma_f32_16x16x32_bf16 v[68:71], a[28:31], v[44:47], 0
    v_mfma_f32_16x16x32_bf16 v[68:71], a[24:27], v[40:43], v[68:71]
    s_add_u32 m0, s27, 98304
    s_nop 0
    v_mfma_f32_16x16x32_bf16 v[68:71], a[20:23], v[36:39], v[68:71]
    buffer_load_dwordx4 v21, s[16:19], s26 offen offset:1024 lds
    v_mfma_f32_16x16x32_bf16 v[68:71], a[16:19], v[32:35], v[68:71]
    v_exp_f32 v64, v64
    v_exp_f32 v65, v65
    buffer_load_dwordx4 v21, s[16:19], s26 offen offset:2048 lds
    s_waitcnt vmcnt(8)
    s_barrier
    v_exp_f32 v66, v66
    v_exp_f32 v67, v67
    v_perm_b32 v232, v65, v64, s35
    v_perm_b32 v233, v67, v66, s35
    v_exp_f32 v68, v68
    v_exp_f32 v69, v69
    v_exp_f32 v70, v70
    v_exp_f32 v71, v71
    v_perm_b32 v234, v69, v68, s35
    v_perm_b32 v235, v71, v70, s35
    v_mfma_f32_16x16x32_bf16 v[72:75], a[0:3], v[48:51], 0
    v_mfma_f32_16x16x32_bf16 v[72:75], a[4:7], v[52:55], v[72:75]
    ds_read_b128 v[32:35], v2 offset:8192
    ds_read_b128 v[36:39], v2 offset:8704
    v_mfma_f32_16x16x32_bf16 v[72:75], a[8:11], v[56:59], v[72:75]
    ds_read_b128 v[40:43], v2 offset:10240
    ds_read_b128 v[44:47], v2 offset:10752
    v_mfma_f32_16x16x32_bf16 v[72:75], a[12:15], v[60:63], v[72:75]
    ds_write_b128 v3, v[232:235] offset:32768
    v_mfma_f32_16x16x32_bf16 v[76:79], a[28:31], v[60:63], 0
    v_mfma_f32_16x16x32_bf16 v[76:79], a[24:27], v[56:59], v[76:79]
    v_mfma_f32_16x16x32_bf16 v[76:79], a[20:23], v[52:55], v[76:79]
    v_exp_f32 v72, v72
    v_mfma_f32_16x16x32_bf16 v[76:79], a[16:19], v[48:51], v[76:79]
    v_exp_f32 v73, v73
    v_exp_f32 v74, v74
    buffer_load_dwordx4 v21, s[16:19], s26 offen offset:3072 lds
    v_exp_f32 v75, v75
    v_perm_b32 v236, v73, v72, s35
    v_perm_b32 v237, v75, v74, s35
    s_nop 1
    v_exp_f32 v76, v76
    v_exp_f32 v77, v77
    v_exp_f32 v78, v78
    v_exp_f32 v79, v79
    s_waitcnt lgkmcnt(1)
    v_perm_b32 v238, v77, v76, s35
    v_perm_b32 v239, v79, v78, s35
    v_mfma_f32_16x16x32_bf16 v[64:67], a[0:3], v[32:35], 0
    v_mfma_f32_16x16x32_bf16 v[64:67], a[4:7], v[36:39], v[64:67]
    v_mfma_f32_16x16x32_bf16 v[64:67], a[8:11], v[40:43], v[64:67]
    v_mfma_f32_16x16x32_bf16 v[64:67], a[12:15], v[44:47], v[64:67]
    ds_write_b128 v3, v[236:239] offset:33792
    v_mfma_f32_16x16x32_bf16 v[68:71], a[28:31], v[44:47], 0
    ds_read_b128 v[48:51], v2 offset:12288
    ds_read_b128 v[52:55], v2 offset:12800
    v_mfma_f32_16x16x32_bf16 v[68:71], a[24:27], v[40:43], v[68:71]
    ds_read_b128 v[56:59], v2 offset:14336
    ds_read_b128 v[60:63], v2 offset:14848
    v_mfma_f32_16x16x32_bf16 v[68:71], a[20:23], v[36:39], v[68:71]
    v_exp_f32 v64, v64
    v_mfma_f32_16x16x32_bf16 v[68:71], a[16:19], v[32:35], v[68:71]
    v_exp_f32 v65, v65
    v_smfmac_f32_16x16x64_bf16 v[148:151], v[28:31], v[232:239], v23
    s_add_u32 m0, s27, 102400
    s_add_u32 s26, s26, 0x1000
    buffer_load_dwordx4 v21, s[16:19], s26 offen offset:0 lds
    s_waitcnt vmcnt(8) lgkmcnt(4)
    s_barrier
    v_exp_f32 v66, v66
    v_exp_f32 v67, v67
    v_perm_b32 v232, v65, v64, s35
    v_perm_b32 v233, v67, v66, s35
    v_exp_f32 v68, v68
    v_exp_f32 v69, v69
    v_exp_f32 v70, v70
    v_exp_f32 v71, v71
    s_waitcnt lgkmcnt(0)
    v_perm_b32 v234, v69, v68, s35
    v_perm_b32 v235, v71, v70, s35
    v_mfma_f32_16x16x32_bf16 v[72:75], a[0:3], v[48:51], 0
    v_mfma_f32_16x16x32_bf16 v[72:75], a[4:7], v[52:55], v[72:75]
    ds_read_b128 v[32:35], v2 offset:32768
    ds_read_b128 v[36:39], v2 offset:33280
    v_mfma_f32_16x16x32_bf16 v[72:75], a[8:11], v[56:59], v[72:75]
    ds_read_b128 v[40:43], v2 offset:34816
    ds_read_b128 v[44:47], v2 offset:35328
    v_mfma_f32_16x16x32_bf16 v[72:75], a[12:15], v[60:63], v[72:75]
    ds_write_b128 v3, v[232:235] offset:34816
    v_mfma_f32_16x16x32_bf16 v[76:79], a[28:31], v[60:63], 0
    v_mfma_f32_16x16x32_bf16 v[76:79], a[24:27], v[56:59], v[76:79]
    v_mfma_f32_16x16x32_bf16 v[76:79], a[20:23], v[52:55], v[76:79]
    v_exp_f32 v72, v72
    v_mfma_f32_16x16x32_bf16 v[76:79], a[16:19], v[48:51], v[76:79]
    v_exp_f32 v73, v73
    v_exp_f32 v74, v74
    buffer_load_dwordx4 v21, s[16:19], s26 offen offset:1024 lds
    v_exp_f32 v75, v75
    v_perm_b32 v236, v73, v72, s35
    v_perm_b32 v237, v75, v74, s35
    s_nop 1
    v_exp_f32 v76, v76
    v_exp_f32 v77, v77
    v_exp_f32 v78, v78
    v_exp_f32 v79, v79
    s_waitcnt lgkmcnt(1)
    v_perm_b32 v238, v77, v76, s35
    v_perm_b32 v239, v79, v78, s35
    v_mfma_f32_16x16x32_bf16 v[64:67], a[0:3], v[32:35], 0
L_s0:
    s_cbranch_execz L_cep
L_s0_n:
    v_mfma_f32_16x16x32_bf16 v[64:67], a[4:7], v[36:39], v[64:67]
    v_mfma_f32_16x16x32_bf16 v[64:67], a[8:11], v[40:43], v[64:67]
    v_mfma_f32_16x16x32_bf16 v[64:67], a[12:15], v[44:47], v[64:67]
    ds_write_b128 v3, v[236:239] offset:35840
    v_mfma_f32_16x16x32_bf16 v[68:71], a[28:31], v[44:47], 0
    ds_read_b128 v[48:51], v2 offset:36864
    ds_read_b128 v[52:55], v2 offset:37376
    v_mfma_f32_16x16x32_bf16 v[68:71], a[24:27], v[40:43], v[68:71]
    ds_read_b128 v[56:59], v2 offset:38912
    ds_read_b128 v[60:63], v2 offset:39424
    v_mfma_f32_16x16x32_bf16 v[68:71], a[20:23], v[36:39], v[68:71]
    v_exp_f32 v64, v64
    v_mfma_f32_16x16x32_bf16 v[68:71], a[16:19], v[32:35], v[68:71]
    v_exp_f32 v65, v65
    v_smfmac_f32_16x16x64_bf16 v[152:155], v[28:31], v[232:239], v23
    buffer_load_dwordx4 v21, s[16:19], s26 offen offset:2048 lds
    s_waitcnt vmcnt(8) lgkmcnt(4)
    s_barrier
    v_exp_f32 v66, v66
    v_exp_f32 v67, v67
    v_perm_b32 v232, v65, v64, s35
    v_perm_b32 v233, v67, v66, s35
    v_exp_f32 v68, v68
    v_exp_f32 v69, v69
    v_exp_f32 v70, v70
    v_exp_f32 v71, v71
    s_waitcnt lgkmcnt(0)
    v_perm_b32 v234, v69, v68, s35
    v_perm_b32 v235, v71, v70, s35
    v_mfma_f32_16x16x32_bf16 v[72:75], a[0:3], v[48:51], 0
    v_mfma_f32_16x16x32_bf16 v[72:75], a[4:7], v[52:55], v[72:75]
    ds_read_b128 v[32:35], v2 offset:40960
    ds_read_b128 v[36:39], v2 offset:41472
    v_mfma_f32_16x16x32_bf16 v[72:75], a[8:11], v[56:59], v[72:75]
    ds_read_b128 v[40:43], v2 offset:43008
    ds_read_b128 v[44:47], v2 offset:43520
    v_mfma_f32_16x16x32_bf16 v[72:75], a[12:15], v[60:63], v[72:75]
    ds_write_b128 v3, v[232:235] offset:36864
    v_mfma_f32_16x16x32_bf16 v[76:79], a[28:31], v[60:63], 0
    v_mfma_f32_16x16x32_bf16 v[76:79], a[24:27], v[56:59], v[76:79]
    v_mfma_f32_16x16x32_bf16 v[76:79], a[20:23], v[52:55], v[76:79]
    v_exp_f32 v72, v72
    v_mfma_f32_16x16x32_bf16 v[76:79], a[16:19], v[48:51], v[76:79]
    v_exp_f32 v73, v73
    v_exp_f32 v74, v74
    buffer_load_dwordx4 v21, s[16:19], s26 offen offset:3072 lds
    v_exp_f32 v75, v75
    v_perm_b32 v236, v73, v72, s35
    v_perm_b32 v237, v75, v74, s35
    s_nop 1
    v_exp_f32 v76, v76
    v_exp_f32 v77, v77
    v_exp_f32 v78, v78
    v_exp_f32 v79, v79
    s_waitcnt lgkmcnt(1)
    v_perm_b32 v238, v77, v76, s35
    v_perm_b32 v239, v79, v78, s35
    v_mfma_f32_16x16x32_bf16 v[64:67], a[0:3], v[32:35], 0
    v_mfma_f32_16x16x32_bf16 v[64:67], a[4:7], v[36:39], v[64:67]
    v_mfma_f32_16x16x32_bf16 v[64:67], a[8:11], v[40:43], v[64:67]
    v_mfma_f32_16x16x32_bf16 v[64:67], a[12:15], v[44:47], v[64:67]
    ds_write_b128 v3, v[236:239] offset:37888
    v_mfma_f32_16x16x32_bf16 v[68:71], a[28:31], v[44:47], 0
    ds_read_b128 v[48:51], v2 offset:45056
    ds_read_b128 v[52:55], v2 offset:45568
    v_mfma_f32_16x16x32_bf16 v[68:71], a[24:27], v[40:43], v[68:71]
    ds_read_b128 v[56:59], v2 offset:47104
    ds_read_b128 v[60:63], v2 offset:47616
    v_mfma_f32_16x16x32_bf16 v[68:71], a[20:23], v[36:39], v[68:71]
    v_exp_f32 v64, v64
    v_mfma_f32_16x16x32_bf16 v[68:71], a[16:19], v[32:35], v[68:71]
    v_exp_f32 v65, v65
    v_smfmac_f32_16x16x64_bf16 v[156:159], v[28:31], v[232:239], v23
    s_add_u32 m0, s24, 57344
    s_mov_b32 s29, 0xa000
    buffer_load_dwordx4 v9, s[8:11], s29 offen lds
    s_waitcnt vmcnt(8) lgkmcnt(4)
    s_barrier
    v_exp_f32 v66, v66
    v_exp_f32 v67, v67
    v_perm_b32 v232, v65, v64, s35
    v_perm_b32 v233, v67, v66, s35
    v_exp_f32 v68, v68
    v_exp_f32 v69, v69
    v_exp_f32 v70, v70
    v_exp_f32 v71, v71
    s_waitcnt lgkmcnt(0)
    v_perm_b32 v234, v69, v68, s35
    v_perm_b32 v235, v71, v70, s35
    v_mfma_f32_16x16x32_bf16 v[72:75], a[0:3], v[48:51], 0
    v_mfma_f32_16x16x32_bf16 v[72:75], a[4:7], v[52:55], v[72:75]
    ds_read_b128 v[32:35], v2 offset:49152
    ds_read_b128 v[36:39], v2 offset:49664
    v_mfma_f32_16x16x32_bf16 v[72:75], a[8:11], v[56:59], v[72:75]
    ds_read_b128 v[40:43], v2 offset:51200
    ds_read_b128 v[44:47], v2 offset:51712
    v_mfma_f32_16x16x32_bf16 v[72:75], a[12:15], v[60:63], v[72:75]
    ds_write_b128 v3, v[232:235] offset:38912
    v_mfma_f32_16x16x32_bf16 v[76:79], a[28:31], v[60:63], 0
    ds_read_b128 v[216:219], v3 offset:32768
    ds_read_b128 v[208:211], v4 offset:32768
    v_mfma_f32_16x16x32_bf16 v[76:79], a[24:27], v[56:59], v[76:79]
    ds_read_b128 v[240:243], v5 offset:32768
    ds_read_b128 v[248:251], v6 offset:32768
    v_mfma_f32_16x16x32_bf16 v[76:79], a[20:23], v[52:55], v[76:79]
    v_exp_f32 v72, v72
    v_mfma_f32_16x16x32_bf16 v[76:79], a[16:19], v[48:51], v[76:79]
    v_exp_f32 v73, v73
    v_exp_f32 v74, v74
    buffer_load_dwordx4 v9, s[8:11], s29 offen offset:1024 lds
    v_exp_f32 v75, v75
    v_perm_b32 v236, v73, v72, s35
    v_perm_b32 v237, v75, v74, s35
    s_nop 1
    v_exp_f32 v76, v76
    v_exp_f32 v77, v77
    v_exp_f32 v78, v78
    v_exp_f32 v79, v79
    s_waitcnt lgkmcnt(5)
    v_perm_b32 v238, v77, v76, s35
    v_perm_b32 v239, v79, v78, s35
    v_mfma_f32_16x16x32_bf16 v[64:67], a[0:3], v[32:35], 0
    v_mfma_f32_16x16x32_bf16 v[64:67], a[4:7], v[36:39], v[64:67]
    ds_read_b128 v[220:223], v3 offset:33792
    ds_read_b128 v[212:215], v4 offset:33792
    v_mfma_f32_16x16x32_bf16 v[64:67], a[8:11], v[40:43], v[64:67]
    ds_read_b128 v[244:247], v5 offset:33792
    ds_read_b128 v[252:255], v6 offset:33792
    v_mfma_f32_16x16x32_bf16 v[64:67], a[12:15], v[44:47], v[64:67]
    s_add_u32 s25, s25, 0x1000
    buffer_load_dwordx4 a[32:35], v10, s[12:15], s25 offen offset:0
    buffer_load_dwordx4 a[36:39], v10, s[12:15], s25 offen offset:64
    s_mov_b64 exec, 0
    s_bitcmp0_b32 s28, 0
    s_cbranch_scc1 L_s4
    s_branch L_s5
L_ce4A:
    s_mov_b64 exec, -1
    buffer_load_dwordx4 a[40:43], v10, s[12:15], s25 offen offset:128
    buffer_load_dwordx4 a[44:47], v10, s[12:15], s25 offen offset:192
    s_add_u32 s25, s25, 0x1000
    buffer_load_dwordx4 a[48:51], v10, s[12:15], s25 offen offset:0
    buffer_load_dwordx4 a[52:55], v10, s[12:15], s25 offen offset:64
    s_waitcnt vmcnt(8) lgkmcnt(0)
    s_barrier
    ds_write_b128 v3, v[236:239] offset:39936
    ds_read_b64_tr_b16 a[128:129], v13 offset:0
    ds_read_b64_tr_b16 a[130:131], v13 offset:4096
    ds_read_b64_tr_b16 a[132:133], v13 offset:8
    ds_read_b64_tr_b16 a[134:135], v13 offset:4104
    ds_read_b64_tr_b16 a[160:161], v14 offset:0
    ds_read_b64_tr_b16 a[162:163], v14 offset:4096
    ds_read_b64_tr_b16 a[164:165], v14 offset:8
    ds_read_b64_tr_b16 a[166:167], v14 offset:4104
    ds_read_b64_tr_b16 a[192:193], v15 offset:0
    ds_read_b64_tr_b16 a[194:195], v15 offset:4096
    ds_read_b64_tr_b16 a[196:197], v15 offset:8
    ds_read_b64_tr_b16 a[198:199], v15 offset:4104
    ds_read_b64_tr_b16 a[224:225], v16 offset:0
    ds_read_b64_tr_b16 a[226:227], v16 offset:4096
    ds_read_b64_tr_b16 a[228:229], v16 offset:8
    ds_read_b64_tr_b16 a[230:231], v16 offset:4104
    buffer_load_dwordx4 a[56:59], v10, s[12:15], s25 offen offset:128
    buffer_load_dwordx4 a[60:63], v10, s[12:15], s25 offen offset:192
    s_add_u32 m0, s27, 131072
    s_add_u32 s26, s26, 0x1000
    buffer_load_dwordx4 v21, s[16:19], s26 offen offset:0 lds
    s_waitcnt vmcnt(8)
    v_mfma_f32_16x16x16_bf16 v[200:203], v[88:89], a[32:33], 0
    v_mfma_f32_16x16x16_bf16 v[200:203], v[90:91], a[32:33], v[200:203]
    v_mfma_f32_16x16x32_bf16 v[68:71], a[28:31], v[44:47], 0
    ds_read_b128 v[48:51], v2 offset:53248
    ds_read_b128 v[52:55], v2 offset:53760
    v_mfma_f32_16x16x32_bf16 v[68:71], a[24:27], v[40:43], v[68:71]
    ds_read_b128 v[56:59], v2 offset:55296
    ds_read_b128 v[60:63], v2 offset:55808
    v_mfma_f32_16x16x32_bf16 v[68:71], a[20:23], v[36:39], v[68:71]
    v_exp_f32 v64, v64
    v_mfma_f32_16x16x32_bf16 v[68:71], a[16:19], v[32:35], v[68:71]
    v_exp_f32 v65, v65
    v_smfmac_f32_16x16x64_bf16 v[160:163], v[28:31], v[232:239], v23
    s_waitcnt lgkmcnt(4)
    v_mfma_f32_16x16x16_bf16 v[204:207], v[88:89], a[34:35], 0
    v_cvt_pk_bf16_f32 v200, v200, v201
    v_cvt_pk_bf16_f32 v202, v202, v203
    v_mfma_f32_16x16x16_bf16 v[204:207], v[90:91], a[34:35], v[204:207]
    v_accvgpr_write_b32 a32, v200
    v_accvgpr_write_b32 a33, v202
    v_mfma_f32_16x16x32_bf16 v[80:83], a[128:131], v[216:219], 0
    v_exp_f32 v66, v66
    v_mfma_f32_16x16x32_bf16 v[80:83], a[160:163], v[208:211], v[80:83]
    v_exp_f32 v67, v67
    v_mfma_f32_16x16x32_bf16 v[80:83], a[192:195], v[240:243], v[80:83]
    v_perm_b32 v232, v65, v64, s35
    v_perm_b32 v233, v67, v66, s35
    v_mfma_f32_16x16x32_bf16 v[80:83], a[224:227], v[248:251], v[80:83]
    v_exp_f32 v68, v68
    v_mfma_f32_16x16x32_bf16 v[84:87], a[228:231], v[248:251], 0
    v_exp_f32 v69, v69
    v_mfma_f32_16x16x32_bf16 v[84:87], a[196:199], v[240:243], v[84:87]
    v_exp_f32 v70, v70
    v_mfma_f32_16x16x32_bf16 v[84:87], a[164:167], v[208:211], v[84:87]
    v_exp_f32 v71, v71
    v_mfma_f32_16x16x32_bf16 v[84:87], a[132:135], v[216:219], v[84:87]
    s_waitcnt lgkmcnt(0)
    v_perm_b32 v234, v69, v68, s35
    v_perm_b32 v235, v71, v70, s35
    buffer_load_dwordx4 v21, s[16:19], s26 offen offset:1024 lds
    s_waitcnt vmcnt(8)
    v_mfma_f32_16x16x16_bf16 v[200:203], v[88:89], a[36:37], 0
    v_cvt_pk_bf16_f32 v204, v204, v205
    v_cvt_pk_bf16_f32 v206, v206, v207
    v_mfma_f32_16x16x16_bf16 v[200:203], v[90:91], a[36:37], v[200:203]
    v_accvgpr_write_b32 a34, v204
    v_accvgpr_write_b32 a35, v206
    v_mfma_f32_16x16x32_bf16 v[72:75], a[0:3], v[48:51], 0
    v_mfma_f32_16x16x32_bf16 v[72:75], a[4:7], v[52:55], v[72:75]
    v_mfma_f32_16x16x32_bf16 v[72:75], a[8:11], v[56:59], v[72:75]
    v_mfma_f32_16x16x32_bf16 v[72:75], a[12:15], v[60:63], v[72:75]
    ds_write_b128 v3, v[232:235] offset:32768
    v_mfma_f32_16x16x32_bf16 v[76:79], a[28:31], v[60:63], 0
    ds_read_b128 v[216:219], v3 offset:34816
    ds_read_b128 v[208:211], v4 offset:34816
    v_mfma_f32_16x16x32_bf16 v[76:79], a[24:27], v[56:59], v[76:79]
    ds_read_b128 v[240:243], v5 offset:34816
    ds_read_b128 v[248:251], v6 offset:34816
    v_mfma_f32_16x16x32_bf16 v[76:79], a[20:23], v[52:55], v[76:79]
    v_exp_f32 v72, v72
    v_mfma_f32_16x16x32_bf16 v[76:79], a[16:19], v[48:51], v[76:79]
    v_exp_f32 v73, v73
    s_barrier
    ds_read_b128 v[32:35], v2 offset:57344
    ds_read_b128 v[36:39], v2 offset:57856
    ds_read_b128 v[40:43], v2 offset:59392
    ds_read_b128 v[44:47], v2 offset:59904
    v_mfma_f32_16x16x16_bf16 v[204:207], v[88:89], a[38:39], 0
    v_cvt_pk_bf16_f32 v200, v200, v201
    v_cvt_pk_bf16_f32 v202, v202, v203
    v_mfma_f32_16x16x16_bf16 v[204:207], v[90:91], a[38:39], v[204:207]
    v_accvgpr_write_b32 a36, v200
    v_accvgpr_write_b32 a37, v202
    v_mfma_f32_16x16x32_bf16 v[92:95], a[128:131], v[220:223], 0
    v_exp_f32 v74, v74
    v_mfma_f32_16x16x32_bf16 v[92:95], a[160:163], v[212:215], v[92:95]
    v_exp_f32 v75, v75
    v_mfma_f32_16x16x32_bf16 v[92:95], a[192:195], v[244:247], v[92:95]
    v_perm_b32 v236, v73, v72, s35
    v_perm_b32 v237, v75, v74, s35
    v_mfma_f32_16x16x32_bf16 v[92:95], a[224:227], v[252:255], v[92:95]
    v_exp_f32 v76, v76
    buffer_load_dwordx4 v21, s[16:19], s26 offen offset:2048 lds
    s_waitcnt vmcnt(8)
    v_mfma_f32_16x16x16_bf16 v[200:203], v[88:89], a[40:41], 0
    v_cvt_pk_bf16_f32 v204, v204, v205
    v_cvt_pk_bf16_f32 v206, v206, v207
    v_mfma_f32_16x16x16_bf16 v[200:203], v[90:91], a[40:41], v[200:203]
    v_accvgpr_write_b32 a38, v204
    v_accvgpr_write_b32 a39, v206
    v_mfma_f32_16x16x32_bf16 v[96:99], a[228:231], v[252:255], 0
    v_exp_f32 v77, v77
    v_mfma_f32_16x16x32_bf16 v[96:99], a[196:199], v[244:247], v[96:99]
    v_exp_f32 v78, v78
    v_mfma_f32_16x16x32_bf16 v[96:99], a[164:167], v[212:215], v[96:99]
    v_exp_f32 v79, v79
    v_mfma_f32_16x16x32_bf16 v[96:99], a[132:135], v[220:223], v[96:99]
    s_waitcnt lgkmcnt(0)
    v_perm_b32 v238, v77, v76, s35
    v_perm_b32 v239, v79, v78, s35
    v_mfma_f32_16x16x16_bf16 v[204:207], v[88:89], a[42:43], 0
    v_cvt_pk_bf16_f32 v200, v200, v201
    v_cvt_pk_bf16_f32 v202, v202, v203
    v_mfma_f32_16x16x16_bf16 v[204:207], v[90:91], a[42:43], v[204:207]
    v_accvgpr_write_b32 a40, v200
    v_accvgpr_write_b32 a41, v202
    v_mfma_f32_16x16x32_bf16 v[64:67], a[0:3], v[32:35], 0
    v_mfma_f32_16x16x32_bf16 v[64:67], a[4:7], v[36:39], v[64:67]
    ds_read_b128 v[220:223], v3 offset:35840
    ds_read_b128 v[212:215], v4 offset:35840
    v_mfma_f32_16x16x32_bf16 v[64:67], a[8:11], v[40:43], v[64:67]
    ds_read_b128 v[244:247], v5 offset:35840
    ds_read_b128 v[252:255], v6 offset:35840
    v_mfma_f32_16x16x32_bf16 v[64:67], a[12:15], v[44:47], v[64:67]
    ds_write_b128 v3, v[236:239] offset:33792
    buffer_load_dwordx4 v21, s[16:19], s26 offen offset:3072 lds
    s_waitcnt vmcnt(8)
    v_mfma_f32_16x16x16_bf16 v[200:203], v[88:89], a[44:45], 0
    v_cvt_pk_bf16_f32 v204, v204, v205
    v_cvt_pk_bf16_f32 v206, v206, v207
    v_mfma_f32_16x16x16_bf16 v[200:203], v[90:91], a[44:45], v[200:203]
    v_accvgpr_write_b32 a42, v204
    v_accvgpr_write_b32 a43, v206
    v_mfma_f32_16x16x32_bf16 v[68:71], a[28:31], v[44:47], 0
    ds_read_b128 v[48:51], v2 offset:61440
    ds_read_b128 v[52:55], v2 offset:61952
    v_mfma_f32_16x16x32_bf16 v[68:71], a[24:27], v[40:43], v[68:71]
    ds_read_b128 v[56:59], v2 offset:63488
    ds_read_b128 v[60:63], v2 offset:64000
    v_mfma_f32_16x16x32_bf16 v[68:71], a[20:23], v[36:39], v[68:71]
    v_exp_f32 v64, v64
    v_mfma_f32_16x16x32_bf16 v[68:71], a[16:19], v[32:35], v[68:71]
    v_exp_f32 v65, v65
    v_smfmac_f32_16x16x64_bf16 v[224:227], v[28:31], v[232:239], v23
    s_waitcnt lgkmcnt(4)
    s_barrier
    v_mfma_f32_16x16x16_bf16 v[204:207], v[88:89], a[46:47], 0
    v_cvt_pk_bf16_f32 v200, v200, v201
    v_cvt_pk_bf16_f32 v202, v202, v203
    v_mfma_f32_16x16x16_bf16 v[204:207], v[90:91], a[46:47], v[204:207]
    v_accvgpr_write_b32 a44, v200
    v_accvgpr_write_b32 a45, v202
    v_mfma_f32_16x16x32_bf16 v[100:103], a[128:131], v[216:219], 0
    v_exp_f32 v66, v66
    v_mfma_f32_16x16x32_bf16 v[100:103], a[160:163], v[208:211], v[100:103]
    v_exp_f32 v67, v67
    v_mfma_f32_16x16x32_bf16 v[100:103], a[192:195], v[240:243], v[100:103]
    v_perm_b32 v232, v65, v64, s35
    v_perm_b32 v233, v67, v66, s35
    v_mfma_f32_16x16x32_bf16 v[100:103], a[224:227], v[248:251], v[100:103]
    v_exp_f32 v68, v68
    v_mfma_f32_16x16x32_bf16 v[104:107], a[228:231], v[248:251], 0
    v_exp_f32 v69, v69
    v_mfma_f32_16x16x32_bf16 v[104:107], a[196:199], v[240:243], v[104:107]
    v_exp_f32 v70, v70
    v_mfma_f32_16x16x32_bf16 v[104:107], a[164:167], v[208:211], v[104:107]
    v_exp_f32 v71, v71
    v_mfma_f32_16x16x32_bf16 v[104:107], a[132:135], v[216:219], v[104:107]
    s_waitcnt lgkmcnt(0)
    v_perm_b32 v234, v69, v68, s35
    v_perm_b32 v235, v71, v70, s35
    s_add_u32 m0, s27, 135168
    s_add_u32 s26, s26, 0x1000
    buffer_load_dwordx4 v21, s[16:19], s26 offen offset:0 lds
    s_waitcnt vmcnt(8)
    v_mfma_f32_16x16x16_bf16 v[200:203], v[88:89], a[48:49], 0
    v_cvt_pk_bf16_f32 v204, v204, v205
    v_cvt_pk_bf16_f32 v206, v206, v207
    v_mfma_f32_16x16x16_bf16 v[200:203], v[90:91], a[48:49], v[200:203]
    v_accvgpr_write_b32 a46, v204
    v_accvgpr_write_b32 a47, v206
    v_mfma_f32_16x16x32_bf16 v[72:75], a[0:3], v[48:51], 0
    v_mfma_f32_16x16x32_bf16 v[72:75], a[4:7], v[52:55], v[72:75]
    ds_read_b128 v[32:35], v2 offset:0
    ds_read_b128 v[36:39], v2 offset:512
    v_mfma_f32_16x16x32_bf16 v[72:75], a[8:11], v[56:59], v[72:75]
    ds_read_b128 v[40:43], v2 offset:2048
    ds_read_b128 v[44:47], v2 offset:2560
    v_mfma_f32_16x16x32_bf16 v[72:75], a[12:15], v[60:63], v[72:75]
    ds_write_b128 v3, v[232:235] offset:34816
    v_mfma_f32_16x16x32_bf16 v[76:79], a[28:31], v[60:63], 0
    ds_read_b128 v[216:219], v3 offset:36864
    ds_read_b128 v[208:211], v4 offset:36864
    v_mfma_f32_16x16x32_bf16 v[76:79], a[24:27], v[56:59], v[76:79]
    ds_read_b128 v[240:243], v5 offset:36864
    ds_read_b128 v[248:251], v6 offset:36864
    v_mfma_f32_16x16x32_bf16 v[76:79], a[20:23], v[52:55], v[76:79]
    v_exp_f32 v72, v72
    v_mfma_f32_16x16x32_bf16 v[76:79], a[16:19], v[48:51], v[76:79]
    v_exp_f32 v73, v73
    v_mfma_f32_16x16x16_bf16 v[204:207], v[88:89], a[50:51], 0
    v_cvt_pk_bf16_f32 v200, v200, v201
    v_cvt_pk_bf16_f32 v202, v202, v203
    v_mfma_f32_16x16x16_bf16 v[204:207], v[90:91], a[50:51], v[204:207]
    v_accvgpr_write_b32 a48, v200
    v_accvgpr_write_b32 a49, v202
    v_mfma_f32_16x16x32_bf16 v[108:111], a[128:131], v[220:223], 0
    v_exp_f32 v74, v74
    v_mfma_f32_16x16x32_bf16 v[108:111], a[160:163], v[212:215], v[108:111]
    v_exp_f32 v75, v75
    v_mfma_f32_16x16x32_bf16 v[108:111], a[192:195], v[244:247], v[108:111]
    v_perm_b32 v236, v73, v72, s35
    v_perm_b32 v237, v75, v74, s35
    v_mfma_f32_16x16x32_bf16 v[108:111], a[224:227], v[252:255], v[108:111]
    v_exp_f32 v76, v76
    buffer_load_dwordx4 v21, s[16:19], s26 offen offset:1024 lds
    s_waitcnt vmcnt(8)
    v_mfma_f32_16x16x16_bf16 v[200:203], v[88:89], a[52:53], 0
    v_cvt_pk_bf16_f32 v204, v204, v205
    v_cvt_pk_bf16_f32 v206, v206, v207
    v_mfma_f32_16x16x16_bf16 v[200:203], v[90:91], a[52:53], v[200:203]
    v_accvgpr_write_b32 a50, v204
    v_accvgpr_write_b32 a51, v206
    v_mfma_f32_16x16x32_bf16 v[112:115], a[228:231], v[252:255], 0
    v_exp_f32 v77, v77
    v_mfma_f32_16x16x32_bf16 v[112:115], a[196:199], v[244:247], v[112:115]
    v_exp_f32 v78, v78
    v_mfma_f32_16x16x32_bf16 v[112:115], a[164:167], v[212:215], v[112:115]
    v_exp_f32 v79, v79
    v_mfma_f32_16x16x32_bf16 v[112:115], a[132:135], v[220:223], v[112:115]
    s_waitcnt lgkmcnt(5)
    v_perm_b32 v238, v77, v76, s35
    v_perm_b32 v239, v79, v78, s35
    v_mfma_f32_16x16x16_bf16 v[204:207], v[88:89], a[54:55], 0
    v_cvt_pk_bf16_f32 v200, v200, v201
    v_cvt_pk_bf16_f32 v202, v202, v203
    v_mfma_f32_16x16x16_bf16 v[204:207], v[90:91], a[54:55], v[204:207]
    v_accvgpr_write_b32 a52, v200
    v_accvgpr_write_b32 a53, v202
    buffer_load_dwordx4 v21, s[16:19], s26 offen offset:2048 lds
    s_waitcnt vmcnt(8)
    v_mfma_f32_16x16x16_bf16 v[200:203], v[88:89], a[56:57], 0
    s_nop 2
    v_cvt_pk_bf16_f32 v204, v204, v205
    v_cvt_pk_bf16_f32 v206, v206, v207
    v_mfma_f32_16x16x16_bf16 v[200:203], v[90:91], a[56:57], v[200:203]
    v_accvgpr_write_b32 a54, v204
    v_accvgpr_write_b32 a55, v206
    v_mfma_f32_16x16x16_bf16 v[204:207], v[88:89], a[58:59], 0
    s_nop 4
    v_cvt_pk_bf16_f32 v200, v200, v201
    v_cvt_pk_bf16_f32 v202, v202, v203
    v_mfma_f32_16x16x16_bf16 v[204:207], v[90:91], a[58:59], v[204:207]
    v_accvgpr_write_b32 a56, v200
    v_accvgpr_write_b32 a57, v202
    buffer_load_dwordx4 v21, s[16:19], s26 offen offset:3072 lds
    s_waitcnt vmcnt(8)
    v_mfma_f32_16x16x16_bf16 v[200:203], v[88:89], a[60:61], 0
    s_nop 2
    v_cvt_pk_bf16_f32 v204, v204, v205
    v_cvt_pk_bf16_f32 v206, v206, v207
    v_mfma_f32_16x16x16_bf16 v[200:203], v[90:91], a[60:61], v[200:203]
    v_accvgpr_write_b32 a58, v204
    v_accvgpr_write_b32 a59, v206
    v_mfma_f32_16x16x16_bf16 v[204:207], v[88:89], a[62:63], 0
    s_nop 4
    v_cvt_pk_bf16_f32 v200, v200, v201
    v_cvt_pk_bf16_f32 v202, v202, v203
    v_mfma_f32_16x16x16_bf16 v[204:207], v[90:91], a[62:63], v[204:207]
    v_accvgpr_write_b32 a60, v200
    v_accvgpr_write_b32 a61, v202
    s_nop 5
    v_cvt_pk_bf16_f32 v204, v204, v205
    v_cvt_pk_bf16_f32 v206, v206, v207
    v_accvgpr_write_b32 a62, v204
    v_accvgpr_write_b32 a63, v206
    v_mfma_f32_16x16x32_bf16 v[64:67], a[32:35], v[32:35], 0
    v_mfma_f32_16x16x32_bf16 v[64:67], a[36:39], v[36:39], v[64:67]
    ds_read_b128 v[220:223], v3 offset:37888
    ds_read_b128 v[212:215], v4 offset:37888
    v_mfma_f32_16x16x32_bf16 v[64:67], a[40:43], v[40:43], v[64:67]
    ds_read_b128 v[244:247], v5 offset:37888
    ds_read_b128 v[252:255], v6 offset:37888
    v_mfma_f32_16x16x32_bf16 v[64:67], a[44:47], v[44:47], v[64:67]
    ds_write_b128 v3, v[236:239] offset:35840
    v_mfma_f32_16x16x32_bf16 v[68:71], a[60:63], v[44:47], 0
    ds_read_b128 v[48:51], v2 offset:4096
    ds_read_b128 v[52:55], v2 offset:4608
    v_mfma_f32_16x16x32_bf16 v[68:71], a[56:59], v[40:43], v[68:71]
    ds_read_b128 v[56:59], v2 offset:6144
    ds_read_b128 v[60:63], v2 offset:6656
    v_mfma_f32_16x16x32_bf16 v[68:71], a[52:55], v[36:39], v[68:71]
    v_exp_f32 v64, v64
    v_mfma_f32_16x16x32_bf16 v[68:71], a[48:51], v[32:35], v[68:71]
    v_exp_f32 v65, v65
    v_smfmac_f32_16x16x64_bf16 v[228:231], v[28:31], v[232:239], v23
    s_waitcnt lgkmcnt(4)
    s_barrier
    v_mfma_f32_16x16x32_bf16 v[116:119], a[128:131], v[216:219], 0
    v_exp_f32 v66, v66
    v_mfma_f32_16x16x32_bf16 v[116:119], a[160:163], v[208:211], v[116:119]
    v_exp_f32 v67, v67
    v_mfma_f32_16x16x32_bf16 v[116:119], a[192:195], v[240:243], v[116:119]
    v_perm_b32 v232, v65, v64, s35
    v_perm_b32 v233, v67, v66, s35
    v_mfma_f32_16x16x32_bf16 v[116:119], a[224:227], v[248:251], v[116:119]
    v_exp_f32 v68, v68
    v_mfma_f32_16x16x32_bf16 v[120:123], a[228:231], v[248:251], 0
    v_exp_f32 v69, v69
    v_mfma_f32_16x16x32_bf16 v[120:123], a[196:199], v[240:243], v[120:123]
    v_exp_f32 v70, v70
    v_mfma_f32_16x16x32_bf16 v[120:123], a[164:167], v[208:211], v[120:123]
    v_exp_f32 v71, v71
    v_mfma_f32_16x16x32_bf16 v[120:123], a[132:135], v[216:219], v[120:123]
    s_waitcnt lgkmcnt(0)
    v_perm_b32 v234, v69, v68, s35
    v_perm_b32 v235, v71, v70, s35
    v_mfma_f32_16x16x32_bf16 v[72:75], a[32:35], v[48:51], 0
    s_add_u32 s25, s25, 0x1000
    v_mfma_f32_16x16x32_bf16 v[72:75], a[36:39], v[52:55], v[72:75]
    buffer_load_dwordx4 a[64:67], v10, s[12:15], s25 offen offset:0
    v_mfma_f32_16x16x32_bf16 v[72:75], a[40:43], v[56:59], v[72:75]
    ds_read_b128 v[32:35], v2 offset:8192
    ds_read_b128 v[36:39], v2 offset:8704
    v_mfma_f32_16x16x32_bf16 v[72:75], a[44:47], v[60:63], v[72:75]
    ds_read_b128 v[40:43], v2 offset:10240
    ds_read_b128 v[44:47], v2 offset:10752
    ds_write_b128 v3, v[232:235] offset:36864
    v_mfma_f32_16x16x32_bf16 v[76:79], a[60:63], v[60:63], 0
    ds_read_b128 v[216:219], v3 offset:38912
    ds_read_b128 v[208:211], v4 offset:38912
    v_mfma_f32_16x16x32_bf16 v[76:79], a[56:59], v[56:59], v[76:79]
    ds_read_b128 v[240:243], v5 offset:38912
    ds_read_b128 v[248:251], v6 offset:38912
    v_mfma_f32_16x16x32_bf16 v[76:79], a[52:55], v[52:55], v[76:79]
    v_exp_f32 v72, v72
    v_mfma_f32_16x16x32_bf16 v[76:79], a[48:51], v[48:51], v[76:79]
    v_exp_f32 v73, v73
    v_mfma_f32_16x16x32_bf16 v[124:127], a[128:131], v[220:223], 0
    v_exp_f32 v74, v74
    v_mfma_f32_16x16x32_bf16 v[124:127], a[160:163], v[212:215], v[124:127]
    v_exp_f32 v75, v75
    v_mfma_f32_16x16x32_bf16 v[124:127], a[192:195], v[244:247], v[124:127]
    v_perm_b32 v236, v73, v72, s35
    v_perm_b32 v237, v75, v74, s35
    v_mfma_f32_16x16x32_bf16 v[124:127], a[224:227], v[252:255], v[124:127]
    v_exp_f32 v76, v76
    v_mfma_f32_16x16x32_bf16 v[128:131], a[228:231], v[252:255], 0
    v_exp_f32 v77, v77
    v_mfma_f32_16x16x32_bf16 v[128:131], a[196:199], v[244:247], v[128:131]
    v_exp_f32 v78, v78
    v_mfma_f32_16x16x32_bf16 v[128:131], a[164:167], v[212:215], v[128:131]
    v_exp_f32 v79, v79
    v_mfma_f32_16x16x32_bf16 v[128:131], a[132:135], v[220:223], v[128:131]
    s_waitcnt lgkmcnt(5)
    v_perm_b32 v238, v77, v76, s35
    v_perm_b32 v239, v79, v78, s35
    v_mfma_f32_16x16x32_bf16 v[64:67], a[32:35], v[32:35], 0
    buffer_load_dwordx4 a[68:71], v10, s[12:15], s25 offen offset:64
    v_mfma_f32_16x16x32_bf16 v[64:67], a[36:39], v[36:39], v[64:67]
    ds_read_b128 v[220:223], v3 offset:39936
    ds_read_b128 v[212:215], v4 offset:39936
    v_mfma_f32_16x16x32_bf16 v[64:67], a[40:43], v[40:43], v[64:67]
    ds_read_b128 v[244:247], v5 offset:39936
    ds_read_b128 v[252:255], v6 offset:39936
    v_mfma_f32_16x16x32_bf16 v[64:67], a[44:47], v[44:47], v[64:67]
    ds_write_b128 v3, v[236:239] offset:37888
    v_mfma_f32_16x16x32_bf16 v[68:71], a[60:63], v[44:47], 0
    ds_read_b128 v[48:51], v2 offset:12288
    ds_read_b128 v[52:55], v2 offset:12800
    v_mfma_f32_16x16x32_bf16 v[68:71], a[56:59], v[40:43], v[68:71]
    ds_read_b128 v[56:59], v2 offset:14336
    ds_read_b128 v[60:63], v2 offset:14848
    v_mfma_f32_16x16x32_bf16 v[68:71], a[52:55], v[36:39], v[68:71]
    v_exp_f32 v64, v64
    v_mfma_f32_16x16x32_bf16 v[68:71], a[48:51], v[32:35], v[68:71]
    v_exp_f32 v65, v65
    v_smfmac_f32_16x16x64_bf16 v[148:151], v[28:31], v[232:239], v23
    s_waitcnt lgkmcnt(4)
    s_barrier
    v_mfma_f32_16x16x32_bf16 v[132:135], a[128:131], v[216:219], 0
    v_exp_f32 v66, v66
    v_mfma_f32_16x16x32_bf16 v[132:135], a[160:163], v[208:211], v[132:135]
    v_exp_f32 v67, v67
    v_mfma_f32_16x16x32_bf16 v[132:135], a[192:195], v[240:243], v[132:135]
    v_perm_b32 v232, v65, v64, s35
    v_perm_b32 v233, v67, v66, s35
    v_mfma_f32_16x16x32_bf16 v[132:135], a[224:227], v[248:251], v[132:135]
    v_exp_f32 v68, v68
    v_mfma_f32_16x16x32_bf16 v[136:139], a[228:231], v[248:251], 0
    v_exp_f32 v69, v69
    v_mfma_f32_16x16x32_bf16 v[136:139], a[196:199], v[240:243], v[136:139]
    v_exp_f32 v70, v70
    v_mfma_f32_16x16x32_bf16 v[136:139], a[164:167], v[208:211], v[136:139]
    v_exp_f32 v71, v71
    v_mfma_f32_16x16x32_bf16 v[136:139], a[132:135], v[216:219], v[136:139]
    s_waitcnt lgkmcnt(0)
    v_perm_b32 v234, v69, v68, s35
    v_perm_b32 v235, v71, v70, s35
    v_mfma_f32_16x16x32_bf16 v[72:75], a[32:35], v[48:51], 0
    buffer_load_dwordx4 a[72:75], v10, s[12:15], s25 offen offset:128
    v_mfma_f32_16x16x32_bf16 v[72:75], a[36:39], v[52:55], v[72:75]
    ds_read_b128 v[32:35], v2 offset:32768
    ds_read_b128 v[36:39], v2 offset:33280
    v_mfma_f32_16x16x32_bf16 v[72:75], a[40:43], v[56:59], v[72:75]
    ds_read_b128 v[40:43], v2 offset:34816
    ds_read_b128 v[44:47], v2 offset:35328
    v_mfma_f32_16x16x32_bf16 v[72:75], a[44:47], v[60:63], v[72:75]
    ds_write_b128 v3, v[232:235] offset:38912
    v_mfma_f32_16x16x32_bf16 v[76:79], a[60:63], v[60:63], 0
    ds_read_b128 v[216:219], v3 offset:32768
    ds_read_b128 v[208:211], v4 offset:32768
    v_mfma_f32_16x16x32_bf16 v[76:79], a[56:59], v[56:59], v[76:79]
    ds_read_b128 v[240:243], v5 offset:32768
    ds_read_b128 v[248:251], v6 offset:32768
    v_mfma_f32_16x16x32_bf16 v[76:79], a[52:55], v[52:55], v[76:79]
L_s1:
    s_cbranch_execz L_cep
L_s1_n:
    v_exp_f32 v72, v72
    v_mfma_f32_16x16x32_bf16 v[76:79], a[48:51], v[48:51], v[76:79]
    v_exp_f32 v73, v73
    v_mfma_f32_16x16x32_bf16 v[140:143], a[128:131], v[220:223], 0
    v_exp_f32 v74, v74
    v_mfma_f32_16x16x32_bf16 v[140:143], a[160:163], v[212:215], v[140:143]
    v_exp_f32 v75, v75
    v_mfma_f32_16x16x32_bf16 v[140:143], a[192:195], v[244:247], v[140:143]
    v_perm_b32 v236, v73, v72, s35
    v_perm_b32 v237, v75, v74, s35
    v_mfma_f32_16x16x32_bf16 v[140:143], a[224:227], v[252:255], v[140:143]
    v_exp_f32 v76, v76
    v_mfma_f32_16x16x32_bf16 v[144:147], a[228:231], v[252:255], 0
    v_exp_f32 v77, v77
    v_mfma_f32_16x16x32_bf16 v[144:147], a[196:199], v[244:247], v[144:147]
    v_exp_f32 v78, v78
    v_mfma_f32_16x16x32_bf16 v[144:147], a[164:167], v[212:215], v[144:147]
    v_exp_f32 v79, v79
    v_mfma_f32_16x16x32_bf16 v[144:147], a[132:135], v[220:223], v[144:147]
    s_waitcnt lgkmcnt(5)
    v_perm_b32 v238, v77, v76, s35
    v_perm_b32 v239, v79, v78, s35
    v_mfma_f32_16x16x32_bf16 v[64:67], a[32:35], v[32:35], 0
    buffer_load_dwordx4 a[76:79], v10, s[12:15], s25 offen offset:192
    v_mfma_f32_16x16x32_bf16 v[64:67], a[36:39], v[36:39], v[64:67]
    ds_read_b128 v[220:223], v3 offset:33792
    ds_read_b128 v[212:215], v4 offset:33792
    v_mfma_f32_16x16x32_bf16 v[64:67], a[40:43], v[40:43], v[64:67]
    ds_read_b128 v[244:247], v5 offset:33792
    ds_read_b128 v[252:255], v6 offset:33792
    v_mfma_f32_16x16x32_bf16 v[64:67], a[44:47], v[44:47], v[64:67]
    ds_write_b128 v3, v[236:239] offset:39936
    v_mfma_f32_16x16x32_bf16 v[68:71], a[60:63], v[44:47], 0
    ds_read_b128 v[48:51], v2 offset:36864
    ds_read_b128 v[52:55], v2 offset:37376
    v_mfma_f32_16x16x32_bf16 v[68:71], a[56:59], v[40:43], v[68:71]
    ds_read_b128 v[56:59], v2 offset:38912
    ds_read_b128 v[60:63], v2 offset:39424
    v_mfma_f32_16x16x32_bf16 v[68:71], a[52:55], v[36:39], v[68:71]
    v_exp_f32 v64, v64
    v_mfma_f32_16x16x32_bf16 v[68:71], a[48:51], v[32:35], v[68:71]
    v_exp_f32 v65, v65
    v_smfmac_f32_16x16x64_bf16 v[152:155], v[28:31], v[232:239], v23
    s_waitcnt lgkmcnt(4)
    s_barrier
    v_mfma_f32_16x16x32_bf16 v[164:167], a[128:131], v[216:219], 0
    v_exp_f32 v66, v66
    v_mfma_f32_16x16x32_bf16 v[164:167], a[160:163], v[208:211], v[164:167]
    v_exp_f32 v67, v67
    v_mfma_f32_16x16x32_bf16 v[164:167], a[192:195], v[240:243], v[164:167]
    v_perm_b32 v232, v65, v64, s35
    v_perm_b32 v233, v67, v66, s35
    v_mfma_f32_16x16x32_bf16 v[164:167], a[224:227], v[248:251], v[164:167]
    v_exp_f32 v68, v68
    v_mfma_f32_16x16x32_bf16 v[168:171], a[228:231], v[248:251], 0
    v_exp_f32 v69, v69
    v_mfma_f32_16x16x32_bf16 v[168:171], a[196:199], v[240:243], v[168:171]
    v_exp_f32 v70, v70
    v_mfma_f32_16x16x32_bf16 v[168:171], a[164:167], v[208:211], v[168:171]
    v_exp_f32 v71, v71
    v_mfma_f32_16x16x32_bf16 v[168:171], a[132:135], v[216:219], v[168:171]
    s_waitcnt lgkmcnt(0)
    v_perm_b32 v234, v69, v68, s35
    v_perm_b32 v235, v71, v70, s35
    v_mfma_f32_16x16x32_bf16 v[72:75], a[32:35], v[48:51], 0
    s_add_u32 s25, s25, 0x1000
    v_mfma_f32_16x16x32_bf16 v[72:75], a[36:39], v[52:55], v[72:75]
    buffer_load_dwordx4 a[80:83], v10, s[12:15], s25 offen offset:0
    v_mfma_f32_16x16x32_bf16 v[72:75], a[40:43], v[56:59], v[72:75]
    ds_read_b128 v[32:35], v2 offset:40960
    ds_read_b128 v[36:39], v2 offset:41472
    v_mfma_f32_16x16x32_bf16 v[72:75], a[44:47], v[60:63], v[72:75]
    ds_read_b128 v[40:43], v2 offset:43008
    ds_read_b128 v[44:47], v2 offset:43520
    ds_write_b128 v3, v[232:235] offset:32768
    v_mfma_f32_16x16x32_bf16 v[76:79], a[60:63], v[60:63], 0
    ds_read_b128 v[216:219], v3 offset:34816
    ds_read_b128 v[208:211], v4 offset:34816
    v_mfma_f32_16x16x32_bf16 v[76:79], a[56:59], v[56:59], v[76:79]
    ds_read_b128 v[240:243], v5 offset:34816
    ds_read_b128 v[248:251], v6 offset:34816
    v_mfma_f32_16x16x32_bf16 v[76:79], a[52:55], v[52:55], v[76:79]
    v_exp_f32 v72, v72
    v_mfma_f32_16x16x32_bf16 v[76:79], a[48:51], v[48:51], v[76:79]
    v_exp_f32 v73, v73
    v_mfma_f32_16x16x32_bf16 v[172:175], a[128:131], v[220:223], 0
    v_exp_f32 v74, v74
    v_mfma_f32_16x16x32_bf16 v[172:175], a[160:163], v[212:215], v[172:175]
    v_exp_f32 v75, v75
    v_mfma_f32_16x16x32_bf16 v[172:175], a[192:195], v[244:247], v[172:175]
    v_perm_b32 v236, v73, v72, s35
    v_perm_b32 v237, v75, v74, s35
    v_mfma_f32_16x16x32_bf16 v[172:175], a[224:227], v[252:255], v[172:175]
    v_exp_f32 v76, v76
    v_mfma_f32_16x16x32_bf16 v[176:179], a[228:231], v[252:255], 0
    v_exp_f32 v77, v77
    v_mfma_f32_16x16x32_bf16 v[176:179], a[196:199], v[244:247], v[176:179]
    v_exp_f32 v78, v78
    v_mfma_f32_16x16x32_bf16 v[176:179], a[164:167], v[212:215], v[176:179]
    v_exp_f32 v79, v79
    v_mfma_f32_16x16x32_bf16 v[176:179], a[132:135], v[220:223], v[176:179]
    s_waitcnt lgkmcnt(5)
    v_perm_b32 v238, v77, v76, s35
    v_perm_b32 v239, v79, v78, s35
    v_mfma_f32_16x16x32_bf16 v[64:67], a[32:35], v[32:35], 0
    buffer_load_dwordx4 a[84:87], v10, s[12:15], s25 offen offset:64
    v_mfma_f32_16x16x32_bf16 v[64:67], a[36:39], v[36:39], v[64:67]
    ds_read_b128 v[220:223], v3 offset:35840
    ds_read_b128 v[212:215], v4 offset:35840
    v_mfma_f32_16x16x32_bf16 v[64:67], a[40:43], v[40:43], v[64:67]
    ds_read_b128 v[244:247], v5 offset:35840
    ds_read_b128 v[252:255], v6 offset:35840
    v_mfma_f32_16x16x32_bf16 v[64:67], a[44:47], v[44:47], v[64:67]
    ds_write_b128 v3, v[236:239] offset:33792
    v_mfma_f32_16x16x32_bf16 v[68:71], a[60:63], v[44:47], 0
    ds_read_b128 v[48:51], v2 offset:45056
    ds_read_b128 v[52:55], v2 offset:45568
    v_mfma_f32_16x16x32_bf16 v[68:71], a[56:59], v[40:43], v[68:71]
    ds_read_b128 v[56:59], v2 offset:47104
    ds_read_b128 v[60:63], v2 offset:47616
    v_mfma_f32_16x16x32_bf16 v[68:71], a[52:55], v[36:39], v[68:71]
    v_exp_f32 v64, v64
    v_mfma_f32_16x16x32_bf16 v[68:71], a[48:51], v[32:35], v[68:71]
    v_exp_f32 v65, v65
    v_smfmac_f32_16x16x64_bf16 v[156:159], v[28:31], v[232:239], v23
    s_waitcnt lgkmcnt(9)
    buffer_load_dwordx4 a[88:91], v10, s[12:15], s25 offen offset:128
    buffer_load_dwordx4 a[92:95], v10, s[12:15], s25 offen offset:192
    s_waitcnt vmcnt(8) lgkmcnt(4)
    s_barrier
    ds_read_b64_tr_b16 a[136:137], v13 offset:32768
    ds_read_b64_tr_b16 a[138:139], v13 offset:36864
    ds_read_b64_tr_b16 a[140:141], v13 offset:32776
    v_mfma_f32_16x16x32_bf16 v[180:183], a[128:131], v[216:219], 0
    v_exp_f32 v66, v66
    v_mfma_f32_16x16x32_bf16 v[180:183], a[160:163], v[208:211], v[180:183]
    v_exp_f32 v67, v67
    v_mfma_f32_16x16x32_bf16 v[180:183], a[192:195], v[240:243], v[180:183]
    v_perm_b32 v232, v65, v64, s35
    v_perm_b32 v233, v67, v66, s35
    v_mfma_f32_16x16x32_bf16 v[180:183], a[224:227], v[248:251], v[180:183]
    ds_read_b64_tr_b16 a[142:143], v13 offset:36872
    ds_read_b64_tr_b16 a[168:169], v14 offset:32768
    ds_read_b64_tr_b16 a[170:171], v14 offset:36864
    v_exp_f32 v68, v68
    v_mfma_f32_16x16x32_bf16 v[184:187], a[228:231], v[248:251], 0
    v_exp_f32 v69, v69
    v_mfma_f32_16x16x32_bf16 v[184:187], a[196:199], v[240:243], v[184:187]
    v_exp_f32 v70, v70
    v_mfma_f32_16x16x32_bf16 v[184:187], a[164:167], v[208:211], v[184:187]
    v_exp_f32 v71, v71
    v_mfma_f32_16x16x32_bf16 v[184:187], a[132:135], v[216:219], v[184:187]
    s_waitcnt lgkmcnt(6)
    ds_read_b64_tr_b16 a[172:173], v14 offset:32776
    ds_read_b64_tr_b16 a[174:175], v14 offset:36872
    v_perm_b32 v234, v69, v68, s35
    v_perm_b32 v235, v71, v70, s35
    v_mfma_f32_16x16x32_bf16 v[72:75], a[32:35], v[48:51], 0
    ds_read_b64_tr_b16 a[200:201], v15 offset:32768
    ds_read_b64_tr_b16 a[202:203], v15 offset:36864
    v_mfma_f32_16x16x32_bf16 v[72:75], a[36:39], v[52:55], v[72:75]
    ds_read_b64_tr_b16 a[204:205], v15 offset:32776
    ds_read_b128 v[32:35], v2 offset:49152
    v_mfma_f32_16x16x32_bf16 v[72:75], a[40:43], v[56:59], v[72:75]
    ds_read_b128 v[36:39], v2 offset:49664
    ds_read_b128 v[40:43], v2 offset:51200
    v_mfma_f32_16x16x32_bf16 v[72:75], a[44:47], v[60:63], v[72:75]
    ds_read_b128 v[44:47], v2 offset:51712
    ds_write_b128 v3, v[232:235] offset:34816
    v_mfma_f32_16x16x32_bf16 v[76:79], a[60:63], v[60:63], 0
    ds_read_b128 v[216:219], v3 offset:36864
    ds_read_b128 v[208:211], v4 offset:36864
    v_mfma_f32_16x16x32_bf16 v[76:79], a[56:59], v[56:59], v[76:79]
    ds_read_b128 v[240:243], v5 offset:36864
    ds_read_b128 v[248:251], v6 offset:36864
    v_mfma_f32_16x16x32_bf16 v[76:79], a[52:55], v[52:55], v[76:79]
    v_exp_f32 v72, v72
    v_mfma_f32_16x16x32_bf16 v[76:79], a[48:51], v[48:51], v[76:79]
    ds_read_b64_tr_b16 a[206:207], v15 offset:36872
    ds_read_b64_tr_b16 a[232:233], v16 offset:32768
    ds_read_b64_tr_b16 a[234:235], v16 offset:36864
    v_exp_f32 v73, v73
    s_add_u32 m0, s27, 98304
    s_add_u32 s26, s26, 0x1000
    buffer_load_dwordx4 v21, s[16:19], s26 offen offset:0 lds
    s_waitcnt vmcnt(8)
    v_mfma_f32_16x16x16_bf16 v[200:203], v[88:89], a[64:65], 0
    v_mfma_f32_16x16x16_bf16 v[200:203], v[90:91], a[64:65], v[200:203]
    v_mfma_f32_16x16x32_bf16 v[188:191], a[128:131], v[220:223], 0
    v_exp_f32 v74, v74
    v_mfma_f32_16x16x32_bf16 v[188:191], a[160:163], v[212:215], v[188:191]
    v_exp_f32 v75, v75
    v_mfma_f32_16x16x32_bf16 v[188:191], a[192:195], v[244:247], v[188:191]
    v_perm_b32 v236, v73, v72, s35
    v_perm_b32 v237, v75, v74, s35
    v_mfma_f32_16x16x32_bf16 v[188:191], a[224:227], v[252:255], v[188:191]
    ds_read_b64_tr_b16 a[236:237], v16 offset:32776
    ds_read_b64_tr_b16 a[238:239], v16 offset:36872
    v_exp_f32 v76, v76
    v_mfma_f32_16x16x16_bf16 v[204:207], v[88:89], a[66:67], 0
    v_cvt_pk_bf16_f32 v200, v200, v201
    v_cvt_pk_bf16_f32 v202, v202, v203
    v_mfma_f32_16x16x16_bf16 v[204:207], v[90:91], a[66:67], v[204:207]
    v_accvgpr_write_b32 a64, v200
    v_accvgpr_write_b32 a65, v202
    v_mfma_f32_16x16x32_bf16 v[192:195], a[228:231], v[252:255], 0
    v_exp_f32 v77, v77
    v_mfma_f32_16x16x32_bf16 v[192:195], a[196:199], v[244:247], v[192:195]
    v_exp_f32 v78, v78
    v_mfma_f32_16x16x32_bf16 v[192:195], a[164:167], v[212:215], v[192:195]
    v_exp_f32 v79, v79
    v_mfma_f32_16x16x32_bf16 v[192:195], a[132:135], v[220:223], v[192:195]
    s_waitcnt lgkmcnt(10)
    v_perm_b32 v238, v77, v76, s35
    v_perm_b32 v239, v79, v78, s35
    buffer_load_dwordx4 v21, s[16:19], s26 offen offset:1024 lds
    s_waitcnt vmcnt(8)
    v_mfma_f32_16x16x16_bf16 v[200:203], v[88:89], a[68:69], 0
    v_cvt_pk_bf16_f32 v204, v204, v205
    v_cvt_pk_bf16_f32 v206, v206, v207
    v_mfma_f32_16x16x16_bf16 v[200:203], v[90:91], a[68:69], v[200:203]
    v_accvgpr_write_b32 a66, v204
    v_accvgpr_write_b32 a67, v206
    v_mfma_f32_16x16x32_bf16 v[64:67], a[32:35], v[32:35], 0
    v_mfma_f32_16x16x32_bf16 v[64:67], a[36:39], v[36:39], v[64:67]
    ds_read_b128 v[220:223], v3 offset:37888
    ds_read_b128 v[212:215], v4 offset:37888
    v_mfma_f32_16x16x32_bf16 v[64:67], a[40:43], v[40:43], v[64:67]
    ds_read_b128 v[244:247], v5 offset:37888
    ds_read_b128 v[252:255], v6 offset:37888
    v_mfma_f32_16x16x32_bf16 v[64:67], a[44:47], v[44:47], v[64:67]
    ds_write_b128 v3, v[236:239] offset:35840
    v_mfma_f32_16x16x16_bf16 v[204:207], v[88:89], a[70:71], 0
    v_cvt_pk_bf16_f32 v200, v200, v201
    v_cvt_pk_bf16_f32 v202, v202, v203
    v_mfma_f32_16x16x16_bf16 v[204:207], v[90:91], a[70:71], v[204:207]
    v_accvgpr_write_b32 a68, v200
    v_accvgpr_write_b32 a69, v202
    v_mfma_f32_16x16x32_bf16 v[68:71], a[60:63], v[44:47], 0
    ds_read_b128 v[48:51], v2 offset:53248
    ds_read_b128 v[52:55], v2 offset:53760
    v_mfma_f32_16x16x32_bf16 v[68:71], a[56:59], v[40:43], v[68:71]
    ds_read_b128 v[56:59], v2 offset:55296
    ds_read_b128 v[60:63], v2 offset:55808
    v_mfma_f32_16x16x32_bf16 v[68:71], a[52:55], v[36:39], v[68:71]
    v_exp_f32 v64, v64
    v_mfma_f32_16x16x32_bf16 v[68:71], a[48:51], v[32:35], v[68:71]
    v_exp_f32 v65, v65
    v_smfmac_f32_16x16x64_bf16 v[160:163], v[28:31], v[232:239], v23
    s_waitcnt lgkmcnt(4)
    s_barrier
    buffer_load_dwordx4 v21, s[16:19], s26 offen offset:2048 lds
    s_waitcnt vmcnt(8)
    v_mfma_f32_16x16x16_bf16 v[200:203], v[88:89], a[72:73], 0
    v_cvt_pk_bf16_f32 v204, v204, v205
    v_cvt_pk_bf16_f32 v206, v206, v207
    v_mfma_f32_16x16x16_bf16 v[200:203], v[90:91], a[72:73], v[200:203]
    v_accvgpr_write_b32 a70, v204
    v_accvgpr_write_b32 a71, v206
    v_mfma_f32_16x16x32_bf16 v[80:83], a[136:139], v[216:219], v[80:83]
    v_exp_f32 v66, v66
    v_mfma_f32_16x16x32_bf16 v[80:83], a[168:171], v[208:211], v[80:83]
    v_exp_f32 v67, v67
    v_mfma_f32_16x16x32_bf16 v[80:83], a[200:203], v[240:243], v[80:83]
    v_perm_b32 v232, v65, v64, s35
    v_perm_b32 v233, v67, v66, s35
    v_mfma_f32_16x16x32_bf16 v[80:83], a[232:235], v[248:251], v[80:83]
    v_exp_f32 v68, v68
    v_mfma_f32_16x16x32_bf16 v[84:87], a[236:239], v[248:251], v[84:87]
    v_exp_f32 v69, v69
    v_mfma_f32_16x16x32_bf16 v[84:87], a[204:207], v[240:243], v[84:87]
    v_exp_f32 v70, v70
    v_mfma_f32_16x16x32_bf16 v[84:87], a[172:175], v[208:211], v[84:87]
    v_exp_f32 v71, v71
    v_mfma_f32_16x16x32_bf16 v[84:87], a[140:143], v[216:219], v[84:87]
    s_waitcnt lgkmcnt(0)
    v_perm_b32 v234, v69, v68, s35
    v_perm_b32 v235, v71, v70, s35
    v_mfma_f32_16x16x16_bf16 v[204:207], v[88:89], a[74:75], 0
    v_cvt_pk_bf16_f32 v200, v200, v201
    v_cvt_pk_bf16_f32 v202, v202, v203
    v_mfma_f32_16x16x16_bf16 v[204:207], v[90:91], a[74:75], v[204:207]
    v_accvgpr_write_b32 a72, v200
    v_accvgpr_write_b32 a73, v202
    v_mfma_f32_16x16x32_bf16 v[72:75], a[32:35], v[48:51], 0
    buffer_load_dwordx4 v21, s[16:19], s26 offen offset:3072 lds
    v_mfma_f32_16x16x32_bf16 v[72:75], a[36:39], v[52:55], v[72:75]
    ds_read_b128 v[32:35], v2 offset:57344
    ds_read_b128 v[36:39], v2 offset:57856
    v_mfma_f32_16x16x32_bf16 v[72:75], a[40:43], v[56:59], v[72:75]
    ds_read_b128 v[40:43], v2 offset:59392
    ds_read_b128 v[44:47], v2 offset:59904
    v_mfma_f32_16x16x32_bf16 v[72:75], a[44:47], v[60:63], v[72:75]
    ds_write_b128 v3, v[232:235] offset:36864
    v_mfma_f32_16x16x32_bf16 v[76:79], a[60:63], v[60:63], 0
    ds_read_b128 v[216:219], v3 offset:38912
    ds_read_b128 v[208:211], v4 offset:38912
    v_mfma_f32_16x16x32_bf16 v[76:79], a[56:59], v[56:59], v[76:79]
    ds_read_b128 v[240:243], v5 offset:38912
    ds_read_b128 v[248:251], v6 offset:38912
    v_mfma_f32_16x16x32_bf16 v[76:79], a[52:55], v[52:55], v[76:79]
    v_exp_f32 v72, v72
    v_mfma_f32_16x16x32_bf16 v[76:79], a[48:51], v[48:51], v[76:79]
    v_exp_f32 v73, v73
    s_waitcnt vmcnt(8)
    v_mfma_f32_16x16x16_bf16 v[200:203], v[88:89], a[76:77], 0
    v_cvt_pk_bf16_f32 v204, v204, v205
    v_cvt_pk_bf16_f32 v206, v206, v207
    v_mfma_f32_16x16x16_bf16 v[200:203], v[90:91], a[76:77], v[200:203]
    v_accvgpr_write_b32 a74, v204
    v_accvgpr_write_b32 a75, v206
    v_mfma_f32_16x16x32_bf16 v[92:95], a[136:139], v[220:223], v[92:95]
    v_exp_f32 v74, v74
    v_mfma_f32_16x16x32_bf16 v[92:95], a[168:171], v[212:215], v[92:95]
    v_exp_f32 v75, v75
    v_mfma_f32_16x16x32_bf16 v[92:95], a[200:203], v[244:247], v[92:95]
    v_perm_b32 v236, v73, v72, s35
    v_perm_b32 v237, v75, v74, s35
    v_mfma_f32_16x16x32_bf16 v[92:95], a[232:235], v[252:255], v[92:95]
    v_exp_f32 v76, v76
    v_mfma_f32_16x16x16_bf16 v[204:207], v[88:89], a[78:79], 0
    v_cvt_pk_bf16_f32 v200, v200, v201
    v_cvt_pk_bf16_f32 v202, v202, v203
    v_mfma_f32_16x16x16_bf16 v[204:207], v[90:91], a[78:79], v[204:207]
    v_accvgpr_write_b32 a76, v200
    v_accvgpr_write_b32 a77, v202
    v_mfma_f32_16x16x32_bf16 v[96:99], a[236:239], v[252:255], v[96:99]
    v_exp_f32 v77, v77
    v_mfma_f32_16x16x32_bf16 v[96:99], a[204:207], v[244:247], v[96:99]
    v_exp_f32 v78, v78
    v_mfma_f32_16x16x32_bf16 v[96:99], a[172:175], v[212:215], v[96:99]
    v_exp_f32 v79, v79
    v_mfma_f32_16x16x32_bf16 v[96:99], a[140:143], v[220:223], v[96:99]
    s_waitcnt lgkmcnt(5)
    v_perm_b32 v238, v77, v76, s35
    v_perm_b32 v239, v79, v78, s35
    s_add_u32 m0, s27, 102400
    s_add_u32 s26, s26, 0x1000
    buffer_load_dwordx4 v21, s[16:19], s26 offen offset:0 lds
    s_waitcnt vmcnt(8)
    v_mfma_f32_16x16x16_bf16 v[200:203], v[88:89], a[80:81], 0
    v_cvt_pk_bf16_f32 v204, v204, v205
    v_cvt_pk_bf16_f32 v206, v206, v207
    v_mfma_f32_16x16x16_bf16 v[200:203], v[90:91], a[80:81], v[200:203]
    v_accvgpr_write_b32 a78, v204
    v_accvgpr_write_b32 a79, v206
    v_mfma_f32_16x16x32_bf16 v[64:67], a[32:35], v[32:35], 0
    v_mfma_f32_16x16x32_bf16 v[64:67], a[36:39], v[36:39], v[64:67]
    ds_read_b128 v[220:223], v3 offset:39936
    ds_read_b128 v[212:215], v4 offset:39936
    v_mfma_f32_16x16x32_bf16 v[64:67], a[40:43], v[40:43], v[64:67]
    ds_read_b128 v[244:247], v5 offset:39936
    ds_read_b128 v[252:255], v6 offset:39936
    v_mfma_f32_16x16x32_bf16 v[64:67], a[44:47], v[44:47], v[64:67]
    ds_write_b128 v3, v[236:239] offset:37888
    v_mfma_f32_16x16x16_bf16 v[204:207], v[88:89], a[82:83], 0
    v_cvt_pk_bf16_f32 v200, v200, v201
    v_cvt_pk_bf16_f32 v202, v202, v203
    v_mfma_f32_16x16x16_bf16 v[204:207], v[90:91], a[82:83], v[204:207]
    v_accvgpr_write_b32 a80, v200
    v_accvgpr_write_b32 a81, v202
    v_mfma_f32_16x16x32_bf16 v[68:71], a[60:63], v[44:47], 0
    ds_read_b128 v[48:51], v2 offset:61440
    ds_read_b128 v[52:55], v2 offset:61952
    v_mfma_f32_16x16x32_bf16 v[68:71], a[56:59], v[40:43], v[68:71]
    ds_read_b128 v[56:59], v2 offset:63488
    ds_read_b128 v[60:63], v2 offset:64000
    v_mfma_f32_16x16x32_bf16 v[68:71], a[52:55], v[36:39], v[68:71]
    v_exp_f32 v64, v64
    v_mfma_f32_16x16x32_bf16 v[68:71], a[48:51], v[32:35], v[68:71]
    v_exp_f32 v65, v65
    v_smfmac_f32_16x16x64_bf16 v[224:227], v[28:31], v[232:239], v23
    s_waitcnt lgkmcnt(4)
    s_barrier
    buffer_load_dwordx4 v21, s[16:19], s26 offen offset:1024 lds
    s_waitcnt vmcnt(8)
    v_mfma_f32_16x16x16_bf16 v[200:203], v[88:89], a[84:85], 0
    v_cvt_pk_bf16_f32 v204, v204, v205
    v_cvt_pk_bf16_f32 v206, v206, v207
    v_mfma_f32_16x16x16_bf16 v[200:203], v[90:91], a[84:85], v[200:203]
    v_accvgpr_write_b32 a82, v204
    v_accvgpr_write_b32 a83, v206
    v_mfma_f32_16x16x32_bf16 v[100:103], a[136:139], v[216:219], v[100:103]
    v_exp_f32 v66, v66
    v_mfma_f32_16x16x32_bf16 v[100:103], a[168:171], v[208:211], v[100:103]
    v_exp_f32 v67, v67
    v_mfma_f32_16x16x32_bf16 v[100:103], a[200:203], v[240:243], v[100:103]
    v_perm_b32 v232, v65, v64, s35
    v_perm_b32 v233, v67, v66, s35
    v_mfma_f32_16x16x32_bf16 v[100:103], a[232:235], v[248:251], v[100:103]
    v_exp_f32 v68, v68
    v_mfma_f32_16x16x32_bf16 v[104:107], a[236:239], v[248:251], v[104:107]
    v_exp_f32 v69, v69
    v_mfma_f32_16x16x32_bf16 v[104:107], a[204:207], v[240:243], v[104:107]
    v_exp_f32 v70, v70
    v_mfma_f32_16x16x32_bf16 v[104:107], a[172:175], v[208:211], v[104:107]
    v_exp_f32 v71, v71
    v_mfma_f32_16x16x32_bf16 v[104:107], a[140:143], v[216:219], v[104:107]
    s_waitcnt lgkmcnt(0)
    v_perm_b32 v234, v69, v68, s35
    v_perm_b32 v235, v71, v70, s35
    v_mfma_f32_16x16x16_bf16 v[204:207], v[88:89], a[86:87], 0
    v_cvt_pk_bf16_f32 v200, v200, v201
    v_cvt_pk_bf16_f32 v202, v202, v203
    v_mfma_f32_16x16x16_bf16 v[204:207], v[90:91], a[86:87], v[204:207]
    v_accvgpr_write_b32 a84, v200
    v_accvgpr_write_b32 a85, v202
    v_mfma_f32_16x16x32_bf16 v[72:75], a[32:35], v[48:51], 0
    buffer_load_dwordx4 v21, s[16:19], s26 offen offset:2048 lds
    v_mfma_f32_16x16x32_bf16 v[72:75], a[36:39], v[52:55], v[72:75]
    ds_read_b128 v[32:35], v2 offset:0
    ds_read_b128 v[36:39], v2 offset:512
    v_mfma_f32_16x16x32_bf16 v[72:75], a[40:43], v[56:59], v[72:75]
    ds_read_b128 v[40:43], v2 offset:2048
    ds_read_b128 v[44:47], v2 offset:2560
    v_mfma_f32_16x16x32_bf16 v[72:75], a[44:47], v[60:63], v[72:75]
    ds_write_b128 v3, v[232:235] offset:38912
    v_mfma_f32_16x16x32_bf16 v[76:79], a[60:63], v[60:63], 0
    ds_read_b128 v[216:219], v3 offset:32768
    ds_read_b128 v[208:211], v4 offset:32768
    v_mfma_f32_16x16x32_bf16 v[76:79], a[56:59], v[56:59], v[76:79]
    ds_read_b128 v[240:243], v5 offset:32768
    ds_read_b128 v[248:251], v6 offset:32768
    v_mfma_f32_16x16x32_bf16 v[76:79], a[52:55], v[52:55], v[76:79]
    v_exp_f32 v72, v72
    v_mfma_f32_16x16x32_bf16 v[76:79], a[48:51], v[48:51], v[76:79]
    v_exp_f32 v73, v73
    s_waitcnt vmcnt(8)
    v_mfma_f32_16x16x16_bf16 v[200:203], v[88:89], a[88:89], 0
    v_cvt_pk_bf16_f32 v204, v204, v205
    v_cvt_pk_bf16_f32 v206, v206, v207
    v_mfma_f32_16x16x16_bf16 v[200:203], v[90:91], a[88:89], v[200:203]
    v_accvgpr_write_b32 a86, v204
    v_accvgpr_write_b32 a87, v206
    v_mfma_f32_16x16x32_bf16 v[108:111], a[136:139], v[220:223], v[108:111]
    v_exp_f32 v74, v74
    v_mfma_f32_16x16x32_bf16 v[108:111], a[168:171], v[212:215], v[108:111]
    v_exp_f32 v75, v75
    v_mfma_f32_16x16x32_bf16 v[108:111], a[200:203], v[244:247], v[108:111]
    v_perm_b32 v236, v73, v72, s35
    v_perm_b32 v237, v75, v74, s35
    v_mfma_f32_16x16x32_bf16 v[108:111], a[232:235], v[252:255], v[108:111]
    v_exp_f32 v76, v76
    v_mfma_f32_16x16x16_bf16 v[204:207], v[88:89], a[90:91], 0
    v_cvt_pk_bf16_f32 v200, v200, v201
    v_cvt_pk_bf16_f32 v202, v202, v203
    v_mfma_f32_16x16x16_bf16 v[204:207], v[90:91], a[90:91], v[204:207]
    v_accvgpr_write_b32 a88, v200
    v_accvgpr_write_b32 a89, v202
    v_mfma_f32_16x16x32_bf16 v[112:115], a[236:239], v[252:255], v[112:115]
    v_exp_f32 v77, v77
    v_mfma_f32_16x16x32_bf16 v[112:115], a[204:207], v[244:247], v[112:115]
    v_exp_f32 v78, v78
    v_mfma_f32_16x16x32_bf16 v[112:115], a[172:175], v[212:215], v[112:115]
    v_exp_f32 v79, v79
    v_mfma_f32_16x16x32_bf16 v[112:115], a[140:143], v[220:223], v[112:115]
    s_waitcnt lgkmcnt(5)
    v_perm_b32 v238, v77, v76, s35
    v_perm_b32 v239, v79, v78, s35
    buffer_load_dwordx4 v21, s[16:19], s26 offen offset:3072 lds
    s_waitcnt vmcnt(8)
    v_mfma_f32_16x16x16_bf16 v[200:203], v[88:89], a[92:93], 0
    v_cvt_pk_bf16_f32 v204, v204, v205
    v_cvt_pk_bf16_f32 v206, v206, v207
    v_mfma_f32_16x16x16_bf16 v[200:203], v[90:91], a[92:93], v[200:203]
    v_accvgpr_write_b32 a90, v204
    v_accvgpr_write_b32 a91, v206
    v_mfma_f32_16x16x16_bf16 v[204:207], v[88:89], a[94:95], 0
    s_nop 4
    v_cvt_pk_bf16_f32 v200, v200, v201
    v_cvt_pk_bf16_f32 v202, v202, v203
    v_mfma_f32_16x16x16_bf16 v[204:207], v[90:91], a[94:95], v[204:207]
    v_accvgpr_write_b32 a92, v200
    v_accvgpr_write_b32 a93, v202
    s_nop 5
    v_cvt_pk_bf16_f32 v204, v204, v205
    v_cvt_pk_bf16_f32 v206, v206, v207
    v_accvgpr_write_b32 a94, v204
    v_accvgpr_write_b32 a95, v206
    v_mfma_f32_16x16x32_bf16 v[64:67], a[64:67], v[32:35], 0
    v_mfma_f32_16x16x32_bf16 v[64:67], a[68:71], v[36:39], v[64:67]
    ds_read_b128 v[220:223], v3 offset:33792
    ds_read_b128 v[212:215], v4 offset:33792
    v_mfma_f32_16x16x32_bf16 v[64:67], a[72:75], v[40:43], v[64:67]
    ds_read_b128 v[244:247], v5 offset:33792
    ds_read_b128 v[252:255], v6 offset:33792
    v_mfma_f32_16x16x32_bf16 v[64:67], a[76:79], v[44:47], v[64:67]
    ds_write_b128 v3, v[236:239] offset:39936
    v_mfma_f32_16x16x32_bf16 v[68:71], a[92:95], v[44:47], 0
    ds_read_b128 v[48:51], v2 offset:4096
    ds_read_b128 v[52:55], v2 offset:4608
    v_mfma_f32_16x16x32_bf16 v[68:71], a[88:91], v[40:43], v[68:71]
    ds_read_b128 v[56:59], v2 offset:6144
    ds_read_b128 v[60:63], v2 offset:6656
    v_mfma_f32_16x16x32_bf16 v[68:71], a[84:87], v[36:39], v[68:71]
    v_exp_f32 v64, v64
    v_mfma_f32_16x16x32_bf16 v[68:71], a[80:83], v[32:35], v[68:71]
    v_exp_f32 v65, v65
    v_smfmac_f32_16x16x64_bf16 v[228:231], v[28:31], v[232:239], v23
    s_waitcnt lgkmcnt(4)
    s_barrier
    v_mfma_f32_16x16x32_bf16 v[116:119], a[136:139], v[216:219], v[116:119]
    v_exp_f32 v66, v66
    v_mfma_f32_16x16x32_bf16 v[116:119], a[168:171], v[208:211], v[116:119]
    v_exp_f32 v67, v67
    v_mfma_f32_16x16x32_bf16 v[116:119], a[200:203], v[240:243], v[116:119]
    v_perm_b32 v232, v65, v64, s35
    v_perm_b32 v233, v67, v66, s35
    v_mfma_f32_16x16x32_bf16 v[116:119], a[232:235], v[248:251], v[116:119]
    v_exp_f32 v68, v68
    v_mfma_f32_16x16x32_bf16 v[120:123], a[236:239], v[248:251], v[120:123]
    v_exp_f32 v69, v69
    v_mfma_f32_16x16x32_bf16 v[120:123], a[204:207], v[240:243], v[120:123]
    v_exp_f32 v70, v70
    v_mfma_f32_16x16x32_bf16 v[120:123], a[172:175], v[208:211], v[120:123]
    v_exp_f32 v71, v71
    v_mfma_f32_16x16x32_bf16 v[120:123], a[140:143], v[216:219], v[120:123]
    s_waitcnt lgkmcnt(0)
    v_perm_b32 v234, v69, v68, s35
    v_perm_b32 v235, v71, v70, s35
    v_mfma_f32_16x16x32_bf16 v[72:75], a[64:67], v[48:51], 0
    s_add_u32 s25, s25, 0x1000
    v_mfma_f32_16x16x32_bf16 v[72:75], a[68:71], v[52:55], v[72:75]
    buffer_load_dwordx4 a[96:99], v10, s[12:15], s25 offen offset:0
    v_mfma_f32_16x16x32_bf16 v[72:75], a[72:75], v[56:59], v[72:75]
    ds_read_b128 v[32:35], v2 offset:8192
    ds_read_b128 v[36:39], v2 offset:8704
    v_mfma_f32_16x16x32_bf16 v[72:75], a[76:79], v[60:63], v[72:75]
    ds_read_b128 v[40:43], v2 offset:10240
    ds_read_b128 v[44:47], v2 offset:10752
    ds_write_b128 v3, v[232:235] offset:32768
    v_mfma_f32_16x16x32_bf16 v[76:79], a[92:95], v[60:63], 0
    ds_read_b128 v[216:219], v3 offset:34816
    ds_read_b128 v[208:211], v4 offset:34816
    v_mfma_f32_16x16x32_bf16 v[76:79], a[88:91], v[56:59], v[76:79]
    ds_read_b128 v[240:243], v5 offset:34816
    ds_read_b128 v[248:251], v6 offset:34816
    v_mfma_f32_16x16x32_bf16 v[76:79], a[84:87], v[52:55], v[76:79]
    v_exp_f32 v72, v72
    v_mfma_f32_16x16x32_bf16 v[76:79], a[80:83], v[48:51], v[76:79]
    v_exp_f32 v73, v73
    v_mfma_f32_16x16x32_bf16 v[124:127], a[136:139], v[220:223], v[124:127]
    v_exp_f32 v74, v74
    v_mfma_f32_16x16x32_bf16 v[124:127], a[168:171], v[212:215], v[124:127]
    v_exp_f32 v75, v75
    v_mfma_f32_16x16x32_bf16 v[124:127], a[200:203], v[244:247], v[124:127]
    v_perm_b32 v236, v73, v72, s35
    v_perm_b32 v237, v75, v74, s35
    v_mfma_f32_16x16x32_bf16 v[124:127], a[232:235], v[252:255], v[124:127]
    v_exp_f32 v76, v76
    v_mfma_f32_16x16x32_bf16 v[128:131], a[236:239], v[252:255], v[128:131]
    v_exp_f32 v77, v77
    v_mfma_f32_16x16x32_bf16 v[128:131], a[204:207], v[244:247], v[128:131]
    v_exp_f32 v78, v78
    v_mfma_f32_16x16x32_bf16 v[128:131], a[172:175], v[212:215], v[128:131]
    v_exp_f32 v79, v79
    v_mfma_f32_16x16x32_bf16 v[128:131], a[140:143], v[220:223], v[128:131]
    s_waitcnt lgkmcnt(5)
    v_perm_b32 v238, v77, v76, s35
    v_perm_b32 v239, v79, v78, s35
    v_mfma_f32_16x16x32_bf16 v[64:67], a[64:67], v[32:35], 0
    buffer_load_dwordx4 a[100:103], v10, s[12:15], s25 offen offset:64
    v_mfma_f32_16x16x32_bf16 v[64:67], a[68:71], v[36:39], v[64:67]
    ds_read_b128 v[220:223], v3 offset:35840
    ds_read_b128 v[212:215], v4 offset:35840
    v_mfma_f32_16x16x32_bf16 v[64:67], a[72:75], v[40:43], v[64:67]
    ds_read_b128 v[244:247], v5 offset:35840
    ds_read_b128 v[252:255], v6 offset:35840
    v_mfma_f32_16x16x32_bf16 v[64:67], a[76:79], v[44:47], v[64:67]
    ds_write_b128 v3, v[236:239] offset:33792
    v_mfma_f32_16x16x32_bf16 v[68:71], a[92:95], v[44:47], 0
    ds_read_b128 v[48:51], v2 offset:12288
    ds_read_b128 v[52:55], v2 offset:12800
    v_mfma_f32_16x16x32_bf16 v[68:71], a[88:91], v[40:43], v[68:71]
L_s2:
    s_cbranch_execz L_cek3
L_s2_n:
    ds_read_b128 v[56:59], v2 offset:14336
    ds_read_b128 v[60:63], v2 offset:14848
    v_mfma_f32_16x16x32_bf16 v[68:71], a[84:87], v[36:39], v[68:71]
    v_exp_f32 v64, v64
    v_mfma_f32_16x16x32_bf16 v[68:71], a[80:83], v[32:35], v[68:71]
    v_exp_f32 v65, v65
    v_smfmac_f32_16x16x64_bf16 v[148:151], v[28:31], v[232:239], v23
    s_waitcnt lgkmcnt(4)
    s_barrier
    v_mfma_f32_16x16x32_bf16 v[132:135], a[136:139], v[216:219], v[132:135]
    v_exp_f32 v66, v66
    v_mfma_f32_16x16x32_bf16 v[132:135], a[168:171], v[208:211], v[132:135]
    v_exp_f32 v67, v67
    v_mfma_f32_16x16x32_bf16 v[132:135], a[200:203], v[240:243], v[132:135]
    v_perm_b32 v232, v65, v64, s35
    v_perm_b32 v233, v67, v66, s35
    v_mfma_f32_16x16x32_bf16 v[132:135], a[232:235], v[248:251], v[132:135]
    v_exp_f32 v68, v68
    v_mfma_f32_16x16x32_bf16 v[136:139], a[236:239], v[248:251], v[136:139]
    v_exp_f32 v69, v69
    v_mfma_f32_16x16x32_bf16 v[136:139], a[204:207], v[240:243], v[136:139]
    v_exp_f32 v70, v70
    v_mfma_f32_16x16x32_bf16 v[136:139], a[172:175], v[208:211], v[136:139]
    v_exp_f32 v71, v71
    v_mfma_f32_16x16x32_bf16 v[136:139], a[140:143], v[216:219], v[136:139]
    s_waitcnt lgkmcnt(0)
    v_perm_b32 v234, v69, v68, s35
    v_perm_b32 v235, v71, v70, s35
    buffer_load_dwordx4 a[104:107], v10, s[12:15], s25 offen offset:128
    v_mfma_f32_16x16x32_bf16 v[72:75], a[64:67], v[48:51], 0
    buffer_load_dwordx4 a[108:111], v10, s[12:15], s25 offen offset:192
    v_mfma_f32_16x16x32_bf16 v[72:75], a[68:71], v[52:55], v[72:75]
    ds_read_b128 v[32:35], v2 offset:32768
    ds_read_b128 v[36:39], v2 offset:33280
    v_mfma_f32_16x16x32_bf16 v[72:75], a[72:75], v[56:59], v[72:75]
    ds_read_b128 v[40:43], v2 offset:34816
    ds_read_b128 v[44:47], v2 offset:35328
    v_mfma_f32_16x16x32_bf16 v[72:75], a[76:79], v[60:63], v[72:75]
    ds_write_b128 v3, v[232:235] offset:34816
    v_mfma_f32_16x16x32_bf16 v[76:79], a[92:95], v[60:63], 0
    ds_read_b128 v[216:219], v3 offset:36864
    ds_read_b128 v[208:211], v4 offset:36864
    v_mfma_f32_16x16x32_bf16 v[76:79], a[88:91], v[56:59], v[76:79]
    ds_read_b128 v[240:243], v5 offset:36864
    ds_read_b128 v[248:251], v6 offset:36864
    v_mfma_f32_16x16x32_bf16 v[76:79], a[84:87], v[52:55], v[76:79]
    v_exp_f32 v72, v72
    v_mfma_f32_16x16x32_bf16 v[76:79], a[80:83], v[48:51], v[76:79]
    v_exp_f32 v73, v73
    v_mfma_f32_16x16x32_bf16 v[140:143], a[136:139], v[220:223], v[140:143]
    v_exp_f32 v74, v74
    v_mfma_f32_16x16x32_bf16 v[140:143], a[168:171], v[212:215], v[140:143]
    v_exp_f32 v75, v75
    v_mfma_f32_16x16x32_bf16 v[140:143], a[200:203], v[244:247], v[140:143]
    v_perm_b32 v236, v73, v72, s35
    v_perm_b32 v237, v75, v74, s35
    v_mfma_f32_16x16x32_bf16 v[140:143], a[232:235], v[252:255], v[140:143]
    v_exp_f32 v76, v76
    v_mfma_f32_16x16x32_bf16 v[144:147], a[236:239], v[252:255], v[144:147]
    v_exp_f32 v77, v77
    v_mfma_f32_16x16x32_bf16 v[144:147], a[204:207], v[244:247], v[144:147]
    v_exp_f32 v78, v78
    v_mfma_f32_16x16x32_bf16 v[144:147], a[172:175], v[212:215], v[144:147]
    v_exp_f32 v79, v79
    v_mfma_f32_16x16x32_bf16 v[144:147], a[140:143], v[220:223], v[144:147]
    s_waitcnt lgkmcnt(5)
    v_perm_b32 v238, v77, v76, s35
    v_perm_b32 v239, v79, v78, s35
    v_mfma_f32_16x16x32_bf16 v[64:67], a[64:67], v[32:35], 0
    s_add_u32 s25, s25, 0x1000
    v_mfma_f32_16x16x32_bf16 v[64:67], a[68:71], v[36:39], v[64:67]
    buffer_load_dwordx4 a[112:115], v10, s[12:15], s25 offen offset:0
    v_mfma_f32_16x16x32_bf16 v[64:67], a[72:75], v[40:43], v[64:67]
    ds_read_b128 v[220:223], v3 offset:37888
    ds_read_b128 v[212:215], v4 offset:37888
    v_mfma_f32_16x16x32_bf16 v[64:67], a[76:79], v[44:47], v[64:67]
    ds_read_b128 v[244:247], v5 offset:37888
    ds_read_b128 v[252:255], v6 offset:37888
    ds_write_b128 v3, v[236:239] offset:35840
    v_mfma_f32_16x16x32_bf16 v[68:71], a[92:95], v[44:47], 0
    ds_read_b128 v[48:51], v2 offset:36864
    ds_read_b128 v[52:55], v2 offset:37376
    v_mfma_f32_16x16x32_bf16 v[68:71], a[88:91], v[40:43], v[68:71]
    ds_read_b128 v[56:59], v2 offset:38912
    ds_read_b128 v[60:63], v2 offset:39424
    v_mfma_f32_16x16x32_bf16 v[68:71], a[84:87], v[36:39], v[68:71]
    v_exp_f32 v64, v64
    v_mfma_f32_16x16x32_bf16 v[68:71], a[80:83], v[32:35], v[68:71]
    v_exp_f32 v65, v65
    v_smfmac_f32_16x16x64_bf16 v[152:155], v[28:31], v[232:239], v23
    s_waitcnt lgkmcnt(4)
    s_barrier
    v_mfma_f32_16x16x32_bf16 v[164:167], a[136:139], v[216:219], v[164:167]
    v_exp_f32 v66, v66
    v_mfma_f32_16x16x32_bf16 v[164:167], a[168:171], v[208:211], v[164:167]
    v_exp_f32 v67, v67
    v_mfma_f32_16x16x32_bf16 v[164:167], a[200:203], v[240:243], v[164:167]
    v_perm_b32 v232, v65, v64, s35
    v_perm_b32 v233, v67, v66, s35
    v_mfma_f32_16x16x32_bf16 v[164:167], a[232:235], v[248:251], v[164:167]
    v_exp_f32 v68, v68
    v_mfma_f32_16x16x32_bf16 v[168:171], a[236:239], v[248:251], v[168:171]
    v_exp_f32 v69, v69
    v_mfma_f32_16x16x32_bf16 v[168:171], a[204:207], v[240:243], v[168:171]
    v_exp_f32 v70, v70
    v_mfma_f32_16x16x32_bf16 v[168:171], a[172:175], v[208:211], v[168:171]
    v_exp_f32 v71, v71
    v_mfma_f32_16x16x32_bf16 v[168:171], a[140:143], v[216:219], v[168:171]
    s_waitcnt lgkmcnt(0)
    v_perm_b32 v234, v69, v68, s35
    v_perm_b32 v235, v71, v70, s35
    v_mfma_f32_16x16x32_bf16 v[72:75], a[64:67], v[48:51], 0
    buffer_load_dwordx4 a[116:119], v10, s[12:15], s25 offen offset:64
    v_mfma_f32_16x16x32_bf16 v[72:75], a[68:71], v[52:55], v[72:75]
    ds_read_b128 v[32:35], v2 offset:40960
    ds_read_b128 v[36:39], v2 offset:41472
    v_mfma_f32_16x16x32_bf16 v[72:75], a[72:75], v[56:59], v[72:75]
    ds_read_b128 v[40:43], v2 offset:43008
    ds_read_b128 v[44:47], v2 offset:43520
    v_mfma_f32_16x16x32_bf16 v[72:75], a[76:79], v[60:63], v[72:75]
    ds_write_b128 v3, v[232:235] offset:36864
    v_mfma_f32_16x16x32_bf16 v[76:79], a[92:95], v[60:63], 0
    ds_read_b128 v[216:219], v3 offset:38912
    ds_read_b128 v[208:211], v4 offset:38912
    v_mfma_f32_16x16x32_bf16 v[76:79], a[88:91], v[56:59], v[76:79]
    ds_read_b128 v[240:243], v5 offset:38912
    ds_read_b128 v[248:251], v6 offset:38912
    v_mfma_f32_16x16x32_bf16 v[76:79], a[84:87], v[52:55], v[76:79]
    v_exp_f32 v72, v72
    v_mfma_f32_16x16x32_bf16 v[76:79], a[80:83], v[48:51], v[76:79]
    v_exp_f32 v73, v73
    v_mfma_f32_16x16x32_bf16 v[172:175], a[136:139], v[220:223], v[172:175]
    v_exp_f32 v74, v74
    v_mfma_f32_16x16x32_bf16 v[172:175], a[168:171], v[212:215], v[172:175]
    v_exp_f32 v75, v75
    v_mfma_f32_16x16x32_bf16 v[172:175], a[200:203], v[244:247], v[172:175]
    v_perm_b32 v236, v73, v72, s35
    v_perm_b32 v237, v75, v74, s35
    v_mfma_f32_16x16x32_bf16 v[172:175], a[232:235], v[252:255], v[172:175]
    v_exp_f32 v76, v76
    v_mfma_f32_16x16x32_bf16 v[176:179], a[236:239], v[252:255], v[176:179]
    v_exp_f32 v77, v77
    v_mfma_f32_16x16x32_bf16 v[176:179], a[204:207], v[244:247], v[176:179]
    v_exp_f32 v78, v78
    v_mfma_f32_16x16x32_bf16 v[176:179], a[172:175], v[212:215], v[176:179]
    v_exp_f32 v79, v79
    v_mfma_f32_16x16x32_bf16 v[176:179], a[140:143], v[220:223], v[176:179]
    s_waitcnt lgkmcnt(5)
    v_perm_b32 v238, v77, v76, s35
    v_perm_b32 v239, v79, v78, s35
    v_mfma_f32_16x16x32_bf16 v[64:67], a[64:67], v[32:35], 0
    buffer_load_dwordx4 a[120:123], v10, s[12:15], s25 offen offset:128
    v_mfma_f32_16x16x32_bf16 v[64:67], a[68:71], v[36:39], v[64:67]
    ds_read_b128 v[220:223], v3 offset:39936
    ds_read_b128 v[212:215], v4 offset:39936
    v_mfma_f32_16x16x32_bf16 v[64:67], a[72:75], v[40:43], v[64:67]
    ds_read_b128 v[244:247], v5 offset:39936
    ds_read_b128 v[252:255], v6 offset:39936
    v_mfma_f32_16x16x32_bf16 v[64:67], a[76:79], v[44:47], v[64:67]
    ds_write_b128 v3, v[236:239] offset:37888
    v_mfma_f32_16x16x32_bf16 v[68:71], a[92:95], v[44:47], 0
    ds_read_b128 v[48:51], v2 offset:45056
    ds_read_b128 v[52:55], v2 offset:45568
    v_mfma_f32_16x16x32_bf16 v[68:71], a[88:91], v[40:43], v[68:71]
    ds_read_b128 v[56:59], v2 offset:47104
    ds_read_b128 v[60:63], v2 offset:47616
    v_mfma_f32_16x16x32_bf16 v[68:71], a[84:87], v[36:39], v[68:71]
    v_exp_f32 v64, v64
    v_mfma_f32_16x16x32_bf16 v[68:71], a[80:83], v[32:35], v[68:71]
    v_exp_f32 v65, v65
    v_smfmac_f32_16x16x64_bf16 v[156:159], v[28:31], v[232:239], v23
    s_waitcnt lgkmcnt(9)
    buffer_load_dwordx4 a[124:127], v10, s[12:15], s25 offen offset:192
    s_waitcnt vmcnt(8) lgkmcnt(4)
    s_barrier
    ds_read_b64_tr_b16 a[144:145], v13 offset:0
    ds_read_b64_tr_b16 a[146:147], v13 offset:4096
    ds_read_b64_tr_b16 a[148:149], v13 offset:8
    v_mfma_f32_16x16x32_bf16 v[180:183], a[136:139], v[216:219], v[180:183]
    v_exp_f32 v66, v66
    v_mfma_f32_16x16x32_bf16 v[180:183], a[168:171], v[208:211], v[180:183]
    v_exp_f32 v67, v67
    v_mfma_f32_16x16x32_bf16 v[180:183], a[200:203], v[240:243], v[180:183]
    v_perm_b32 v232, v65, v64, s35
    v_perm_b32 v233, v67, v66, s35
    v_mfma_f32_16x16x32_bf16 v[180:183], a[232:235], v[248:251], v[180:183]
    ds_read_b64_tr_b16 a[150:151], v13 offset:4104
    ds_read_b64_tr_b16 a[176:177], v14 offset:0
    ds_read_b64_tr_b16 a[178:179], v14 offset:4096
    v_exp_f32 v68, v68
    v_mfma_f32_16x16x32_bf16 v[184:187], a[236:239], v[248:251], v[184:187]
    v_exp_f32 v69, v69
    v_mfma_f32_16x16x32_bf16 v[184:187], a[204:207], v[240:243], v[184:187]
    v_exp_f32 v70, v70
    v_mfma_f32_16x16x32_bf16 v[184:187], a[172:175], v[208:211], v[184:187]
    v_exp_f32 v71, v71
    v_mfma_f32_16x16x32_bf16 v[184:187], a[140:143], v[216:219], v[184:187]
    s_waitcnt lgkmcnt(6)
    ds_read_b64_tr_b16 a[180:181], v14 offset:8
    ds_read_b64_tr_b16 a[182:183], v14 offset:4104
    v_perm_b32 v234, v69, v68, s35
    v_perm_b32 v235, v71, v70, s35
    v_mfma_f32_16x16x32_bf16 v[72:75], a[64:67], v[48:51], 0
    ds_read_b64_tr_b16 a[208:209], v15 offset:0
    ds_read_b64_tr_b16 a[210:211], v15 offset:4096
    v_mfma_f32_16x16x32_bf16 v[72:75], a[68:71], v[52:55], v[72:75]
    ds_read_b64_tr_b16 a[212:213], v15 offset:8
    ds_read_b128 v[32:35], v2 offset:49152
    v_mfma_f32_16x16x32_bf16 v[72:75], a[72:75], v[56:59], v[72:75]
    ds_read_b128 v[36:39], v2 offset:49664
    ds_read_b128 v[40:43], v2 offset:51200
    v_mfma_f32_16x16x32_bf16 v[72:75], a[76:79], v[60:63], v[72:75]
    ds_read_b128 v[44:47], v2 offset:51712
    ds_write_b128 v3, v[232:235] offset:38912
    v_mfma_f32_16x16x32_bf16 v[76:79], a[92:95], v[60:63], 0
    ds_read_b128 v[216:219], v3 offset:32768
    ds_read_b128 v[208:211], v4 offset:32768
    v_mfma_f32_16x16x32_bf16 v[76:79], a[88:91], v[56:59], v[76:79]
    ds_read_b128 v[240:243], v5 offset:32768
    ds_read_b128 v[248:251], v6 offset:32768
    v_mfma_f32_16x16x32_bf16 v[76:79], a[84:87], v[52:55], v[76:79]
    v_exp_f32 v72, v72
    v_mfma_f32_16x16x32_bf16 v[76:79], a[80:83], v[48:51], v[76:79]
    ds_read_b64_tr_b16 a[214:215], v15 offset:4104
    ds_read_b64_tr_b16 a[240:241], v16 offset:0
    ds_read_b64_tr_b16 a[242:243], v16 offset:4096
    v_exp_f32 v73, v73
    s_add_u32 m0, s27, 131072
    s_add_u32 s26, s26, 0x1000
    buffer_load_dwordx4 v21, s[16:19], s26 offen offset:0 lds
    s_waitcnt vmcnt(8)
    v_mfma_f32_16x16x16_bf16 v[200:203], v[88:89], a[96:97], 0
    v_mfma_f32_16x16x16_bf16 v[200:203], v[90:91], a[96:97], v[200:203]
    v_mfma_f32_16x16x32_bf16 v[188:191], a[136:139], v[220:223], v[188:191]
    v_exp_f32 v74, v74
    v_mfma_f32_16x16x32_bf16 v[188:191], a[168:171], v[212:215], v[188:191]
    v_exp_f32 v75, v75
    v_mfma_f32_16x16x32_bf16 v[188:191], a[200:203], v[244:247], v[188:191]
    v_perm_b32 v236, v73, v72, s35
    v_perm_b32 v237, v75, v74, s35
    v_mfma_f32_16x16x32_bf16 v[188:191], a[232:235], v[252:255], v[188:191]
    ds_read_b64_tr_b16 a[244:245], v16 offset:8
    ds_read_b64_tr_b16 a[246:247], v16 offset:4104
    v_exp_f32 v76, v76
    v_mfma_f32_16x16x16_bf16 v[204:207], v[88:89], a[98:99], 0
    v_cvt_pk_bf16_f32 v200, v200, v201
    v_cvt_pk_bf16_f32 v202, v202, v203
    v_mfma_f32_16x16x16_bf16 v[204:207], v[90:91], a[98:99], v[204:207]
    v_accvgpr_write_b32 a96, v200
    v_accvgpr_write_b32 a97, v202
    v_mfma_f32_16x16x32_bf16 v[192:195], a[236:239], v[252:255], v[192:195]
    v_exp_f32 v77, v77
    v_mfma_f32_16x16x32_bf16 v[192:195], a[204:207], v[244:247], v[192:195]
    v_exp_f32 v78, v78
    v_mfma_f32_16x16x32_bf16 v[192:195], a[172:175], v[212:215], v[192:195]
    v_exp_f32 v79, v79
    v_mfma_f32_16x16x32_bf16 v[192:195], a[140:143], v[220:223], v[192:195]
    s_waitcnt lgkmcnt(10)
    v_perm_b32 v238, v77, v76, s35
    v_perm_b32 v239, v79, v78, s35
    buffer_load_dwordx4 v21, s[16:19], s26 offen offset:1024 lds
    s_waitcnt vmcnt(8)
    v_mfma_f32_16x16x16_bf16 v[200:203], v[88:89], a[100:101], 0
    v_cvt_pk_bf16_f32 v204, v204, v205
    v_cvt_pk_bf16_f32 v206, v206, v207
    v_mfma_f32_16x16x16_bf16 v[200:203], v[90:91], a[100:101], v[200:203]
    v_accvgpr_write_b32 a98, v204
    v_accvgpr_write_b32 a99, v206
    v_mfma_f32_16x16x32_bf16 v[64:67], a[64:67], v[32:35], 0
    v_mfma_f32_16x16x32_bf16 v[64:67], a[68:71], v[36:39], v[64:67]
    ds_read_b128 v[220:223], v3 offset:33792
    ds_read_b128 v[212:215], v4 offset:33792
    v_mfma_f32_16x16x32_bf16 v[64:67], a[72:75], v[40:43], v[64:67]
    ds_read_b128 v[244:247], v5 offset:33792
    ds_read_b128 v[252:255], v6 offset:33792
    v_mfma_f32_16x16x32_bf16 v[64:67], a[76:79], v[44:47], v[64:67]
    ds_write_b128 v3, v[236:239] offset:39936
    v_mfma_f32_16x16x16_bf16 v[204:207], v[88:89], a[102:103], 0
    v_cvt_pk_bf16_f32 v200, v200, v201
    v_cvt_pk_bf16_f32 v202, v202, v203
    v_mfma_f32_16x16x16_bf16 v[204:207], v[90:91], a[102:103], v[204:207]
    v_accvgpr_write_b32 a100, v200
    v_accvgpr_write_b32 a101, v202
    v_mfma_f32_16x16x32_bf16 v[68:71], a[92:95], v[44:47], 0
    ds_read_b128 v[48:51], v2 offset:53248
    ds_read_b128 v[52:55], v2 offset:53760
    v_mfma_f32_16x16x32_bf16 v[68:71], a[88:91], v[40:43], v[68:71]
    ds_read_b128 v[56:59], v2 offset:55296
    ds_read_b128 v[60:63], v2 offset:55808
    v_mfma_f32_16x16x32_bf16 v[68:71], a[84:87], v[36:39], v[68:71]
    v_exp_f32 v64, v64
    v_mfma_f32_16x16x32_bf16 v[68:71], a[80:83], v[32:35], v[68:71]
    v_exp_f32 v65, v65
    v_smfmac_f32_16x16x64_bf16 v[160:163], v[28:31], v[232:239], v23
    s_waitcnt lgkmcnt(4)
    s_barrier
    buffer_load_dwordx4 v21, s[16:19], s26 offen offset:2048 lds
    s_waitcnt vmcnt(8)
    v_mfma_f32_16x16x16_bf16 v[200:203], v[88:89], a[104:105], 0
    v_cvt_pk_bf16_f32 v204, v204, v205
    v_cvt_pk_bf16_f32 v206, v206, v207
    v_mfma_f32_16x16x16_bf16 v[200:203], v[90:91], a[104:105], v[200:203]
    v_accvgpr_write_b32 a102, v204
    v_accvgpr_write_b32 a103, v206
    v_mfma_f32_16x16x32_bf16 v[80:83], a[144:147], v[216:219], v[80:83]
    v_exp_f32 v66, v66
    v_mfma_f32_16x16x32_bf16 v[80:83], a[176:179], v[208:211], v[80:83]
    v_exp_f32 v67, v67
    v_mfma_f32_16x16x32_bf16 v[80:83], a[208:211], v[240:243], v[80:83]
    v_perm_b32 v232, v65, v64, s35
    v_perm_b32 v233, v67, v66, s35
    v_mfma_f32_16x16x32_bf16 v[80:83], a[240:243], v[248:251], v[80:83]
    v_exp_f32 v68, v68
    v_mfma_f32_16x16x32_bf16 v[84:87], a[244:247], v[248:251], v[84:87]
    v_exp_f32 v69, v69
    v_mfma_f32_16x16x32_bf16 v[84:87], a[212:215], v[240:243], v[84:87]
    v_exp_f32 v70, v70
    v_mfma_f32_16x16x32_bf16 v[84:87], a[180:183], v[208:211], v[84:87]
    v_exp_f32 v71, v71
    v_mfma_f32_16x16x32_bf16 v[84:87], a[148:151], v[216:219], v[84:87]
    s_waitcnt lgkmcnt(0)
    v_perm_b32 v234, v69, v68, s35
    v_perm_b32 v235, v71, v70, s35
    v_mfma_f32_16x16x16_bf16 v[204:207], v[88:89], a[106:107], 0
    v_cvt_pk_bf16_f32 v200, v200, v201
    v_cvt_pk_bf16_f32 v202, v202, v203
    v_mfma_f32_16x16x16_bf16 v[204:207], v[90:91], a[106:107], v[204:207]
    v_accvgpr_write_b32 a104, v200
    v_accvgpr_write_b32 a105, v202
    v_mfma_f32_16x16x32_bf16 v[72:75], a[64:67], v[48:51], 0
    buffer_load_dwordx4 v21, s[16:19], s26 offen offset:3072 lds
    v_mfma_f32_16x16x32_bf16 v[72:75], a[68:71], v[52:55], v[72:75]
    ds_read_b128 v[32:35], v2 offset:57344
    ds_read_b128 v[36:39], v2 offset:57856
    v_mfma_f32_16x16x32_bf16 v[72:75], a[72:75], v[56:59], v[72:75]
    ds_read_b128 v[40:43], v2 offset:59392
    ds_read_b128 v[44:47], v2 offset:59904
    v_mfma_f32_16x16x32_bf16 v[72:75], a[76:79], v[60:63], v[72:75]
    ds_write_b128 v3, v[232:235] offset:32768
    v_mfma_f32_16x16x32_bf16 v[76:79], a[92:95], v[60:63], 0
    ds_read_b128 v[216:219], v3 offset:34816
    ds_read_b128 v[208:211], v4 offset:34816
    v_mfma_f32_16x16x32_bf16 v[76:79], a[88:91], v[56:59], v[76:79]
    ds_read_b128 v[240:243], v5 offset:34816
    ds_read_b128 v[248:251], v6 offset:34816
    v_mfma_f32_16x16x32_bf16 v[76:79], a[84:87], v[52:55], v[76:79]
    v_exp_f32 v72, v72
    v_mfma_f32_16x16x32_bf16 v[76:79], a[80:83], v[48:51], v[76:79]
    v_exp_f32 v73, v73
    s_waitcnt vmcnt(8)
    v_mfma_f32_16x16x16_bf16 v[200:203], v[88:89], a[108:109], 0
    v_cvt_pk_bf16_f32 v204, v204, v205
    v_cvt_pk_bf16_f32 v206, v206, v207
    v_mfma_f32_16x16x16_bf16 v[200:203], v[90:91], a[108:109], v[200:203]
    v_accvgpr_write_b32 a106, v204
    v_accvgpr_write_b32 a107, v206
    v_mfma_f32_16x16x32_bf16 v[92:95], a[144:147], v[220:223], v[92:95]
    v_exp_f32 v74, v74
    v_mfma_f32_16x16x32_bf16 v[92:95], a[176:179], v[212:215], v[92:95]
    v_exp_f32 v75, v75
    v_mfma_f32_16x16x32_bf16 v[92:95], a[208:211], v[244:247], v[92:95]
    v_perm_b32 v236, v73, v72, s35
    v_perm_b32 v237, v75, v74, s35
    v_mfma_f32_16x16x32_bf16 v[92:95], a[240:243], v[252:255], v[92:95]
    v_exp_f32 v76, v76
    v_mfma_f32_16x16x16_bf16 v[204:207], v[88:89], a[110:111], 0
    v_cvt_pk_bf16_f32 v200, v200, v201
    v_cvt_pk_bf16_f32 v202, v202, v203
    v_mfma_f32_16x16x16_bf16 v[204:207], v[90:91], a[110:111], v[204:207]
    v_accvgpr_write_b32 a108, v200
    v_accvgpr_write_b32 a109, v202
    v_mfma_f32_16x16x32_bf16 v[96:99], a[244:247], v[252:255], v[96:99]
    v_exp_f32 v77, v77
    v_mfma_f32_16x16x32_bf16 v[96:99], a[212:215], v[244:247], v[96:99]
    v_exp_f32 v78, v78
    v_mfma_f32_16x16x32_bf16 v[96:99], a[180:183], v[212:215], v[96:99]
    v_exp_f32 v79, v79
    v_mfma_f32_16x16x32_bf16 v[96:99], a[148:151], v[220:223], v[96:99]
    s_waitcnt lgkmcnt(5)
    v_perm_b32 v238, v77, v76, s35
    v_perm_b32 v239, v79, v78, s35
    s_add_u32 m0, s27, 135168
    s_add_u32 s26, s26, 0x1000
    buffer_load_dwordx4 v21, s[16:19], s26 offen offset:0 lds
    s_waitcnt vmcnt(8)
    v_mfma_f32_16x16x16_bf16 v[200:203], v[88:89], a[112:113], 0
    v_cvt_pk_bf16_f32 v204, v204, v205
    v_cvt_pk_bf16_f32 v206, v206, v207
    v_mfma_f32_16x16x16_bf16 v[200:203], v[90:91], a[112:113], v[200:203]
    v_accvgpr_write_b32 a110, v204
    v_accvgpr_write_b32 a111, v206
    v_mfma_f32_16x16x32_bf16 v[64:67], a[64:67], v[32:35], 0
    v_mfma_f32_16x16x32_bf16 v[64:67], a[68:71], v[36:39], v[64:67]
    ds_read_b128 v[220:223], v3 offset:35840
    ds_read_b128 v[212:215], v4 offset:35840
    v_mfma_f32_16x16x32_bf16 v[64:67], a[72:75], v[40:43], v[64:67]
    ds_read_b128 v[244:247], v5 offset:35840
    ds_read_b128 v[252:255], v6 offset:35840
    v_mfma_f32_16x16x32_bf16 v[64:67], a[76:79], v[44:47], v[64:67]
    ds_write_b128 v3, v[236:239] offset:33792
    v_mfma_f32_16x16x16_bf16 v[204:207], v[88:89], a[114:115], 0
    v_cvt_pk_bf16_f32 v200, v200, v201
    v_cvt_pk_bf16_f32 v202, v202, v203
    v_mfma_f32_16x16x16_bf16 v[204:207], v[90:91], a[114:115], v[204:207]
    v_accvgpr_write_b32 a112, v200
    v_accvgpr_write_b32 a113, v202
    v_mfma_f32_16x16x32_bf16 v[68:71], a[92:95], v[44:47], 0
    ds_read_b128 v[48:51], v2 offset:61440
    ds_read_b128 v[52:55], v2 offset:61952
    v_mfma_f32_16x16x32_bf16 v[68:71], a[88:91], v[40:43], v[68:71]
    ds_read_b128 v[56:59], v2 offset:63488
    ds_read_b128 v[60:63], v2 offset:64000
    v_mfma_f32_16x16x32_bf16 v[68:71], a[84:87], v[36:39], v[68:71]
    v_exp_f32 v64, v64
    v_mfma_f32_16x16x32_bf16 v[68:71], a[80:83], v[32:35], v[68:71]
    v_exp_f32 v65, v65
    v_smfmac_f32_16x16x64_bf16 v[224:227], v[28:31], v[232:239], v23
    s_waitcnt lgkmcnt(4)
    s_barrier
    buffer_load_dwordx4 v21, s[16:19], s26 offen offset:1024 lds
    s_waitcnt vmcnt(8)
    v_mfma_f32_16x16x16_bf16 v[200:203], v[88:89], a[116:117], 0
    v_cvt_pk_bf16_f32 v204, v204, v205
    v_cvt_pk_bf16_f32 v206, v206, v207
    v_mfma_f32_16x16x16_bf16 v[200:203], v[90:91], a[116:117], v[200:203]
    v_accvgpr_write_b32 a114, v204
    v_accvgpr_write_b32 a115, v206
    v_mfma_f32_16x16x32_bf16 v[100:103], a[144:147], v[216:219], v[100:103]
    v_exp_f32 v66, v66
    v_mfma_f32_16x16x32_bf16 v[100:103], a[176:179], v[208:211], v[100:103]
    v_exp_f32 v67, v67
    v_mfma_f32_16x16x32_bf16 v[100:103], a[208:211], v[240:243], v[100:103]
    v_perm_b32 v232, v65, v64, s35
    v_perm_b32 v233, v67, v66, s35
    v_mfma_f32_16x16x32_bf16 v[100:103], a[240:243], v[248:251], v[100:103]
    v_exp_f32 v68, v68
    v_mfma_f32_16x16x32_bf16 v[104:107], a[244:247], v[248:251], v[104:107]
    v_exp_f32 v69, v69
    v_mfma_f32_16x16x32_bf16 v[104:107], a[212:215], v[240:243], v[104:107]
    v_exp_f32 v70, v70
    v_mfma_f32_16x16x32_bf16 v[104:107], a[180:183], v[208:211], v[104:107]
    v_exp_f32 v71, v71
    v_mfma_f32_16x16x32_bf16 v[104:107], a[148:151], v[216:219], v[104:107]
    s_waitcnt lgkmcnt(0)
    v_perm_b32 v234, v69, v68, s35
    v_perm_b32 v235, v71, v70, s35
    v_mfma_f32_16x16x16_bf16 v[204:207], v[88:89], a[118:119], 0
    v_cvt_pk_bf16_f32 v200, v200, v201
    v_cvt_pk_bf16_f32 v202, v202, v203
    v_mfma_f32_16x16x16_bf16 v[204:207], v[90:91], a[118:119], v[204:207]
    v_accvgpr_write_b32 a116, v200
    v_accvgpr_write_b32 a117, v202
    v_mfma_f32_16x16x32_bf16 v[72:75], a[64:67], v[48:51], 0
    buffer_load_dwordx4 v21, s[16:19], s26 offen offset:2048 lds
    v_mfma_f32_16x16x32_bf16 v[72:75], a[68:71], v[52:55], v[72:75]
    ds_read_b128 v[32:35], v2 offset:0
    ds_read_b128 v[36:39], v2 offset:512
    v_mfma_f32_16x16x32_bf16 v[72:75], a[72:75], v[56:59], v[72:75]
    ds_read_b128 v[40:43], v2 offset:2048
    ds_read_b128 v[44:47], v2 offset:2560
    v_mfma_f32_16x16x32_bf16 v[72:75], a[76:79], v[60:63], v[72:75]
    ds_write_b128 v3, v[232:235] offset:34816
    v_mfma_f32_16x16x32_bf16 v[76:79], a[92:95], v[60:63], 0
    ds_read_b128 v[216:219], v3 offset:36864
    ds_read_b128 v[208:211], v4 offset:36864
    v_mfma_f32_16x16x32_bf16 v[76:79], a[88:91], v[56:59], v[76:79]
    ds_read_b128 v[240:243], v5 offset:36864
    ds_read_b128 v[248:251], v6 offset:36864
    v_mfma_f32_16x16x32_bf16 v[76:79], a[84:87], v[52:55], v[76:79]
    v_exp_f32 v72, v72
    v_mfma_f32_16x16x32_bf16 v[76:79], a[80:83], v[48:51], v[76:79]
    v_exp_f32 v73, v73
    s_waitcnt vmcnt(8)
    v_mfma_f32_16x16x16_bf16 v[200:203], v[88:89], a[120:121], 0
    v_cvt_pk_bf16_f32 v204, v204, v205
    v_cvt_pk_bf16_f32 v206, v206, v207
    v_mfma_f32_16x16x16_bf16 v[200:203], v[90:91], a[120:121], v[200:203]
    v_accvgpr_write_b32 a118, v204
    v_accvgpr_write_b32 a119, v206
    v_mfma_f32_16x16x32_bf16 v[108:111], a[144:147], v[220:223], v[108:111]
    v_exp_f32 v74, v74
    v_mfma_f32_16x16x32_bf16 v[108:111], a[176:179], v[212:215], v[108:111]
    v_exp_f32 v75, v75
    v_mfma_f32_16x16x32_bf16 v[108:111], a[208:211], v[244:247], v[108:111]
    v_perm_b32 v236, v73, v72, s35
    v_perm_b32 v237, v75, v74, s35
    v_mfma_f32_16x16x32_bf16 v[108:111], a[240:243], v[252:255], v[108:111]
    v_exp_f32 v76, v76
    v_mfma_f32_16x16x16_bf16 v[204:207], v[88:89], a[122:123], 0
    v_cvt_pk_bf16_f32 v200, v200, v201
    v_cvt_pk_bf16_f32 v202, v202, v203
    v_mfma_f32_16x16x16_bf16 v[204:207], v[90:91], a[122:123], v[204:207]
    v_accvgpr_write_b32 a120, v200
    v_accvgpr_write_b32 a121, v202
    v_mfma_f32_16x16x32_bf16 v[112:115], a[244:247], v[252:255], v[112:115]
    v_exp_f32 v77, v77
    v_mfma_f32_16x16x32_bf16 v[112:115], a[212:215], v[244:247], v[112:115]
    v_exp_f32 v78, v78
    v_mfma_f32_16x16x32_bf16 v[112:115], a[180:183], v[212:215], v[112:115]
    v_exp_f32 v79, v79
    v_mfma_f32_16x16x32_bf16 v[112:115], a[148:151], v[220:223], v[112:115]
    s_waitcnt lgkmcnt(5)
    v_perm_b32 v238, v77, v76, s35
    v_perm_b32 v239, v79, v78, s35
    buffer_load_dwordx4 v21, s[16:19], s26 offen offset:3072 lds
    s_waitcnt vmcnt(8)
    v_mfma_f32_16x16x16_bf16 v[200:203], v[88:89], a[124:125], 0
    v_cvt_pk_bf16_f32 v204, v204, v205
    v_cvt_pk_bf16_f32 v206, v206, v207
    v_mfma_f32_16x16x16_bf16 v[200:203], v[90:91], a[124:125], v[200:203]
    v_accvgpr_write_b32 a122, v204
    v_accvgpr_write_b32 a123, v206
    v_mfma_f32_16x16x16_bf16 v[204:207], v[88:89], a[126:127], 0
    s_nop 4
    v_cvt_pk_bf16_f32 v200, v200, v201
    v_cvt_pk_bf16_f32 v202, v202, v203
    v_mfma_f32_16x16x16_bf16 v[204:207], v[90:91], a[126:127], v[204:207]
    v_accvgpr_write_b32 a124, v200
    v_accvgpr_write_b32 a125, v202
    s_nop 5
    v_cvt_pk_bf16_f32 v204, v204, v205
    v_cvt_pk_bf16_f32 v206, v206, v207
    v_accvgpr_write_b32 a126, v204
    v_accvgpr_write_b32 a127, v206
    v_mfma_f32_16x16x32_bf16 v[64:67], a[96:99], v[32:35], 0
    v_mfma_f32_16x16x32_bf16 v[64:67], a[100:103], v[36:39], v[64:67]
    ds_read_b128 v[220:223], v3 offset:37888
    ds_read_b128 v[212:215], v4 offset:37888
    v_mfma_f32_16x16x32_bf16 v[64:67], a[104:107], v[40:43], v[64:67]
    ds_read_b128 v[244:247], v5 offset:37888
    ds_read_b128 v[252:255], v6 offset:37888
    v_mfma_f32_16x16x32_bf16 v[64:67], a[108:111], v[44:47], v[64:67]
    ds_write_b128 v3, v[236:239] offset:35840
    v_mfma_f32_16x16x32_bf16 v[68:71], a[124:127], v[44:47], 0
    ds_read_b128 v[48:51], v2 offset:4096
    ds_read_b128 v[52:55], v2 offset:4608
    v_mfma_f32_16x16x32_bf16 v[68:71], a[120:123], v[40:43], v[68:71]
    ds_read_b128 v[56:59], v2 offset:6144
    ds_read_b128 v[60:63], v2 offset:6656
    v_mfma_f32_16x16x32_bf16 v[68:71], a[116:119], v[36:39], v[68:71]
    v_exp_f32 v64, v64
    v_mfma_f32_16x16x32_bf16 v[68:71], a[112:115], v[32:35], v[68:71]
    v_exp_f32 v65, v65
    v_smfmac_f32_16x16x64_bf16 v[228:231], v[28:31], v[232:239], v23
    s_waitcnt lgkmcnt(4)
    s_barrier
    v_mfma_f32_16x16x32_bf16 v[116:119], a[144:147], v[216:219], v[116:119]
    v_exp_f32 v66, v66
    v_mfma_f32_16x16x32_bf16 v[116:119], a[176:179], v[208:211], v[116:119]
    v_exp_f32 v67, v67
    v_mfma_f32_16x16x32_bf16 v[116:119], a[208:211], v[240:243], v[116:119]
    v_perm_b32 v232, v65, v64, s35
    v_perm_b32 v233, v67, v66, s35
    v_mfma_f32_16x16x32_bf16 v[116:119], a[240:243], v[248:251], v[116:119]
    v_exp_f32 v68, v68
    v_mfma_f32_16x16x32_bf16 v[120:123], a[244:247], v[248:251], v[120:123]
    v_exp_f32 v69, v69
    v_mfma_f32_16x16x32_bf16 v[120:123], a[212:215], v[240:243], v[120:123]
    v_exp_f32 v70, v70
    v_mfma_f32_16x16x32_bf16 v[120:123], a[180:183], v[208:211], v[120:123]
    v_exp_f32 v71, v71
    v_mfma_f32_16x16x32_bf16 v[120:123], a[148:151], v[216:219], v[120:123]
    s_waitcnt lgkmcnt(0)
    v_perm_b32 v234, v69, v68, s35
    v_perm_b32 v235, v71, v70, s35
    v_mfma_f32_16x16x32_bf16 v[72:75], a[96:99], v[48:51], 0
    s_add_u32 m0, s24, 16384
    s_mov_b32 s29, 0xc000
    v_mfma_f32_16x16x32_bf16 v[72:75], a[100:103], v[52:55], v[72:75]
    buffer_load_dwordx4 v9, s[8:11], s29 offen lds
    v_mfma_f32_16x16x32_bf16 v[72:75], a[104:107], v[56:59], v[72:75]
L_s3:
    s_cbranch_execz L_cek3
L_s3_n:
    ds_read_b128 v[32:35], v2 offset:8192
    ds_read_b128 v[36:39], v2 offset:8704
    v_mfma_f32_16x16x32_bf16 v[72:75], a[108:111], v[60:63], v[72:75]
    ds_read_b128 v[40:43], v2 offset:10240
    ds_read_b128 v[44:47], v2 offset:10752
    ds_write_b128 v3, v[232:235] offset:36864
    v_mfma_f32_16x16x32_bf16 v[76:79], a[124:127], v[60:63], 0
    ds_read_b128 v[216:219], v3 offset:38912
    ds_read_b128 v[208:211], v4 offset:38912
    v_mfma_f32_16x16x32_bf16 v[76:79], a[120:123], v[56:59], v[76:79]
    ds_read_b128 v[240:243], v5 offset:38912
    ds_read_b128 v[248:251], v6 offset:38912
    v_mfma_f32_16x16x32_bf16 v[76:79], a[116:119], v[52:55], v[76:79]
    v_exp_f32 v72, v72
    v_mfma_f32_16x16x32_bf16 v[76:79], a[112:115], v[48:51], v[76:79]
    v_exp_f32 v73, v73
    v_mfma_f32_16x16x32_bf16 v[124:127], a[144:147], v[220:223], v[124:127]
    v_exp_f32 v74, v74
    v_mfma_f32_16x16x32_bf16 v[124:127], a[176:179], v[212:215], v[124:127]
    v_exp_f32 v75, v75
    v_mfma_f32_16x16x32_bf16 v[124:127], a[208:211], v[244:247], v[124:127]
    v_perm_b32 v236, v73, v72, s35
    v_perm_b32 v237, v75, v74, s35
    v_mfma_f32_16x16x32_bf16 v[124:127], a[240:243], v[252:255], v[124:127]
    v_exp_f32 v76, v76
    v_mfma_f32_16x16x32_bf16 v[128:131], a[244:247], v[252:255], v[128:131]
    v_exp_f32 v77, v77
    v_mfma_f32_16x16x32_bf16 v[128:131], a[212:215], v[244:247], v[128:131]
    v_exp_f32 v78, v78
    v_mfma_f32_16x16x32_bf16 v[128:131], a[180:183], v[212:215], v[128:131]
    v_exp_f32 v79, v79
    v_mfma_f32_16x16x32_bf16 v[128:131], a[148:151], v[220:223], v[128:131]
    s_waitcnt lgkmcnt(5)
    v_perm_b32 v238, v77, v76, s35
    v_perm_b32 v239, v79, v78, s35
    v_mfma_f32_16x16x32_bf16 v[64:67], a[96:99], v[32:35], 0
    buffer_load_dwordx4 v9, s[8:11], s29 offen offset:1024 lds
    v_mfma_f32_16x16x32_bf16 v[64:67], a[100:103], v[36:39], v[64:67]
    ds_read_b128 v[220:223], v3 offset:39936
    ds_read_b128 v[212:215], v4 offset:39936
    v_mfma_f32_16x16x32_bf16 v[64:67], a[104:107], v[40:43], v[64:67]
    ds_read_b128 v[244:247], v5 offset:39936
    ds_read_b128 v[252:255], v6 offset:39936
    v_mfma_f32_16x16x32_bf16 v[64:67], a[108:111], v[44:47], v[64:67]
    ds_write_b128 v3, v[236:239] offset:37888
    v_mfma_f32_16x16x32_bf16 v[68:71], a[124:127], v[44:47], 0
    ds_read_b128 v[48:51], v2 offset:12288
    ds_read_b128 v[52:55], v2 offset:12800
    v_mfma_f32_16x16x32_bf16 v[68:71], a[120:123], v[40:43], v[68:71]
    ds_read_b128 v[56:59], v2 offset:14336
    ds_read_b128 v[60:63], v2 offset:14848
    v_mfma_f32_16x16x32_bf16 v[68:71], a[116:119], v[36:39], v[68:71]
    v_exp_f32 v64, v64
    v_mfma_f32_16x16x32_bf16 v[68:71], a[112:115], v[32:35], v[68:71]
    v_exp_f32 v65, v65
    v_smfmac_f32_16x16x64_bf16 v[148:151], v[28:31], v[232:239], v23
    s_waitcnt lgkmcnt(4)
    s_barrier
    v_mfma_f32_16x16x32_bf16 v[132:135], a[144:147], v[216:219], v[132:135]
    v_exp_f32 v66, v66
    v_mfma_f32_16x16x32_bf16 v[132:135], a[176:179], v[208:211], v[132:135]
    v_exp_f32 v67, v67
    v_mfma_f32_16x16x32_bf16 v[132:135], a[208:211], v[240:243], v[132:135]
    v_perm_b32 v232, v65, v64, s35
    v_perm_b32 v233, v67, v66, s35
    v_mfma_f32_16x16x32_bf16 v[132:135], a[240:243], v[248:251], v[132:135]
    v_add_f32 v150, v148, v149
    v_exp_f32 v68, v68
    v_mfma_f32_16x16x32_bf16 v[136:139], a[244:247], v[248:251], v[136:139]
    v_exp_f32 v69, v69
    v_mfma_f32_16x16x32_bf16 v[136:139], a[212:215], v[240:243], v[136:139]
    v_exp_f32 v70, v70
    v_mfma_f32_16x16x32_bf16 v[136:139], a[180:183], v[208:211], v[136:139]
    v_exp_f32 v71, v71
    v_mfma_f32_16x16x32_bf16 v[136:139], a[148:151], v[216:219], v[136:139]
    s_waitcnt lgkmcnt(0)
    ds_write_b32 v7, v150 offset:28672
    v_perm_b32 v234, v69, v68, s35
    v_perm_b32 v235, v71, v70, s35
    v_mfma_f32_16x16x32_bf16 v[72:75], a[96:99], v[48:51], 0
    s_add_u32 m0, s24, 24576
    s_mov_b32 s29, 0xe000
    v_mfma_f32_16x16x32_bf16 v[72:75], a[100:103], v[52:55], v[72:75]
    buffer_load_dwordx4 v9, s[8:11], s29 offen lds
    v_mfma_f32_16x16x32_bf16 v[72:75], a[104:107], v[56:59], v[72:75]
    ds_read_b128 v[32:35], v2 offset:32768
    ds_read_b128 v[36:39], v2 offset:33280
    v_mfma_f32_16x16x32_bf16 v[72:75], a[108:111], v[60:63], v[72:75]
    ds_read_b128 v[40:43], v2 offset:34816
    ds_read_b128 v[44:47], v2 offset:35328
    ds_write_b128 v3, v[232:235] offset:38912
    v_mfma_f32_16x16x32_bf16 v[76:79], a[124:127], v[60:63], 0
    ds_read_b128 v[216:219], v3 offset:32768
    ds_read_b128 v[208:211], v4 offset:32768
    v_mfma_f32_16x16x32_bf16 v[76:79], a[120:123], v[56:59], v[76:79]
    ds_read_b128 v[240:243], v5 offset:32768
    ds_read_b128 v[248:251], v6 offset:32768
    v_mfma_f32_16x16x32_bf16 v[76:79], a[116:119], v[52:55], v[76:79]
    v_exp_f32 v72, v72
    v_mfma_f32_16x16x32_bf16 v[76:79], a[112:115], v[48:51], v[76:79]
    v_exp_f32 v73, v73
    v_mfma_f32_16x16x32_bf16 v[140:143], a[144:147], v[220:223], v[140:143]
    v_exp_f32 v74, v74
    v_mfma_f32_16x16x32_bf16 v[140:143], a[176:179], v[212:215], v[140:143]
    v_exp_f32 v75, v75
    v_mfma_f32_16x16x32_bf16 v[140:143], a[208:211], v[244:247], v[140:143]
    v_perm_b32 v236, v73, v72, s35
    v_perm_b32 v237, v75, v74, s35
    v_mfma_f32_16x16x32_bf16 v[140:143], a[240:243], v[252:255], v[140:143]
    v_exp_f32 v76, v76
    v_mfma_f32_16x16x32_bf16 v[144:147], a[244:247], v[252:255], v[144:147]
    v_exp_f32 v77, v77
    v_mfma_f32_16x16x32_bf16 v[144:147], a[212:215], v[244:247], v[144:147]
    v_exp_f32 v78, v78
    v_mfma_f32_16x16x32_bf16 v[144:147], a[180:183], v[212:215], v[144:147]
    v_exp_f32 v79, v79
    v_mfma_f32_16x16x32_bf16 v[144:147], a[148:151], v[220:223], v[144:147]
    s_waitcnt lgkmcnt(5)
    v_perm_b32 v238, v77, v76, s35
    v_perm_b32 v239, v79, v78, s35
    buffer_load_dwordx4 v9, s[8:11], s29 offen offset:1024 lds
    v_mfma_f32_16x16x32_bf16 v[64:67], a[96:99], v[32:35], 0
    s_add_u32 m0, s24, 0
    s_mov_b32 s29, 0x10000
    v_mfma_f32_16x16x32_bf16 v[64:67], a[100:103], v[36:39], v[64:67]
    buffer_load_dwordx4 v9, s[8:11], s29 offen lds
    v_mfma_f32_16x16x32_bf16 v[64:67], a[104:107], v[40:43], v[64:67]
    ds_read_b128 v[220:223], v3 offset:33792
    ds_read_b128 v[212:215], v4 offset:33792
    v_mfma_f32_16x16x32_bf16 v[64:67], a[108:111], v[44:47], v[64:67]
    ds_read_b128 v[244:247], v5 offset:33792
    ds_read_b128 v[252:255], v6 offset:33792
    ds_write_b128 v3, v[236:239] offset:39936
    v_mfma_f32_16x16x32_bf16 v[68:71], a[124:127], v[44:47], 0
    ds_read_b128 v[48:51], v2 offset:36864
    ds_read_b128 v[52:55], v2 offset:37376
    v_mfma_f32_16x16x32_bf16 v[68:71], a[120:123], v[40:43], v[68:71]
    ds_read_b128 v[56:59], v2 offset:38912
    ds_read_b128 v[60:63], v2 offset:39424
    v_mfma_f32_16x16x32_bf16 v[68:71], a[116:119], v[36:39], v[68:71]
    v_exp_f32 v64, v64
    v_mfma_f32_16x16x32_bf16 v[68:71], a[112:115], v[32:35], v[68:71]
    v_exp_f32 v65, v65
    v_smfmac_f32_16x16x64_bf16 v[152:155], v[28:31], v[232:239], v23
    s_waitcnt lgkmcnt(4)
    s_barrier
    ds_read_b128 v[200:203], v8 offset:28672
    v_mfma_f32_16x16x32_bf16 v[164:167], a[144:147], v[216:219], v[164:167]
    v_exp_f32 v66, v66
    v_mfma_f32_16x16x32_bf16 v[164:167], a[176:179], v[208:211], v[164:167]
    v_exp_f32 v67, v67
    v_mfma_f32_16x16x32_bf16 v[164:167], a[208:211], v[240:243], v[164:167]
    v_perm_b32 v232, v65, v64, s35
    v_perm_b32 v233, v67, v66, s35
    v_mfma_f32_16x16x32_bf16 v[164:167], a[240:243], v[248:251], v[164:167]
    v_add_f32 v154, v152, v153
    v_exp_f32 v68, v68
    v_mfma_f32_16x16x32_bf16 v[168:171], a[244:247], v[248:251], v[168:171]
    v_exp_f32 v69, v69
    v_mfma_f32_16x16x32_bf16 v[168:171], a[212:215], v[240:243], v[168:171]
    v_exp_f32 v70, v70
    v_mfma_f32_16x16x32_bf16 v[168:171], a[180:183], v[208:211], v[168:171]
    v_exp_f32 v71, v71
    v_mfma_f32_16x16x32_bf16 v[168:171], a[148:151], v[216:219], v[168:171]
    s_waitcnt lgkmcnt(1)
    ds_write_b32 v7, v154 offset:29184
    v_perm_b32 v234, v69, v68, s35
    v_perm_b32 v235, v71, v70, s35
    s_waitcnt lgkmcnt(1)
    v_add_f32 v200, v200, v201
    v_mfma_f32_16x16x32_bf16 v[72:75], a[96:99], v[48:51], 0
    v_add_f32 v202, v202, v203
    v_add_f32 v17, v200, v202
    v_mfma_f32_16x16x32_bf16 v[72:75], a[100:103], v[52:55], v[72:75]
    ds_read_b128 v[32:35], v2 offset:40960
    ds_read_b128 v[36:39], v2 offset:41472
    v_mfma_f32_16x16x32_bf16 v[72:75], a[104:107], v[56:59], v[72:75]
    ds_read_b128 v[40:43], v2 offset:43008
    ds_read_b128 v[44:47], v2 offset:43520
    v_mfma_f32_16x16x32_bf16 v[72:75], a[108:111], v[60:63], v[72:75]
    ds_write_b128 v3, v[232:235] offset:32768
    v_rcp_f32 v148, v17
    v_mfma_f32_16x16x32_bf16 v[76:79], a[124:127], v[60:63], 0
    ds_read_b128 v[216:219], v3 offset:34816
    ds_read_b128 v[208:211], v4 offset:34816
    v_mfma_f32_16x16x32_bf16 v[76:79], a[120:123], v[56:59], v[76:79]
    ds_read_b128 v[240:243], v5 offset:34816
    ds_read_b128 v[248:251], v6 offset:34816
    v_mfma_f32_16x16x32_bf16 v[76:79], a[116:119], v[52:55], v[76:79]
    v_exp_f32 v72, v72
    v_mfma_f32_16x16x32_bf16 v[76:79], a[112:115], v[48:51], v[76:79]
    v_exp_f32 v73, v73
    v_mov_b32 v149, v148
    buffer_load_dwordx4 v9, s[8:11], s29 offen offset:1024 lds
    v_mfma_f32_16x16x32_bf16 v[172:175], a[144:147], v[220:223], v[172:175]
    v_exp_f32 v74, v74
    v_mfma_f32_16x16x32_bf16 v[172:175], a[176:179], v[212:215], v[172:175]
    v_exp_f32 v75, v75
    v_mfma_f32_16x16x32_bf16 v[172:175], a[208:211], v[244:247], v[172:175]
    v_perm_b32 v236, v73, v72, s35
    v_perm_b32 v237, v75, v74, s35
    v_mfma_f32_16x16x32_bf16 v[172:175], a[240:243], v[252:255], v[172:175]
    v_exp_f32 v76, v76
    v_max3_u32 v11, v11, v17, v148
    v_mfma_f32_16x16x32_bf16 v[176:179], a[244:247], v[252:255], v[176:179]
    v_exp_f32 v77, v77
    v_mfma_f32_16x16x32_bf16 v[176:179], a[212:215], v[244:247], v[176:179]
    v_exp_f32 v78, v78
    v_mfma_f32_16x16x32_bf16 v[176:179], a[180:183], v[212:215], v[176:179]
    v_exp_f32 v79, v79
    v_mfma_f32_16x16x32_bf16 v[176:179], a[148:151], v[220:223], v[176:179]
    s_waitcnt lgkmcnt(5)
    v_perm_b32 v238, v77, v76, s35
    v_perm_b32 v239, v79, v78, s35
    v_permlane32_swap_b32 v148, v149
    v_mfma_f32_16x16x32_bf16 v[64:67], a[96:99], v[32:35], 0
    s_add_u32 m0, s24, 8192
    s_mov_b32 s29, 0x12000
    v_mfma_f32_16x16x32_bf16 v[64:67], a[100:103], v[36:39], v[64:67]
    buffer_load_dwordx4 v9, s[8:11], s29 offen lds
    v_mfma_f32_16x16x32_bf16 v[64:67], a[104:107], v[40:43], v[64:67]
    ds_read_b128 v[220:223], v3 offset:35840
    ds_read_b128 v[212:215], v4 offset:35840
    v_mfma_f32_16x16x32_bf16 v[64:67], a[108:111], v[44:47], v[64:67]
    ds_read_b128 v[244:247], v5 offset:35840
    ds_read_b128 v[252:255], v6 offset:35840
    ds_write_b128 v3, v[236:239] offset:33792
    v_mfma_f32_16x16x32_bf16 v[68:71], a[124:127], v[44:47], 0
    ds_read_b128 v[48:51], v2 offset:45056
    ds_read_b128 v[52:55], v2 offset:45568
    v_mfma_f32_16x16x32_bf16 v[68:71], a[120:123], v[40:43], v[68:71]
    ds_read_b128 v[56:59], v2 offset:47104
    ds_read_b128 v[60:63], v2 offset:47616
    v_mfma_f32_16x16x32_bf16 v[68:71], a[116:119], v[36:39], v[68:71]
    v_exp_f32 v64, v64
    v_mfma_f32_16x16x32_bf16 v[68:71], a[112:115], v[32:35], v[68:71]
    v_exp_f32 v65, v65
    v_smfmac_f32_16x16x64_bf16 v[156:159], v[28:31], v[232:239], v23
    s_waitcnt lgkmcnt(9)
    buffer_load_dwordx4 v9, s[8:11], s29 offen offset:1024 lds
    s_waitcnt vmcnt(8) lgkmcnt(4)
    s_barrier
    ds_read_b64_tr_b16 a[152:153], v13 offset:32768
    ds_read_b64_tr_b16 a[154:155], v13 offset:36864
    ds_read_b64_tr_b16 a[156:157], v13 offset:32776
    ds_read_b128 v[200:203], v8 offset:29184
    v_mfma_f32_16x16x32_bf16 v[180:183], a[144:147], v[216:219], v[180:183]
    v_exp_f32 v66, v66
    v_mfma_f32_16x16x32_bf16 v[180:183], a[176:179], v[208:211], v[180:183]
    v_exp_f32 v67, v67
    v_mfma_f32_16x16x32_bf16 v[180:183], a[208:211], v[240:243], v[180:183]
    v_perm_b32 v232, v65, v64, s35
    v_perm_b32 v233, v67, v66, s35
    v_mfma_f32_16x16x32_bf16 v[180:183], a[240:243], v[248:251], v[180:183]
    v_add_f32 v158, v156, v157
    ds_read_b64_tr_b16 a[158:159], v13 offset:36872
    ds_read_b64_tr_b16 a[184:185], v14 offset:32768
    ds_read_b64_tr_b16 a[186:187], v14 offset:36864
    v_exp_f32 v68, v68
    v_mfma_f32_16x16x32_bf16 v[184:187], a[244:247], v[248:251], v[184:187]
    v_exp_f32 v69, v69
    v_mfma_f32_16x16x32_bf16 v[184:187], a[212:215], v[240:243], v[184:187]
    v_exp_f32 v70, v70
    v_mfma_f32_16x16x32_bf16 v[184:187], a[180:183], v[208:211], v[184:187]
    v_exp_f32 v71, v71
    v_mfma_f32_16x16x32_bf16 v[184:187], a[148:151], v[216:219], v[184:187]
    s_waitcnt lgkmcnt(7)
    ds_write_b32 v7, v158 offset:28672
    ds_read_b64_tr_b16 a[188:189], v14 offset:32776
    ds_read_b64_tr_b16 a[190:191], v14 offset:36872
    v_perm_b32 v234, v69, v68, s35
    v_perm_b32 v235, v71, v70, s35
    s_waitcnt lgkmcnt(6)
    v_add_f32 v200, v200, v201
    v_mfma_f32_16x16x32_bf16 v[72:75], a[96:99], v[48:51], 0
    ds_read_b64_tr_b16 a[216:217], v15 offset:32768
    ds_read_b64_tr_b16 a[218:219], v15 offset:36864
    v_mfma_f32_16x16x32_bf16 v[72:75], a[100:103], v[52:55], v[72:75]
    ds_read_b64_tr_b16 a[220:221], v15 offset:32776
    v_add_f32 v202, v202, v203
    v_mfma_f32_16x16x32_bf16 v[72:75], a[104:107], v[56:59], v[72:75]
    v_add_f32 v17, v200, v202
    ds_read_b128 v[32:35], v2 offset:49152
    v_mfma_f32_16x16x32_bf16 v[72:75], a[108:111], v[60:63], v[72:75]
    ds_read_b128 v[36:39], v2 offset:49664
    ds_read_b128 v[40:43], v2 offset:51200
    ds_read_b128 v[44:47], v2 offset:51712
    ds_write_b128 v3, v[232:235] offset:34816
    v_rcp_f32 v152, v17
    v_mfma_f32_16x16x32_bf16 v[76:79], a[124:127], v[60:63], 0
    ds_read_b128 v[216:219], v3 offset:36864
    ds_read_b128 v[208:211], v4 offset:36864
    v_mfma_f32_16x16x32_bf16 v[76:79], a[120:123], v[56:59], v[76:79]
    ds_read_b128 v[240:243], v5 offset:36864
    ds_read_b128 v[248:251], v6 offset:36864
    v_mfma_f32_16x16x32_bf16 v[76:79], a[116:119], v[52:55], v[76:79]
    v_exp_f32 v72, v72
    v_mfma_f32_16x16x32_bf16 v[76:79], a[112:115], v[48:51], v[76:79]
    ds_read_b64_tr_b16 a[222:223], v15 offset:36872
    ds_read_b64_tr_b16 a[248:249], v16 offset:32768
    ds_read_b64_tr_b16 a[250:251], v16 offset:36864
    v_exp_f32 v73, v73
    v_mov_b32 v153, v152
    v_mfma_f32_16x16x32_bf16 v[188:191], a[144:147], v[220:223], v[188:191]
    v_exp_f32 v74, v74
    v_mfma_f32_16x16x32_bf16 v[188:191], a[176:179], v[212:215], v[188:191]
    v_exp_f32 v75, v75
    v_mfma_f32_16x16x32_bf16 v[188:191], a[208:211], v[244:247], v[188:191]
    v_perm_b32 v236, v73, v72, s35
    v_perm_b32 v237, v75, v74, s35
    v_mfma_f32_16x16x32_bf16 v[188:191], a[240:243], v[252:255], v[188:191]
    ds_read_b64_tr_b16 a[252:253], v16 offset:32776
    ds_read_b64_tr_b16 a[254:255], v16 offset:36872
    v_exp_f32 v76, v76
    v_max3_u32 v11, v11, v17, v152
    v_mfma_f32_16x16x32_bf16 v[192:195], a[244:247], v[252:255], v[192:195]
    v_exp_f32 v77, v77
    v_mfma_f32_16x16x32_bf16 v[192:195], a[212:215], v[244:247], v[192:195]
    v_exp_f32 v78, v78
    v_mfma_f32_16x16x32_bf16 v[192:195], a[180:183], v[212:215], v[192:195]
    v_exp_f32 v79, v79
    v_mfma_f32_16x16x32_bf16 v[192:195], a[148:151], v[220:223], v[192:195]
    s_waitcnt lgkmcnt(10)
    v_perm_b32 v238, v77, v76, s35
    v_perm_b32 v239, v79, v78, s35
    v_permlane32_swap_b32 v152, v153
    v_mfma_f32_16x16x32_bf16 v[64:67], a[96:99], v[32:35], 0
    v_mfma_f32_16x16x32_bf16 v[64:67], a[100:103], v[36:39], v[64:67]
    ds_read_b128 v[220:223], v3 offset:37888
    ds_read_b128 v[212:215], v4 offset:37888
    v_mfma_f32_16x16x32_bf16 v[64:67], a[104:107], v[40:43], v[64:67]
    ds_read_b128 v[244:247], v5 offset:37888
    ds_read_b128 v[252:255], v6 offset:37888
    v_mfma_f32_16x16x32_bf16 v[64:67], a[108:111], v[44:47], v[64:67]
    ds_write_b128 v3, v[236:239] offset:35840
    v_mfma_f32_16x16x32_bf16 v[68:71], a[124:127], v[44:47], 0
    ds_read_b128 v[48:51], v2 offset:53248
    ds_read_b128 v[52:55], v2 offset:53760
    v_mfma_f32_16x16x32_bf16 v[68:71], a[120:123], v[40:43], v[68:71]
    ds_read_b128 v[56:59], v2 offset:55296
    ds_read_b128 v[60:63], v2 offset:55808
    v_mfma_f32_16x16x32_bf16 v[68:71], a[116:119], v[36:39], v[68:71]
    v_exp_f32 v64, v64
    v_mfma_f32_16x16x32_bf16 v[68:71], a[112:115], v[32:35], v[68:71]
    v_exp_f32 v65, v65
    v_smfmac_f32_16x16x64_bf16 v[160:163], v[28:31], v[232:239], v23
    s_waitcnt lgkmcnt(4)
    s_barrier
    ds_read_b128 v[200:203], v8 offset:28672
    v_mfma_f32_16x16x32_bf16 v[80:83], a[152:155], v[216:219], v[80:83]
    v_exp_f32 v66, v66
    v_mfma_f32_16x16x32_bf16 v[80:83], a[184:187], v[208:211], v[80:83]
    v_exp_f32 v67, v67
    v_mfma_f32_16x16x32_bf16 v[80:83], a[216:219], v[240:243], v[80:83]
    v_perm_b32 v232, v65, v64, s35
    v_perm_b32 v233, v67, v66, s35
    v_mfma_f32_16x16x32_bf16 v[80:83], a[248:251], v[248:251], v[80:83]
    v_add_f32 v162, v160, v161
    v_exp_f32 v68, v68
    v_mfma_f32_16x16x32_bf16 v[84:87], a[252:255], v[248:251], v[84:87]
    v_exp_f32 v69, v69
    v_mfma_f32_16x16x32_bf16 v[84:87], a[220:223], v[240:243], v[84:87]
    v_exp_f32 v70, v70
    v_mfma_f32_16x16x32_bf16 v[84:87], a[188:191], v[208:211], v[84:87]
    v_exp_f32 v71, v71
    v_mfma_f32_16x16x32_bf16 v[84:87], a[156:159], v[216:219], v[84:87]
    s_waitcnt lgkmcnt(1)
    ds_write_b32 v7, v162 offset:29184
    v_perm_b32 v234, v69, v68, s35
    v_perm_b32 v235, v71, v70, s35
    s_waitcnt lgkmcnt(1)
    v_add_f32 v200, v200, v201
    v_mfma_f32_16x16x32_bf16 v[72:75], a[96:99], v[48:51], 0
    v_add_f32 v202, v202, v203
    v_add_f32 v17, v200, v202
    v_mfma_f32_16x16x32_bf16 v[72:75], a[100:103], v[52:55], v[72:75]
    ds_read_b128 v[32:35], v2 offset:57344
    ds_read_b128 v[36:39], v2 offset:57856
    v_mfma_f32_16x16x32_bf16 v[72:75], a[104:107], v[56:59], v[72:75]
    ds_read_b128 v[40:43], v2 offset:59392
    ds_read_b128 v[44:47], v2 offset:59904
    v_mfma_f32_16x16x32_bf16 v[72:75], a[108:111], v[60:63], v[72:75]
    ds_write_b128 v3, v[232:235] offset:36864
    v_rcp_f32 v156, v17
    v_mfma_f32_16x16x32_bf16 v[76:79], a[124:127], v[60:63], 0
    ds_read_b128 v[216:219], v3 offset:38912
    ds_read_b128 v[208:211], v4 offset:38912
    v_mfma_f32_16x16x32_bf16 v[76:79], a[120:123], v[56:59], v[76:79]
    ds_read_b128 v[240:243], v5 offset:38912
    ds_read_b128 v[248:251], v6 offset:38912
    v_mfma_f32_16x16x32_bf16 v[76:79], a[116:119], v[52:55], v[76:79]
    v_exp_f32 v72, v72
    v_mfma_f32_16x16x32_bf16 v[76:79], a[112:115], v[48:51], v[76:79]
    v_exp_f32 v73, v73
    v_mov_b32 v157, v156
    v_mfma_f32_16x16x32_bf16 v[92:95], a[152:155], v[220:223], v[92:95]
    v_exp_f32 v74, v74
    v_mfma_f32_16x16x32_bf16 v[92:95], a[184:187], v[212:215], v[92:95]
    v_exp_f32 v75, v75
    v_mfma_f32_16x16x32_bf16 v[92:95], a[216:219], v[244:247], v[92:95]
    v_perm_b32 v236, v73, v72, s35
    v_perm_b32 v237, v75, v74, s35
    v_mfma_f32_16x16x32_bf16 v[92:95], a[248:251], v[252:255], v[92:95]
    v_exp_f32 v76, v76
    v_max3_u32 v11, v11, v17, v156
    v_mfma_f32_16x16x32_bf16 v[96:99], a[252:255], v[252:255], v[96:99]
    v_exp_f32 v77, v77
    v_mfma_f32_16x16x32_bf16 v[96:99], a[220:223], v[244:247], v[96:99]
    v_exp_f32 v78, v78
    v_mfma_f32_16x16x32_bf16 v[96:99], a[188:191], v[212:215], v[96:99]
    v_exp_f32 v79, v79
    v_mfma_f32_16x16x32_bf16 v[96:99], a[156:159], v[220:223], v[96:99]
    s_waitcnt lgkmcnt(5)
    v_perm_b32 v238, v77, v76, s35
    v_perm_b32 v239, v79, v78, s35
    v_permlane32_swap_b32 v156, v157
    v_mfma_f32_16x16x32_bf16 v[64:67], a[96:99], v[32:35], 0
    v_mfma_f32_16x16x32_bf16 v[64:67], a[100:103], v[36:39], v[64:67]
    ds_read_b128 v[220:223], v3 offset:39936
    ds_read_b128 v[212:215], v4 offset:39936
    v_mfma_f32_16x16x32_bf16 v[64:67], a[104:107], v[40:43], v[64:67]
    ds_read_b128 v[244:247], v5 offset:39936
    ds_read_b128 v[252:255], v6 offset:39936
    v_mfma_f32_16x16x32_bf16 v[64:67], a[108:111], v[44:47], v[64:67]
    ds_write_b128 v3, v[236:239] offset:37888
    v_mfma_f32_16x16x32_bf16 v[68:71], a[124:127], v[44:47], 0
    ds_read_b128 v[48:51], v2 offset:61440
    ds_read_b128 v[52:55], v2 offset:61952
    v_mfma_f32_16x16x32_bf16 v[68:71], a[120:123], v[40:43], v[68:71]
    ds_read_b128 v[56:59], v2 offset:63488
    ds_read_b128 v[60:63], v2 offset:64000
    v_mfma_f32_16x16x32_bf16 v[68:71], a[116:119], v[36:39], v[68:71]
    v_exp_f32 v64, v64
    v_mfma_f32_16x16x32_bf16 v[68:71], a[112:115], v[32:35], v[68:71]
    v_exp_f32 v65, v65
    v_smfmac_f32_16x16x64_bf16 v[224:227], v[28:31], v[232:239], v23
    s_waitcnt vmcnt(6) lgkmcnt(4)
    s_barrier
    ds_read_b128 v[200:203], v8 offset:29184
    v_mfma_f32_16x16x32_bf16 v[100:103], a[152:155], v[216:219], v[100:103]
    v_exp_f32 v66, v66
    v_mfma_f32_16x16x32_bf16 v[100:103], a[184:187], v[208:211], v[100:103]
    v_exp_f32 v67, v67
    v_mfma_f32_16x16x32_bf16 v[100:103], a[216:219], v[240:243], v[100:103]
    v_perm_b32 v232, v65, v64, s35
    v_perm_b32 v233, v67, v66, s35
    v_mfma_f32_16x16x32_bf16 v[100:103], a[248:251], v[248:251], v[100:103]
    v_add_f32 v226, v224, v225
    v_exp_f32 v68, v68
    v_mfma_f32_16x16x32_bf16 v[104:107], a[252:255], v[248:251], v[104:107]
    v_exp_f32 v69, v69
    v_mfma_f32_16x16x32_bf16 v[104:107], a[220:223], v[240:243], v[104:107]
    v_exp_f32 v70, v70
    v_mfma_f32_16x16x32_bf16 v[104:107], a[188:191], v[208:211], v[104:107]
    v_exp_f32 v71, v71
    v_mfma_f32_16x16x32_bf16 v[104:107], a[156:159], v[216:219], v[104:107]
    s_waitcnt lgkmcnt(1)
    ds_write_b32 v7, v226 offset:28672
    v_perm_b32 v234, v69, v68, s35
    v_perm_b32 v235, v71, v70, s35
    s_waitcnt lgkmcnt(1)
    v_add_f32 v200, v200, v201
    v_add_f32 v202, v202, v203
    v_add_f32 v17, v200, v202
    v_mfma_f32_16x16x32_bf16 v[72:75], a[96:99], v[48:51], 0
    v_rcp_f32 v160, v17
    v_mfma_f32_16x16x32_bf16 v[72:75], a[100:103], v[52:55], v[72:75]
    v_mov_b32 v161, v160
    v_max3_u32 v11, v11, v17, v160
    v_mfma_f32_16x16x32_bf16 v[72:75], a[104:107], v[56:59], v[72:75]
    v_permlane32_swap_b32 v160, v161
    v_mfma_f32_16x16x32_bf16 v[72:75], a[108:111], v[60:63], v[72:75]
    s_mov_b32 s31, 0x0
    s_mov_b32 s32, 0x1000
    v_mul_f32 v80, v80, v148
    v_mul_f32 v81, v81, v148
    ds_read_b128 v[32:35], v2 offset:16384
    ds_read_b128 v[36:39], v2 offset:16896
    ds_read_b128 v[40:43], v2 offset:18432
    ds_read_b128 v[44:47], v2 offset:18944
    ds_write_b128 v3, v[232:235] offset:38912
    v_mul_f32 v82, v82, v148
    v_mul_f32 v83, v83, v148
    v_mul_f32 v84, v84, v148
    v_mfma_f32_16x16x32_bf16 v[76:79], a[124:127], v[60:63], 0
    ds_read_b128 v[216:219], v3 offset:32768
    ds_read_b128 v[208:211], v4 offset:32768
    v_mfma_f32_16x16x32_bf16 v[76:79], a[120:123], v[56:59], v[76:79]
    ds_read_b128 v[240:243], v5 offset:32768
    ds_read_b128 v[248:251], v6 offset:32768
    v_mfma_f32_16x16x32_bf16 v[76:79], a[116:119], v[52:55], v[76:79]
    v_exp_f32 v72, v72
    v_mfma_f32_16x16x32_bf16 v[76:79], a[112:115], v[48:51], v[76:79]
    v_exp_f32 v73, v73
    v_mul_f32 v85, v85, v148
    v_mul_f32 v86, v86, v148
    v_mul_f32 v87, v87, v148
    v_cvt_pk_bf16_f32 v80, v80, v81
    v_mfma_f32_16x16x32_bf16 v[108:111], a[152:155], v[220:223], v[108:111]
    v_exp_f32 v74, v74
    v_mfma_f32_16x16x32_bf16 v[108:111], a[184:187], v[212:215], v[108:111]
    v_exp_f32 v75, v75
    v_mfma_f32_16x16x32_bf16 v[108:111], a[216:219], v[244:247], v[108:111]
    v_perm_b32 v236, v73, v72, s35
    v_perm_b32 v237, v75, v74, s35
    v_mfma_f32_16x16x32_bf16 v[108:111], a[248:251], v[252:255], v[108:111]
    v_exp_f32 v76, v76
    v_cvt_pk_bf16_f32 v81, v82, v83
    v_cvt_pk_bf16_f32 v82, v84, v85
    v_cvt_pk_bf16_f32 v83, v86, v87
    buffer_store_dwordx4 v[80:83], v10, s[20:23], s31 offen
    v_mfma_f32_16x16x32_bf16 v[112:115], a[252:255], v[252:255], v[112:115]
    v_exp_f32 v77, v77
    v_mfma_f32_16x16x32_bf16 v[112:115], a[220:223], v[244:247], v[112:115]
    v_exp_f32 v78, v78
    v_mfma_f32_16x16x32_bf16 v[112:115], a[188:191], v[212:215], v[112:115]
    v_exp_f32 v79, v79
    v_mfma_f32_16x16x32_bf16 v[112:115], a[156:159], v[220:223], v[112:115]
    s_waitcnt lgkmcnt(5)
    v_perm_b32 v238, v77, v76, s35
    v_perm_b32 v239, v79, v78, s35
    v_mul_f32 v92, v92, v149
    v_mul_f32 v93, v93, v149
    v_mul_f32 v94, v94, v149
    v_mfma_f32_16x16x32_bf16 v[64:67], a[0:3], v[32:35], 0
    v_mul_f32 v95, v95, v149
    v_mul_f32 v96, v96, v149
    v_mfma_f32_16x16x32_bf16 v[64:67], a[4:7], v[36:39], v[64:67]
    ds_read_b128 v[220:223], v3 offset:33792
    ds_read_b128 v[212:215], v4 offset:33792
    v_mfma_f32_16x16x32_bf16 v[64:67], a[8:11], v[40:43], v[64:67]
    ds_read_b128 v[244:247], v5 offset:33792
    ds_read_b128 v[252:255], v6 offset:33792
    v_mfma_f32_16x16x32_bf16 v[64:67], a[12:15], v[44:47], v[64:67]
    ds_write_b128 v3, v[236:239] offset:39936
    v_mul_f32 v97, v97, v149
    v_mul_f32 v98, v98, v149
    v_mfma_f32_16x16x32_bf16 v[68:71], a[28:31], v[44:47], 0
    ds_read_b128 v[48:51], v2 offset:20480
    ds_read_b128 v[52:55], v2 offset:20992
    v_mfma_f32_16x16x32_bf16 v[68:71], a[24:27], v[40:43], v[68:71]
    ds_read_b128 v[56:59], v2 offset:22528
    ds_read_b128 v[60:63], v2 offset:23040
    v_mfma_f32_16x16x32_bf16 v[68:71], a[20:23], v[36:39], v[68:71]
    v_exp_f32 v64, v64
    v_mfma_f32_16x16x32_bf16 v[68:71], a[16:19], v[32:35], v[68:71]
    v_exp_f32 v65, v65
    v_exp_f32 v66, v66
    v_exp_f32 v67, v67
    v_mul_f32 v99, v99, v149
    v_smfmac_f32_16x16x64_bf16 v[228:231], v[28:31], v[232:239], v23
    s_waitcnt lgkmcnt(0)
    s_barrier
    ds_read_b128 v[200:203], v8 offset:28672
    v_mfma_f32_16x16x32_bf16 v[116:119], a[152:155], v[216:219], v[116:119]
    v_perm_b32 v80, v65, v64, s35
    v_perm_b32 v81, v67, v66, s35
    v_mfma_f32_16x16x32_bf16 v[116:119], a[184:187], v[208:211], v[116:119]
    v_exp_f32 v68, v68
    v_mfma_f32_16x16x32_bf16 v[116:119], a[216:219], v[240:243], v[116:119]
    v_add_f32 v230, v228, v229
    v_cvt_pk_bf16_f32 v92, v92, v93
    v_mfma_f32_16x16x32_bf16 v[116:119], a[248:251], v[248:251], v[116:119]
    ds_write_b32 v7, v230 offset:29184
    v_exp_f32 v69, v69
    v_exp_f32 v70, v70
    v_cvt_pk_bf16_f32 v93, v94, v95
    s_waitcnt lgkmcnt(1)
    v_mfma_f32_16x16x32_bf16 v[120:123], a[252:255], v[248:251], v[120:123]
    v_mov_b32_dpp v28, v24 row_ror:8 row_mask:0xf bank_mask:0xf
    v_mov_b32_dpp v29, v24 row_ror:8 row_mask:0xf bank_mask:0xf
    v_mfma_f32_16x16x32_bf16 v[120:123], a[220:223], v[240:243], v[120:123]
    v_mov_b64 v[30:31], v[28:29]
    v_perm_b32 v82, v69, v68, s35
    v_mfma_f32_16x16x32_bf16 v[120:123], a[188:191], v[208:211], v[120:123]
    v_exp_f32 v71, v71
    v_mfma_f32_16x16x32_bf16 v[120:123], a[156:159], v[216:219], v[120:123]
    v_perm_b32 v83, v71, v70, s35
    v_cvt_pk_bf16_f32 v94, v96, v97
    v_cvt_pk_bf16_f32 v95, v98, v99
    s_mov_b32 s31, 0x2000
    v_mul_f32 v100, v100, v152
    v_mul_f32 v101, v101, v152
    v_mul_f32 v102, v102, v152
    v_mfma_f32_16x16x32_bf16 v[72:75], a[32:35], v[32:35], 0
    ds_read_b128 v[216:219], v3 offset:34816
    ds_read_b128 v[208:211], v4 offset:34816
    v_mfma_f32_16x16x32_bf16 v[72:75], a[36:39], v[36:39], v[72:75]
    ds_read_b128 v[240:243], v5 offset:34816
    ds_read_b128 v[248:251], v6 offset:34816
    v_mfma_f32_16x16x32_bf16 v[72:75], a[40:43], v[40:43], v[72:75]
    v_mul_f32 v103, v103, v152
    v_mul_f32 v104, v104, v152
    v_mfma_f32_16x16x32_bf16 v[72:75], a[44:47], v[44:47], v[72:75]
    s_waitcnt vmcnt(5) lgkmcnt(0)
    s_barrier
    v_mul_f32 v105, v105, v152
    v_mfma_f32_16x16x32_bf16 v[76:79], a[60:63], v[44:47], 0
    v_mul_f32 v106, v106, v152
    v_mul_f32 v107, v107, v152
    v_mfma_f32_16x16x32_bf16 v[76:79], a[56:59], v[40:43], v[76:79]
    s_add_u32 s29, s29, 0x2000
    v_cvt_pk_bf16_f32 v100, v100, v101
    v_mfma_f32_16x16x32_bf16 v[76:79], a[52:55], v[36:39], v[76:79]
L_s4:
    s_cbranch_execz L_s6
L_s4_n:
    s_add_u32 s30, s30, 0x2000
    v_cvt_pk_bf16_f32 v101, v102, v103
    v_mfma_f32_16x16x32_bf16 v[76:79], a[48:51], v[32:35], v[76:79]
    s_and_b32 s30, s30, 0x7fff
    buffer_store_dwordx4 v[92:95], v10, s[20:23], s32 offen
    v_mfma_f32_16x16x32_bf16 v[124:127], a[152:155], v[220:223], v[124:127]
    s_mov_b32 m0, s30
    v_cvt_pk_bf16_f32 v102, v104, v105
    v_mfma_f32_16x16x32_bf16 v[124:127], a[184:187], v[212:215], v[124:127]
    buffer_load_dwordx4 v9, s[8:11], s29 offen lds
    v_mfma_f32_16x16x32_bf16 v[124:127], a[216:219], v[244:247], v[124:127]
    v_exp_f32 v72, v72
    v_mfma_f32_16x16x32_bf16 v[124:127], a[248:251], v[252:255], v[124:127]
    ds_write_b128 v3, v[80:83] offset:0
    v_exp_f32 v73, v73
    v_mfma_f32_16x16x32_bf16 v[128:131], a[252:255], v[252:255], v[128:131]
    v_exp_f32 v74, v74
    v_mfma_f32_16x16x32_bf16 v[128:131], a[220:223], v[244:247], v[128:131]
    buffer_load_dwordx4 v9, s[8:11], s29 offen offset:1024 lds
    v_mfma_f32_16x16x32_bf16 v[128:131], a[188:191], v[212:215], v[128:131]
    v_exp_f32 v75, v75
    v_mfma_f32_16x16x32_bf16 v[128:131], a[156:159], v[220:223], v[128:131]
    v_perm_b32 v84, v73, v72, s35
    v_perm_b32 v85, v75, v74, s35
    v_exp_f32 v76, v76
    v_exp_f32 v77, v77
    v_cvt_pk_bf16_f32 v103, v106, v107
    v_mfma_f32_16x16x32_bf16 v[64:67], a[64:67], v[32:35], 0
    ds_read_b128 v[220:223], v3 offset:35840
    ds_read_b128 v[212:215], v4 offset:35840
    v_mfma_f32_16x16x32_bf16 v[64:67], a[68:71], v[36:39], v[64:67]
    ds_read_b128 v[244:247], v5 offset:35840
    ds_read_b128 v[252:255], v6 offset:35840
    v_mfma_f32_16x16x32_bf16 v[64:67], a[72:75], v[40:43], v[64:67]
    v_exp_f32 v78, v78
    v_mfma_f32_16x16x32_bf16 v[64:67], a[76:79], v[44:47], v[64:67]
    buffer_store_dwordx4 v[100:103], v10, s[20:23], s31 offen
    v_mfma_f32_16x16x32_bf16 v[68:71], a[92:95], v[44:47], 0
    v_exp_f32 v79, v79
    v_mfma_f32_16x16x32_bf16 v[68:71], a[88:91], v[40:43], v[68:71]
    v_perm_b32 v86, v77, v76, s35
    v_perm_b32 v87, v79, v78, s35
    v_mfma_f32_16x16x32_bf16 v[68:71], a[84:87], v[36:39], v[68:71]
    v_exp_f32 v64, v64
    v_mfma_f32_16x16x32_bf16 v[68:71], a[80:83], v[32:35], v[68:71]
    ds_write_b128 v3, v[84:87] offset:1024
    v_exp_f32 v65, v65
    v_smfmac_f32_16x16x64_bf16 v[196:199], v[24:27], v[80:87], v23
    v_exp_f32 v66, v66
    v_exp_f32 v67, v67
    v_perm_b32 v92, v65, v64, s35
    s_mov_b32 s32, 0x3000
    v_mfma_f32_16x16x32_bf16 v[132:135], a[152:155], v[216:219], v[132:135]
    v_perm_b32 v93, v67, v66, s35
    v_mul_f32 v108, v108, v153
    v_mfma_f32_16x16x32_bf16 v[132:135], a[184:187], v[208:211], v[132:135]
    v_exp_f32 v68, v68
    v_mfma_f32_16x16x32_bf16 v[132:135], a[216:219], v[240:243], v[132:135]
    v_exp_f32 v69, v69
    v_mfma_f32_16x16x32_bf16 v[132:135], a[248:251], v[248:251], v[132:135]
    v_exp_f32 v70, v70
    v_exp_f32 v71, v71
    v_perm_b32 v94, v69, v68, s35
    v_mul_f32 v109, v109, v153
    v_mul_f32 v110, v110, v153
    v_mfma_f32_16x16x32_bf16 v[136:139], a[252:255], v[248:251], v[136:139]
    v_perm_b32 v95, v71, v70, s35
    v_mul_f32 v111, v111, v153
    v_mfma_f32_16x16x32_bf16 v[136:139], a[220:223], v[240:243], v[136:139]
    v_mul_f32 v112, v112, v153
    v_mul_f32 v113, v113, v153
    v_mfma_f32_16x16x32_bf16 v[136:139], a[188:191], v[208:211], v[136:139]
    v_mul_f32 v114, v114, v153
    v_mul_f32 v115, v115, v153
    v_mfma_f32_16x16x32_bf16 v[136:139], a[156:159], v[216:219], v[136:139]
    ds_write_b128 v3, v[92:95] offset:2048
    v_cvt_pk_bf16_f32 v108, v108, v109
    v_cvt_pk_bf16_f32 v109, v110, v111
    v_mfma_f32_16x16x32_bf16 v[72:75], a[96:99], v[32:35], 0
    ds_read_b128 v[216:219], v3 offset:36864
    ds_read_b128 v[208:211], v4 offset:36864
    v_mfma_f32_16x16x32_bf16 v[72:75], a[100:103], v[36:39], v[72:75]
    ds_read_b128 v[240:243], v5 offset:36864
    ds_read_b128 v[248:251], v6 offset:36864
    v_mfma_f32_16x16x32_bf16 v[72:75], a[104:107], v[40:43], v[72:75]
    v_cvt_pk_bf16_f32 v110, v112, v113
    v_cvt_pk_bf16_f32 v111, v114, v115
    v_mfma_f32_16x16x32_bf16 v[72:75], a[108:111], v[44:47], v[72:75]
    buffer_store_dwordx4 v[108:111], v10, s[20:23], s32 offen
    v_mfma_f32_16x16x32_bf16 v[76:79], a[124:127], v[44:47], 0
    v_add_f32 v200, v200, v201
    v_add_f32 v202, v202, v203
    v_mfma_f32_16x16x32_bf16 v[76:79], a[120:123], v[40:43], v[76:79]
    v_add_f32 v17, v200, v202
    s_mov_b32 s31, 0x4000
    v_mfma_f32_16x16x32_bf16 v[76:79], a[116:119], v[36:39], v[76:79]
    v_exp_f32 v72, v72
    v_mfma_f32_16x16x32_bf16 v[76:79], a[112:115], v[32:35], v[76:79]
    s_waitcnt lgkmcnt(6)
    v_exp_f32 v73, v73
    v_exp_f32 v74, v74
    v_exp_f32 v75, v75
    s_mov_b32 s32, 0x5000
    v_mfma_f32_16x16x32_bf16 v[140:143], a[152:155], v[220:223], v[140:143]
    v_perm_b32 v96, v73, v72, s35
    v_perm_b32 v97, v75, v74, s35
    v_mfma_f32_16x16x32_bf16 v[140:143], a[184:187], v[212:215], v[140:143]
    v_rcp_f32 v224, v17
    v_mfma_f32_16x16x32_bf16 v[140:143], a[216:219], v[244:247], v[140:143]
    v_exp_f32 v76, v76
    v_mfma_f32_16x16x32_bf16 v[140:143], a[248:251], v[252:255], v[140:143]
    v_exp_f32 v77, v77
    v_exp_f32 v78, v78
    v_exp_f32 v79, v79
    v_mov_b32 v225, v224
    v_mfma_f32_16x16x32_bf16 v[144:147], a[252:255], v[252:255], v[144:147]
    v_perm_b32 v98, v77, v76, s35
    v_perm_b32 v99, v79, v78, s35
    v_mfma_f32_16x16x32_bf16 v[144:147], a[220:223], v[244:247], v[144:147]
    v_max3_u32 v11, v11, v17, v224
    v_mul_f32 v116, v116, v156
    v_mfma_f32_16x16x32_bf16 v[144:147], a[188:191], v[212:215], v[144:147]
    v_permlane32_swap_b32 v224, v225
    v_mfma_f32_16x16x32_bf16 v[144:147], a[156:159], v[220:223], v[144:147]
    ds_write_b128 v3, v[96:99] offset:3072
    v_mul_f32 v117, v117, v156
    v_mul_f32 v118, v118, v156
    v_mfma_f32_16x16x32_bf16 v[64:67], a[0:3], v[48:51], 0
    ds_read_b128 v[220:223], v3 offset:37888
    ds_read_b128 v[212:215], v4 offset:37888
    v_mfma_f32_16x16x32_bf16 v[64:67], a[4:7], v[52:55], v[64:67]
    ds_read_b128 v[244:247], v5 offset:37888
    ds_read_b128 v[252:255], v6 offset:37888
    v_mfma_f32_16x16x32_bf16 v[64:67], a[8:11], v[56:59], v[64:67]
    v_mul_f32 v119, v119, v156
    v_mul_f32 v120, v120, v156
    v_mfma_f32_16x16x32_bf16 v[64:67], a[12:15], v[60:63], v[64:67]
    v_mul_f32 v121, v121, v156
    v_mul_f32 v122, v122, v156
    v_mul_f32 v123, v123, v156
    v_cvt_pk_bf16_f32 v116, v116, v117
    v_cvt_pk_bf16_f32 v117, v118, v119
    v_cvt_pk_bf16_f32 v118, v120, v121
    v_cvt_pk_bf16_f32 v119, v122, v123
    v_mfma_f32_16x16x32_bf16 v[68:71], a[28:31], v[60:63], 0
    v_mul_f32 v124, v124, v157
    v_mul_f32 v125, v125, v157
    v_mfma_f32_16x16x32_bf16 v[68:71], a[24:27], v[56:59], v[68:71]
    v_mul_f32 v126, v126, v157
    v_mul_f32 v127, v127, v157
    v_mfma_f32_16x16x32_bf16 v[68:71], a[20:23], v[52:55], v[68:71]
    v_exp_f32 v64, v64
    v_mfma_f32_16x16x32_bf16 v[68:71], a[16:19], v[48:51], v[68:71]
    buffer_store_dwordx4 v[116:119], v10, s[20:23], s31 offen
    v_smfmac_f32_16x16x64_bf16 v[196:199], v[24:27], v[92:99], v23
    s_waitcnt lgkmcnt(5)
    v_exp_f32 v65, v65
    v_exp_f32 v66, v66
    v_exp_f32 v67, v67
    v_mfma_f32_16x16x32_bf16 v[164:167], a[152:155], v[216:219], v[164:167]
    v_perm_b32 v100, v65, v64, s35
    v_perm_b32 v101, v67, v66, s35
    v_mfma_f32_16x16x32_bf16 v[164:167], a[184:187], v[208:211], v[164:167]
    v_exp_f32 v68, v68
    v_mfma_f32_16x16x32_bf16 v[164:167], a[216:219], v[240:243], v[164:167]
    v_exp_f32 v69, v69
    v_mfma_f32_16x16x32_bf16 v[164:167], a[248:251], v[248:251], v[164:167]
    v_exp_f32 v70, v70
    v_exp_f32 v71, v71
    v_perm_b32 v102, v69, v68, s35
    v_mul_f32 v128, v128, v157
    v_mul_f32 v129, v129, v157
    v_mfma_f32_16x16x32_bf16 v[168:171], a[252:255], v[248:251], v[168:171]
    v_perm_b32 v103, v71, v70, s35
    v_mul_f32 v130, v130, v157
    v_mfma_f32_16x16x32_bf16 v[168:171], a[220:223], v[240:243], v[168:171]
    v_mul_f32 v131, v131, v157
    v_cvt_pk_bf16_f32 v124, v124, v125
    v_mfma_f32_16x16x32_bf16 v[168:171], a[188:191], v[208:211], v[168:171]
    v_cvt_pk_bf16_f32 v125, v126, v127
    v_cvt_pk_bf16_f32 v126, v128, v129
    v_mfma_f32_16x16x32_bf16 v[168:171], a[156:159], v[216:219], v[168:171]
    ds_write_b128 v3, v[100:103] offset:4096
    v_cvt_pk_bf16_f32 v127, v130, v131
    s_mov_b32 s31, 0x6000
    v_mfma_f32_16x16x32_bf16 v[72:75], a[32:35], v[48:51], 0
    ds_read_b128 v[216:219], v3 offset:38912
    ds_read_b128 v[208:211], v4 offset:38912
    v_mfma_f32_16x16x32_bf16 v[72:75], a[36:39], v[52:55], v[72:75]
    ds_read_b128 v[240:243], v5 offset:38912
    ds_read_b128 v[248:251], v6 offset:38912
    v_mfma_f32_16x16x32_bf16 v[72:75], a[40:43], v[56:59], v[72:75]
    v_mul_f32 v132, v132, v160
    v_mul_f32 v133, v133, v160
    v_mfma_f32_16x16x32_bf16 v[72:75], a[44:47], v[60:63], v[72:75]
    buffer_store_dwordx4 v[124:127], v10, s[20:23], s32 offen
    v_mfma_f32_16x16x32_bf16 v[76:79], a[60:63], v[60:63], 0
    s_mov_b32 s32, 0x7000
    v_mul_f32 v134, v134, v160
    v_mfma_f32_16x16x32_bf16 v[76:79], a[56:59], v[56:59], v[76:79]
    v_mul_f32 v135, v135, v160
    v_mul_f32 v136, v136, v160
    v_mfma_f32_16x16x32_bf16 v[76:79], a[52:55], v[52:55], v[76:79]
    v_exp_f32 v72, v72
    v_mfma_f32_16x16x32_bf16 v[76:79], a[48:51], v[48:51], v[76:79]
    s_waitcnt lgkmcnt(5)
    v_exp_f32 v73, v73
    v_exp_f32 v74, v74
    v_exp_f32 v75, v75
    v_mul_f32 v137, v137, v160
    v_mfma_f32_16x16x32_bf16 v[172:175], a[152:155], v[220:223], v[172:175]
    v_perm_b32 v104, v73, v72, s35
    v_perm_b32 v105, v75, v74, s35
    v_mfma_f32_16x16x32_bf16 v[172:175], a[184:187], v[212:215], v[172:175]
    v_mul_f32 v138, v138, v160
    v_mul_f32 v139, v139, v160
    v_mfma_f32_16x16x32_bf16 v[172:175], a[216:219], v[244:247], v[172:175]
    v_exp_f32 v76, v76
    v_mfma_f32_16x16x32_bf16 v[172:175], a[248:251], v[252:255], v[172:175]
    v_exp_f32 v77, v77
    v_exp_f32 v78, v78
    v_exp_f32 v79, v79
    v_cvt_pk_bf16_f32 v132, v132, v133
    v_mfma_f32_16x16x32_bf16 v[176:179], a[252:255], v[252:255], v[176:179]
    v_perm_b32 v106, v77, v76, s35
    v_perm_b32 v107, v79, v78, s35
    v_mfma_f32_16x16x32_bf16 v[176:179], a[220:223], v[244:247], v[176:179]
    v_cvt_pk_bf16_f32 v133, v134, v135
    v_cvt_pk_bf16_f32 v134, v136, v137
    v_mfma_f32_16x16x32_bf16 v[176:179], a[188:191], v[212:215], v[176:179]
    v_xor_b32 v2, 0x4000, v2
    v_cvt_pk_bf16_f32 v135, v138, v139
    v_mfma_f32_16x16x32_bf16 v[176:179], a[156:159], v[220:223], v[176:179]
    ds_write_b128 v3, v[104:107] offset:5120
    v_mul_f32 v140, v140, v161
    v_mul_f32 v141, v141, v161
    v_mfma_f32_16x16x32_bf16 v[64:67], a[64:67], v[48:51], 0
    ds_read_b128 v[220:223], v3 offset:39936
    ds_read_b128 v[212:215], v4 offset:39936
    ds_read_b128 v[32:35], v2 offset:8192
    v_mfma_f32_16x16x32_bf16 v[64:67], a[68:71], v[52:55], v[64:67]
    ds_read_b128 v[244:247], v5 offset:39936
    ds_read_b128 v[252:255], v6 offset:39936
    v_mfma_f32_16x16x32_bf16 v[64:67], a[72:75], v[56:59], v[64:67]
    ds_read_b128 v[36:39], v2 offset:8704
    v_mul_f32 v142, v142, v161
    v_mfma_f32_16x16x32_bf16 v[64:67], a[76:79], v[60:63], v[64:67]
    buffer_store_dwordx4 v[132:135], v10, s[20:23], s31 offen
    v_mfma_f32_16x16x32_bf16 v[68:71], a[92:95], v[60:63], 0
    ds_read_b128 v[40:43], v2 offset:10240
    v_mul_f32 v143, v143, v161
    v_mfma_f32_16x16x32_bf16 v[68:71], a[88:91], v[56:59], v[68:71]
    v_mul_f32 v144, v144, v161
    v_mul_f32 v145, v145, v161
    v_mfma_f32_16x16x32_bf16 v[68:71], a[84:87], v[52:55], v[68:71]
    ds_read_b128 v[44:47], v2 offset:10752
    v_mul_f32 v146, v146, v161
    v_mfma_f32_16x16x32_bf16 v[68:71], a[80:83], v[48:51], v[68:71]
    v_exp_f32 v64, v64
    v_exp_f32 v65, v65
    v_exp_f32 v66, v66
    v_mul_f32 v147, v147, v161
    v_smfmac_f32_16x16x64_bf16 v[196:199], v[28:31], v[100:107], v23
    s_waitcnt lgkmcnt(9)
    v_exp_f32 v67, v67
    v_perm_b32 v108, v65, v64, s35
    v_cvt_pk_bf16_f32 v140, v140, v141
    v_cvt_pk_bf16_f32 v141, v142, v143
    v_cvt_pk_bf16_f32 v142, v144, v145
    v_mfma_f32_16x16x32_bf16 v[180:183], a[152:155], v[216:219], v[180:183]
    v_perm_b32 v109, v67, v66, s35
    v_cvt_pk_bf16_f32 v143, v146, v147
    v_mfma_f32_16x16x32_bf16 v[180:183], a[184:187], v[208:211], v[180:183]
    v_exp_f32 v68, v68
    v_mfma_f32_16x16x32_bf16 v[180:183], a[216:219], v[240:243], v[180:183]
    v_exp_f32 v69, v69
    v_mfma_f32_16x16x32_bf16 v[180:183], a[248:251], v[248:251], v[180:183]
    buffer_store_dwordx4 v[140:143], v10, s[20:23], s32 offen
    v_mfma_f32_16x16x32_bf16 v[184:187], a[252:255], v[248:251], v[184:187]
    v_exp_f32 v70, v70
    v_mfma_f32_16x16x32_bf16 v[184:187], a[220:223], v[240:243], v[184:187]
    v_exp_f32 v71, v71
    v_mfma_f32_16x16x32_bf16 v[184:187], a[188:191], v[208:211], v[184:187]
    v_perm_b32 v110, v69, v68, s35
    v_perm_b32 v111, v71, v70, s35
    v_mfma_f32_16x16x32_bf16 v[184:187], a[156:159], v[216:219], v[184:187]
    ds_write_b128 v3, v[108:111] offset:6144
    s_mov_b32 s31, 0x8000
    s_mov_b32 s32, 0x9000
    v_mfma_f32_16x16x32_bf16 v[72:75], a[96:99], v[48:51], 0
    v_mul_f32 v164, v164, v224
    v_mul_f32 v165, v165, v224
    v_mfma_f32_16x16x32_bf16 v[72:75], a[100:103], v[52:55], v[72:75]
    v_mul_f32 v166, v166, v224
    v_mul_f32 v167, v167, v224
    v_mfma_f32_16x16x32_bf16 v[72:75], a[104:107], v[56:59], v[72:75]
    v_mul_f32 v168, v168, v224
    v_mul_f32 v169, v169, v224
    v_mfma_f32_16x16x32_bf16 v[72:75], a[108:111], v[60:63], v[72:75]
    v_mul_f32 v170, v170, v224
    v_mul_f32 v171, v171, v224
    v_cvt_pk_bf16_f32 v164, v164, v165
    v_cvt_pk_bf16_f32 v165, v166, v167
    v_cvt_pk_bf16_f32 v166, v168, v169
    v_cvt_pk_bf16_f32 v167, v170, v171
    v_mul_f32 v172, v172, v225
    v_mfma_f32_16x16x32_bf16 v[76:79], a[124:127], v[60:63], 0
    v_mul_f32 v173, v173, v225
    v_mul_f32 v174, v174, v225
    v_mfma_f32_16x16x32_bf16 v[76:79], a[120:123], v[56:59], v[76:79]
    v_mul_f32 v175, v175, v225
    v_mul_f32 v176, v176, v225
    v_mfma_f32_16x16x32_bf16 v[76:79], a[116:119], v[52:55], v[76:79]
    ds_read_b128 v[200:203], v8 offset:29184
    v_mul_f32 v177, v177, v225
    v_mfma_f32_16x16x32_bf16 v[76:79], a[112:115], v[48:51], v[76:79]
    s_waitcnt lgkmcnt(5)
    buffer_store_dwordx4 v[164:167], v10, s[20:23], s31 offen
    v_mfma_f32_16x16x32_bf16 v[188:191], a[152:155], v[220:223], v[188:191]
    v_exp_f32 v72, v72
    v_mfma_f32_16x16x32_bf16 v[188:191], a[184:187], v[212:215], v[188:191]
    v_exp_f32 v73, v73
    v_mfma_f32_16x16x32_bf16 v[188:191], a[216:219], v[244:247], v[188:191]
    v_exp_f32 v74, v74
    v_mfma_f32_16x16x32_bf16 v[188:191], a[248:251], v[252:255], v[188:191]
    v_exp_f32 v75, v75
    v_perm_b32 v112, v73, v72, s35
    v_exp_f32 v76, v76
    v_exp_f32 v77, v77
    v_mfma_f32_16x16x32_bf16 v[192:195], a[252:255], v[252:255], v[192:195]
    v_perm_b32 v113, v75, v74, s35
    v_mul_f32 v178, v178, v225
    v_mfma_f32_16x16x32_bf16 v[192:195], a[220:223], v[244:247], v[192:195]
    ds_read_b128 v[48:51], v2 offset:12288
    ds_read_b128 v[52:55], v2 offset:12800
    v_mfma_f32_16x16x32_bf16 v[192:195], a[188:191], v[212:215], v[192:195]
    ds_read_b128 v[56:59], v2 offset:14336
    ds_read_b128 v[60:63], v2 offset:14848
    v_mfma_f32_16x16x32_bf16 v[192:195], a[156:159], v[220:223], v[192:195]
    s_waitcnt lgkmcnt(4)
    v_mul_f32 v179, v179, v225
    v_cvt_pk_bf16_f32 v172, v172, v173
    v_cvt_pk_bf16_f32 v173, v174, v175
    v_cvt_pk_bf16_f32 v174, v176, v177
    v_cvt_pk_bf16_f32 v175, v178, v179
    buffer_store_dwordx4 v[172:175], v10, s[20:23], s32 offen
    s_mov_b32 s33, 18
L_loopA0:
    v_mfma_f32_16x16x32_bf16 v[64:67], a[0:3], v[32:35], 0
    v_exp_f32 v78, v78
    v_mfma_f32_16x16x32_bf16 v[64:67], a[4:7], v[36:39], v[64:67]
    v_exp_f32 v79, v79
    v_mfma_f32_16x16x32_bf16 v[64:67], a[8:11], v[40:43], v[64:67]
    v_perm_b32 v114, v77, v76, s35
    v_perm_b32 v115, v79, v78, s35
    v_mfma_f32_16x16x32_bf16 v[64:67], a[12:15], v[44:47], v[64:67]
    v_add_f32 v200, v200, v201
    v_add_f32 v202, v202, v203
    v_smfmac_f32_16x16x64_bf16 v[196:199], v[28:31], v[108:115], v23
    v_add_f32 v17, v200, v202
    v_mfma_f32_16x16x32_bf16 v[68:71], a[28:31], v[44:47], 0
    v_rcp_f32 v19, v17
    v_mfma_f32_16x16x32_bf16 v[68:71], a[24:27], v[40:43], v[68:71]
    v_max3_u32 v11, v11, v17, v19
    v_mov_b32 v20, v19
    v_mfma_f32_16x16x32_bf16 v[68:71], a[20:23], v[36:39], v[68:71]
    v_add_f32 v198, v196, v197
    v_mov_b64 v[196:197], 0
    v_mfma_f32_16x16x32_bf16 v[68:71], a[16:19], v[32:35], v[68:71]
    ds_write_b128 v3, v[112:115] offset:7168
    v_mfma_f32_16x16x32_bf16 v[164:167], a[128:131], v[80:83], 0
    ds_write_b32 v7, v198 offset:28672
    v_mfma_f32_16x16x32_bf16 v[164:167], a[136:139], v[84:87], v[164:167]
    v_exp_f32 v64, v64
    v_mfma_f32_16x16x32_bf16 v[164:167], a[144:147], v[92:95], v[164:167]
    v_exp_f32 v65, v65
    v_mfma_f32_16x16x32_bf16 v[164:167], a[152:155], v[96:99], v[164:167]
    v_exp_f32 v66, v66
    v_mfma_f32_16x16x32_bf16 v[168:171], a[156:159], v[96:99], 0
    v_exp_f32 v67, v67
    v_mfma_f32_16x16x32_bf16 v[168:171], a[148:151], v[92:95], v[168:171]
    v_perm_b32 v88, v65, v64, s35
    v_perm_b32 v89, v67, v66, s35
    v_mfma_f32_16x16x32_bf16 v[168:171], a[140:143], v[84:87], v[168:171]
    s_waitcnt vmcnt(9) lgkmcnt(0)
    v_exp_f32 v68, v68
    v_mfma_f32_16x16x32_bf16 v[168:171], a[132:135], v[80:83], v[168:171]
    s_barrier
    v_mfma_f32_16x16x32_bf16 v[72:75], a[32:35], v[32:35], 0
    v_exp_f32 v69, v69
    v_mfma_f32_16x16x32_bf16 v[72:75], a[36:39], v[36:39], v[72:75]
    v_exp_f32 v70, v70
    v_mfma_f32_16x16x32_bf16 v[72:75], a[40:43], v[40:43], v[72:75]
    v_exp_f32 v71, v71
    v_mfma_f32_16x16x32_bf16 v[72:75], a[44:47], v[44:47], v[72:75]
    v_perm_b32 v90, v69, v68, s35
    v_perm_b32 v91, v71, v70, s35
    v_mfma_f32_16x16x32_bf16 v[76:79], a[60:63], v[44:47], 0
    v_permlane32_swap_b32 v19, v20
    v_mfma_f32_16x16x32_bf16 v[76:79], a[56:59], v[40:43], v[76:79]
    ds_read_b128 v[116:119], v4 offset:0
    ds_read_b128 v[120:123], v4 offset:1024
    v_mfma_f32_16x16x32_bf16 v[76:79], a[52:55], v[36:39], v[76:79]
    ds_read_b128 v[124:127], v4 offset:2048
    ds_read_b128 v[128:131], v4 offset:3072
    v_mfma_f32_16x16x32_bf16 v[76:79], a[48:51], v[32:35], v[76:79]
    ds_write_b128 v3, v[88:91] offset:32768
    v_mfma_f32_16x16x32_bf16 v[172:175], a[128:131], v[100:103], 0
    v_exp_f32 v72, v72
    v_mfma_f32_16x16x32_bf16 v[172:175], a[136:139], v[104:107], v[172:175]
    s_add_u32 s29, s29, 0x2000
    v_exp_f32 v73, v73
    v_mfma_f32_16x16x32_bf16 v[172:175], a[144:147], v[108:111], v[172:175]
    v_exp_f32 v74, v74
    v_mfma_f32_16x16x32_bf16 v[172:175], a[152:155], v[112:115], v[172:175]
    s_add_u32 s30, s30, 0x2000
    v_exp_f32 v75, v75
    v_mfma_f32_16x16x32_bf16 v[176:179], a[156:159], v[112:115], 0
    v_perm_b32 v84, v73, v72, s35
    v_perm_b32 v85, v75, v74, s35
    v_mfma_f32_16x16x32_bf16 v[176:179], a[148:151], v[108:111], v[176:179]
    s_add_u32 s31, s31, 0x2000
    ds_read_b128 v[132:135], v5 offset:0
    ds_read_b128 v[136:139], v5 offset:1024
    v_mfma_f32_16x16x32_bf16 v[176:179], a[140:143], v[104:107], v[176:179]
    s_and_b32 s30, s30, 0x7fff
    v_exp_f32 v76, v76
    v_mfma_f32_16x16x32_bf16 v[176:179], a[132:135], v[100:103], v[176:179]
    v_exp_f32 v77, v77
    v_mfma_f32_16x16x32_bf16 v[64:67], a[64:67], v[32:35], 0
    v_exp_f32 v78, v78
    v_mfma_f32_16x16x32_bf16 v[64:67], a[68:71], v[36:39], v[64:67]
    s_add_u32 s32, s32, 0x2000
    v_exp_f32 v79, v79
    v_mfma_f32_16x16x32_bf16 v[64:67], a[72:75], v[40:43], v[64:67]
    v_perm_b32 v86, v77, v76, s35
    v_perm_b32 v87, v79, v78, s35
    v_mfma_f32_16x16x32_bf16 v[64:67], a[76:79], v[44:47], v[64:67]
    ds_write_b128 v3, v[84:87] offset:33792
    v_mfma_f32_16x16x32_bf16 v[68:71], a[92:95], v[44:47], 0
    ds_read_b128 v[140:143], v5 offset:2048
    ds_read_b128 v[144:147], v5 offset:3072
    v_mfma_f32_16x16x32_bf16 v[68:71], a[88:91], v[40:43], v[68:71]
    s_mov_b32 m0, s30
    v_mul_f32 v180, v180, v19
    v_mul_f32 v181, v181, v19
    v_mfma_f32_16x16x32_bf16 v[68:71], a[84:87], v[36:39], v[68:71]
    v_exp_f32 v64, v64
    v_mfma_f32_16x16x32_bf16 v[68:71], a[80:83], v[32:35], v[68:71]
    v_exp_f32 v65, v65
    v_smfmac_f32_16x16x64_bf16 v[196:199], v[24:27], v[84:91], v23
    v_mul_f32 v182, v182, v19
    v_mfma_f32_16x16x32_bf16 v[72:75], a[96:99], v[32:35], 0
    v_exp_f32 v66, v66
    v_mfma_f32_16x16x32_bf16 v[72:75], a[100:103], v[36:39], v[72:75]
    ds_read_b128 v[148:151], v6 offset:0
    ds_read_b128 v[152:155], v6 offset:1024
    v_mfma_f32_16x16x32_bf16 v[72:75], a[104:107], v[40:43], v[72:75]
    ds_read_b128 v[156:159], v6 offset:2048
    ds_read_b128 v[160:163], v6 offset:3072
    v_mfma_f32_16x16x32_bf16 v[72:75], a[108:111], v[44:47], v[72:75]
    s_waitcnt lgkmcnt(10)
    buffer_load_dwordx4 v9, s[8:11], s29 offen lds
    v_mfma_f32_16x16x32_bf16 v[164:167], a[160:163], v[116:119], v[164:167]
    v_exp_f32 v67, v67
    v_mfma_f32_16x16x32_bf16 v[164:167], a[168:171], v[120:123], v[164:167]
    v_perm_b32 v92, v65, v64, s35
    v_perm_b32 v93, v67, v66, s35
    v_mfma_f32_16x16x32_bf16 v[164:167], a[176:179], v[124:127], v[164:167]
    v_exp_f32 v68, v68
    v_mfma_f32_16x16x32_bf16 v[164:167], a[184:187], v[128:131], v[164:167]
    s_waitcnt lgkmcnt(4)
    v_exp_f32 v69, v69
    v_mfma_f32_16x16x32_bf16 v[164:167], a[192:195], v[132:135], v[164:167]
    v_mfma_f32_16x16x32_bf16 v[164:167], a[200:203], v[136:139], v[164:167]
    v_exp_f32 v70, v70
    v_mfma_f32_16x16x32_bf16 v[164:167], a[208:211], v[140:143], v[164:167]
    v_exp_f32 v71, v71
    v_mfma_f32_16x16x32_bf16 v[164:167], a[216:219], v[144:147], v[164:167]
    s_waitcnt lgkmcnt(0)
    v_perm_b32 v94, v69, v68, s35
    v_perm_b32 v95, v71, v70, s35
    v_mfma_f32_16x16x32_bf16 v[164:167], a[224:227], v[148:151], v[164:167]
    v_exp_f32 v72, v72
    v_mfma_f32_16x16x32_bf16 v[164:167], a[232:235], v[152:155], v[164:167]
    v_exp_f32 v73, v73
    v_mfma_f32_16x16x32_bf16 v[164:167], a[240:243], v[156:159], v[164:167]
    v_exp_f32 v74, v74
    v_mfma_f32_16x16x32_bf16 v[164:167], a[248:251], v[160:163], v[164:167]
    ds_write_b128 v3, v[92:95] offset:34816
    v_mfma_f32_16x16x32_bf16 v[76:79], a[112:115], v[32:35], 0
    v_exp_f32 v75, v75
    v_mfma_f32_16x16x32_bf16 v[76:79], a[116:119], v[36:39], v[76:79]
    v_perm_b32 v96, v73, v72, s35
    v_perm_b32 v97, v75, v74, s35
    v_mfma_f32_16x16x32_bf16 v[76:79], a[120:123], v[40:43], v[76:79]
    v_mul_f32 v183, v183, v19
    v_mul_f32 v184, v184, v19
    v_mfma_f32_16x16x32_bf16 v[76:79], a[124:127], v[44:47], v[76:79]
    v_mul_f32 v185, v185, v19
    v_mul_f32 v186, v186, v19
    v_mfma_f32_16x16x32_bf16 v[64:67], a[0:3], v[48:51], 0
    v_mul_f32 v187, v187, v19
    v_cvt_pk_bf16_f32 v208, v180, v181
    v_mfma_f32_16x16x32_bf16 v[64:67], a[4:7], v[52:55], v[64:67]
    v_cvt_pk_bf16_f32 v209, v182, v183
    v_cvt_pk_bf16_f32 v210, v184, v185
    v_mfma_f32_16x16x32_bf16 v[64:67], a[8:11], v[56:59], v[64:67]
    v_exp_f32 v76, v76
    v_mfma_f32_16x16x32_bf16 v[64:67], a[12:15], v[60:63], v[64:67]
    v_exp_f32 v77, v77
    v_mfma_f32_16x16x32_bf16 v[68:71], a[28:31], v[60:63], 0
    v_exp_f32 v78, v78
    v_mfma_f32_16x16x32_bf16 v[68:71], a[24:27], v[56:59], v[68:71]
    v_exp_f32 v79, v79
    v_mfma_f32_16x16x32_bf16 v[68:71], a[20:23], v[52:55], v[68:71]
    v_perm_b32 v98, v77, v76, s35
    v_perm_b32 v99, v79, v78, s35
    v_mfma_f32_16x16x32_bf16 v[68:71], a[16:19], v[48:51], v[68:71]
    ds_write_b128 v3, v[96:99] offset:35840
    v_mfma_f32_16x16x32_bf16 v[168:171], a[164:167], v[116:119], v[168:171]
    v_exp_f32 v64, v64
    v_mfma_f32_16x16x32_bf16 v[168:171], a[172:175], v[120:123], v[168:171]
    v_exp_f32 v65, v65
    v_mfma_f32_16x16x32_bf16 v[168:171], a[180:183], v[124:127], v[168:171]
    v_exp_f32 v66, v66
    v_mfma_f32_16x16x32_bf16 v[168:171], a[188:191], v[128:131], v[168:171]
    v_exp_f32 v67, v67
    v_mfma_f32_16x16x32_bf16 v[168:171], a[196:199], v[132:135], v[168:171]
    v_perm_b32 v100, v65, v64, s35
    v_perm_b32 v101, v67, v66, s35
    v_mfma_f32_16x16x32_bf16 v[168:171], a[204:207], v[136:139], v[168:171]
    ds_read_b128 v[116:119], v4 offset:4096
    ds_read_b128 v[120:123], v4 offset:5120
    v_mfma_f32_16x16x32_bf16 v[168:171], a[212:215], v[140:143], v[168:171]
    ds_read_b128 v[124:127], v4 offset:6144
    ds_read_b128 v[128:131], v4 offset:7168
    v_mfma_f32_16x16x32_bf16 v[168:171], a[220:223], v[144:147], v[168:171]
    ds_read_b128 v[132:135], v5 offset:4096
    ds_read_b128 v[136:139], v5 offset:5120
    v_mfma_f32_16x16x32_bf16 v[168:171], a[228:231], v[148:151], v[168:171]
    ds_read_b128 v[140:143], v5 offset:6144
    ds_read_b128 v[144:147], v5 offset:7168
    v_mfma_f32_16x16x32_bf16 v[168:171], a[236:239], v[152:155], v[168:171]
    v_exp_f32 v68, v68
    v_mfma_f32_16x16x32_bf16 v[168:171], a[244:247], v[156:159], v[168:171]
    v_exp_f32 v69, v69
    v_mfma_f32_16x16x32_bf16 v[168:171], a[252:255], v[160:163], v[168:171]
    v_exp_f32 v70, v70
    v_smfmac_f32_16x16x64_bf16 v[196:199], v[24:27], v[92:99], v23
    v_cvt_pk_bf16_f32 v211, v186, v187
    v_mfma_f32_16x16x32_bf16 v[72:75], a[32:35], v[48:51], 0
    v_exp_f32 v71, v71
    v_mfma_f32_16x16x32_bf16 v[72:75], a[36:39], v[52:55], v[72:75]
    v_perm_b32 v102, v69, v68, s35
    v_perm_b32 v103, v71, v70, s35
    v_mfma_f32_16x16x32_bf16 v[72:75], a[40:43], v[56:59], v[72:75]
    ds_read_b128 v[148:151], v6 offset:4096
    ds_read_b128 v[152:155], v6 offset:5120
    v_mfma_f32_16x16x32_bf16 v[72:75], a[44:47], v[60:63], v[72:75]
    ds_write_b128 v3, v[100:103] offset:36864
    v_mfma_f32_16x16x32_bf16 v[76:79], a[60:63], v[60:63], 0
    ds_read_b128 v[156:159], v6 offset:6144
    ds_read_b128 v[160:163], v6 offset:7168
    v_mfma_f32_16x16x32_bf16 v[76:79], a[56:59], v[56:59], v[76:79]
    v_mul_f32 v188, v188, v20
    v_mul_f32 v189, v189, v20
    v_mfma_f32_16x16x32_bf16 v[76:79], a[52:55], v[52:55], v[76:79]
    v_exp_f32 v72, v72
    v_mfma_f32_16x16x32_bf16 v[76:79], a[48:51], v[48:51], v[76:79]
    v_exp_f32 v73, v73
    v_mfma_f32_16x16x32_bf16 v[64:67], a[64:67], v[48:51], 0
    v_exp_f32 v74, v74
    v_mfma_f32_16x16x32_bf16 v[64:67], a[68:71], v[52:55], v[64:67]
    v_exp_f32 v75, v75
    v_mfma_f32_16x16x32_bf16 v[64:67], a[72:75], v[56:59], v[64:67]
    v_perm_b32 v104, v73, v72, s35
    v_perm_b32 v105, v75, v74, s35
    v_mfma_f32_16x16x32_bf16 v[64:67], a[76:79], v[60:63], v[64:67]
    s_waitcnt lgkmcnt(9)
    buffer_store_dwordx4 v[208:211], v10, s[20:23], s31 offen sc1 nt
    v_mfma_f32_16x16x32_bf16 v[172:175], a[160:163], v[116:119], v[172:175]
    v_exp_f32 v76, v76
    v_mfma_f32_16x16x32_bf16 v[172:175], a[168:171], v[120:123], v[172:175]
    v_exp_f32 v77, v77
    v_mfma_f32_16x16x32_bf16 v[172:175], a[176:179], v[124:127], v[172:175]
    v_exp_f32 v78, v78
    v_mfma_f32_16x16x32_bf16 v[172:175], a[184:187], v[128:131], v[172:175]
    s_waitcnt lgkmcnt(5)
    v_exp_f32 v79, v79
    v_mfma_f32_16x16x32_bf16 v[172:175], a[192:195], v[132:135], v[172:175]
    v_perm_b32 v106, v77, v76, s35
    v_perm_b32 v107, v79, v78, s35
    v_mfma_f32_16x16x32_bf16 v[172:175], a[200:203], v[136:139], v[172:175]
    v_exp_f32 v64, v64
    v_mfma_f32_16x16x32_bf16 v[172:175], a[208:211], v[140:143], v[172:175]
    v_exp_f32 v65, v65
    v_mfma_f32_16x16x32_bf16 v[172:175], a[216:219], v[144:147], v[172:175]
    s_waitcnt lgkmcnt(0)
    v_exp_f32 v66, v66
    v_mfma_f32_16x16x32_bf16 v[172:175], a[224:227], v[148:151], v[172:175]
    v_exp_f32 v67, v67
    v_mfma_f32_16x16x32_bf16 v[172:175], a[232:235], v[152:155], v[172:175]
    v_perm_b32 v108, v65, v64, s35
    v_perm_b32 v109, v67, v66, s35
    v_mfma_f32_16x16x32_bf16 v[172:175], a[240:243], v[156:159], v[172:175]
    v_mul_f32 v190, v190, v20
    v_mul_f32 v191, v191, v20
    v_mfma_f32_16x16x32_bf16 v[172:175], a[248:251], v[160:163], v[172:175]
    ds_write_b128 v3, v[104:107] offset:37888
    v_mfma_f32_16x16x32_bf16 v[68:71], a[80:83], v[48:51], 0
    ds_read_b128 v[200:203], v8 offset:28672
    v_mul_f32 v192, v192, v20
    v_mfma_f32_16x16x32_bf16 v[68:71], a[84:87], v[52:55], v[68:71]
    v_mul_f32 v193, v193, v20
    v_mul_f32 v194, v194, v20
    v_mfma_f32_16x16x32_bf16 v[68:71], a[88:91], v[56:59], v[68:71]
L_s5:
    s_cbranch_execz L_ce4A
L_s5_n:
    v_mul_f32 v195, v195, v20
    v_cvt_pk_bf16_f32 v212, v188, v189
    v_mfma_f32_16x16x32_bf16 v[68:71], a[92:95], v[60:63], v[68:71]
    v_cvt_pk_bf16_f32 v213, v190, v191
    v_smfmac_f32_16x16x64_bf16 v[196:199], v[28:31], v[100:107], v23
    v_xor_b32 v2, 0x4000, v2
    v_mfma_f32_16x16x32_bf16 v[72:75], a[108:111], v[60:63], 0
    v_cvt_pk_bf16_f32 v214, v192, v193
    v_cvt_pk_bf16_f32 v215, v194, v195
    v_mfma_f32_16x16x32_bf16 v[72:75], a[104:107], v[56:59], v[72:75]
    ds_read_b128 v[32:35], v2 offset:0
    ds_read_b128 v[36:39], v2 offset:512
    v_mfma_f32_16x16x32_bf16 v[72:75], a[100:103], v[52:55], v[72:75]
    v_exp_f32 v68, v68
    v_mfma_f32_16x16x32_bf16 v[72:75], a[96:99], v[48:51], v[72:75]
    v_exp_f32 v69, v69
    v_mfma_f32_16x16x32_bf16 v[76:79], a[112:115], v[48:51], 0
    v_exp_f32 v70, v70
    v_mfma_f32_16x16x32_bf16 v[76:79], a[116:119], v[52:55], v[76:79]
    v_exp_f32 v71, v71
    v_mfma_f32_16x16x32_bf16 v[76:79], a[120:123], v[56:59], v[76:79]
    v_perm_b32 v110, v69, v68, s35
    v_perm_b32 v111, v71, v70, s35
    v_mfma_f32_16x16x32_bf16 v[76:79], a[124:127], v[60:63], v[76:79]
    ds_write_b128 v3, v[108:111] offset:38912
    v_mfma_f32_16x16x32_bf16 v[176:179], a[164:167], v[116:119], v[176:179]
    ds_read_b128 v[40:43], v2 offset:2048
    ds_read_b128 v[44:47], v2 offset:2560
    v_mfma_f32_16x16x32_bf16 v[176:179], a[172:175], v[120:123], v[176:179]
    v_exp_f32 v72, v72
    v_mfma_f32_16x16x32_bf16 v[176:179], a[180:183], v[124:127], v[176:179]
    v_exp_f32 v73, v73
    v_mfma_f32_16x16x32_bf16 v[176:179], a[188:191], v[128:131], v[176:179]
    v_exp_f32 v74, v74
    v_mfma_f32_16x16x32_bf16 v[176:179], a[196:199], v[132:135], v[176:179]
    v_exp_f32 v75, v75
    v_mfma_f32_16x16x32_bf16 v[176:179], a[204:207], v[136:139], v[176:179]
    v_perm_b32 v112, v73, v72, s35
    v_perm_b32 v113, v75, v74, s35
    v_mfma_f32_16x16x32_bf16 v[176:179], a[212:215], v[140:143], v[176:179]
    v_exp_f32 v76, v76
    v_mfma_f32_16x16x32_bf16 v[176:179], a[220:223], v[144:147], v[176:179]
    v_exp_f32 v77, v77
    v_mfma_f32_16x16x32_bf16 v[176:179], a[228:231], v[148:151], v[176:179]
    buffer_load_dwordx4 v9, s[8:11], s29 offen offset:1024 lds
    v_mfma_f32_16x16x32_bf16 v[176:179], a[236:239], v[152:155], v[176:179]
    ds_read_b128 v[48:51], v2 offset:4096
    ds_read_b128 v[52:55], v2 offset:4608
    v_mfma_f32_16x16x32_bf16 v[176:179], a[244:247], v[156:159], v[176:179]
    ds_read_b128 v[56:59], v2 offset:6144
    ds_read_b128 v[60:63], v2 offset:6656
    v_mfma_f32_16x16x32_bf16 v[176:179], a[252:255], v[160:163], v[176:179]
    s_waitcnt lgkmcnt(4)
    buffer_store_dwordx4 v[212:215], v10, s[20:23], s32 offen sc1 nt
    v_mfma_f32_16x16x32_bf16 v[64:67], a[0:3], v[32:35], 0
    v_exp_f32 v78, v78
    v_mfma_f32_16x16x32_bf16 v[64:67], a[4:7], v[36:39], v[64:67]
    v_exp_f32 v79, v79
    v_mfma_f32_16x16x32_bf16 v[64:67], a[8:11], v[40:43], v[64:67]
    v_perm_b32 v114, v77, v76, s35
    v_perm_b32 v115, v79, v78, s35
    v_mfma_f32_16x16x32_bf16 v[64:67], a[12:15], v[44:47], v[64:67]
    v_add_f32 v200, v200, v201
    v_add_f32 v202, v202, v203
    v_smfmac_f32_16x16x64_bf16 v[196:199], v[28:31], v[108:115], v23
    v_add_f32 v17, v200, v202
    v_mfma_f32_16x16x32_bf16 v[68:71], a[28:31], v[44:47], 0
    v_rcp_f32 v19, v17
    v_mfma_f32_16x16x32_bf16 v[68:71], a[24:27], v[40:43], v[68:71]
    v_max3_u32 v11, v11, v17, v19
    v_mov_b32 v20, v19
    v_mfma_f32_16x16x32_bf16 v[68:71], a[20:23], v[36:39], v[68:71]
    v_add_f32 v198, v196, v197
    v_mov_b64 v[196:197], 0
    v_mfma_f32_16x16x32_bf16 v[68:71], a[16:19], v[32:35], v[68:71]
    ds_write_b128 v3, v[112:115] offset:39936
    v_mfma_f32_16x16x32_bf16 v[180:183], a[128:131], v[88:91], 0
    ds_write_b32 v7, v198 offset:29184
    v_mfma_f32_16x16x32_bf16 v[180:183], a[136:139], v[84:87], v[180:183]
    v_exp_f32 v64, v64
    v_mfma_f32_16x16x32_bf16 v[180:183], a[144:147], v[92:95], v[180:183]
    v_exp_f32 v65, v65
    v_mfma_f32_16x16x32_bf16 v[180:183], a[152:155], v[96:99], v[180:183]
    v_exp_f32 v66, v66
    v_mfma_f32_16x16x32_bf16 v[184:187], a[156:159], v[96:99], 0
    v_exp_f32 v67, v67
    v_mfma_f32_16x16x32_bf16 v[184:187], a[148:151], v[92:95], v[184:187]
    v_perm_b32 v80, v65, v64, s35
    v_perm_b32 v81, v67, v66, s35
    v_mfma_f32_16x16x32_bf16 v[184:187], a[140:143], v[84:87], v[184:187]
    s_waitcnt vmcnt(9) lgkmcnt(0)
    v_exp_f32 v68, v68
    v_mfma_f32_16x16x32_bf16 v[184:187], a[132:135], v[88:91], v[184:187]
    s_barrier
    v_mfma_f32_16x16x32_bf16 v[72:75], a[32:35], v[32:35], 0
    v_exp_f32 v69, v69
    v_mfma_f32_16x16x32_bf16 v[72:75], a[36:39], v[36:39], v[72:75]
    v_exp_f32 v70, v70
    v_mfma_f32_16x16x32_bf16 v[72:75], a[40:43], v[40:43], v[72:75]
    v_exp_f32 v71, v71
    v_mfma_f32_16x16x32_bf16 v[72:75], a[44:47], v[44:47], v[72:75]
    v_perm_b32 v82, v69, v68, s35
    v_perm_b32 v83, v71, v70, s35
    v_mfma_f32_16x16x32_bf16 v[76:79], a[60:63], v[44:47], 0
    v_permlane32_swap_b32 v19, v20
    v_mfma_f32_16x16x32_bf16 v[76:79], a[56:59], v[40:43], v[76:79]
    ds_read_b128 v[116:119], v4 offset:32768
    ds_read_b128 v[120:123], v4 offset:33792
    v_mfma_f32_16x16x32_bf16 v[76:79], a[52:55], v[36:39], v[76:79]
    ds_read_b128 v[124:127], v4 offset:34816
    ds_read_b128 v[128:131], v4 offset:35840
    v_mfma_f32_16x16x32_bf16 v[76:79], a[48:51], v[32:35], v[76:79]
    ds_write_b128 v3, v[80:83] offset:0
    v_mfma_f32_16x16x32_bf16 v[188:191], a[128:131], v[100:103], 0
    v_exp_f32 v72, v72
    v_mfma_f32_16x16x32_bf16 v[188:191], a[136:139], v[104:107], v[188:191]
    s_add_u32 s29, s29, 0x2000
    v_exp_f32 v73, v73
    v_mfma_f32_16x16x32_bf16 v[188:191], a[144:147], v[108:111], v[188:191]
    v_exp_f32 v74, v74
    v_mfma_f32_16x16x32_bf16 v[188:191], a[152:155], v[112:115], v[188:191]
    s_add_u32 s30, s30, 0x2000
    v_exp_f32 v75, v75
    v_mfma_f32_16x16x32_bf16 v[192:195], a[156:159], v[112:115], 0
    v_perm_b32 v84, v73, v72, s35
    v_perm_b32 v85, v75, v74, s35
    v_mfma_f32_16x16x32_bf16 v[192:195], a[148:151], v[108:111], v[192:195]
    s_add_u32 s31, s31, 0x2000
    ds_read_b128 v[132:135], v5 offset:32768
    ds_read_b128 v[136:139], v5 offset:33792
    v_mfma_f32_16x16x32_bf16 v[192:195], a[140:143], v[104:107], v[192:195]
    s_and_b32 s30, s30, 0x7fff
    v_exp_f32 v76, v76
    v_mfma_f32_16x16x32_bf16 v[192:195], a[132:135], v[100:103], v[192:195]
    v_exp_f32 v77, v77
    v_mfma_f32_16x16x32_bf16 v[64:67], a[64:67], v[32:35], 0
    v_exp_f32 v78, v78
    v_mfma_f32_16x16x32_bf16 v[64:67], a[68:71], v[36:39], v[64:67]
    s_add_u32 s32, s32, 0x2000
    v_exp_f32 v79, v79
    v_mfma_f32_16x16x32_bf16 v[64:67], a[72:75], v[40:43], v[64:67]
    v_perm_b32 v86, v77, v76, s35
    v_perm_b32 v87, v79, v78, s35
    v_mfma_f32_16x16x32_bf16 v[64:67], a[76:79], v[44:47], v[64:67]
    ds_write_b128 v3, v[84:87] offset:1024
    v_mfma_f32_16x16x32_bf16 v[68:71], a[92:95], v[44:47], 0
    ds_read_b128 v[140:143], v5 offset:34816
    ds_read_b128 v[144:147], v5 offset:35840
    v_mfma_f32_16x16x32_bf16 v[68:71], a[88:91], v[40:43], v[68:71]
    s_mov_b32 m0, s30
    v_mul_f32 v164, v164, v19
    v_mul_f32 v165, v165, v19
    v_mfma_f32_16x16x32_bf16 v[68:71], a[84:87], v[36:39], v[68:71]
    v_exp_f32 v64, v64
    v_mfma_f32_16x16x32_bf16 v[68:71], a[80:83], v[32:35], v[68:71]
    v_exp_f32 v65, v65
    v_smfmac_f32_16x16x64_bf16 v[196:199], v[24:27], v[80:87], v23
    v_mul_f32 v166, v166, v19
    v_mfma_f32_16x16x32_bf16 v[72:75], a[96:99], v[32:35], 0
    v_exp_f32 v66, v66
    v_mfma_f32_16x16x32_bf16 v[72:75], a[100:103], v[36:39], v[72:75]
    ds_read_b128 v[148:151], v6 offset:32768
    ds_read_b128 v[152:155], v6 offset:33792
    v_mfma_f32_16x16x32_bf16 v[72:75], a[104:107], v[40:43], v[72:75]
    ds_read_b128 v[156:159], v6 offset:34816
    ds_read_b128 v[160:163], v6 offset:35840
    v_mfma_f32_16x16x32_bf16 v[72:75], a[108:111], v[44:47], v[72:75]
    s_waitcnt lgkmcnt(10)
    buffer_load_dwordx4 v9, s[8:11], s29 offen lds
    v_mfma_f32_16x16x32_bf16 v[180:183], a[160:163], v[116:119], v[180:183]
    v_exp_f32 v67, v67
    v_mfma_f32_16x16x32_bf16 v[180:183], a[168:171], v[120:123], v[180:183]
    v_perm_b32 v92, v65, v64, s35
    v_perm_b32 v93, v67, v66, s35
    v_mfma_f32_16x16x32_bf16 v[180:183], a[176:179], v[124:127], v[180:183]
    v_exp_f32 v68, v68
    v_mfma_f32_16x16x32_bf16 v[180:183], a[184:187], v[128:131], v[180:183]
    s_waitcnt lgkmcnt(4)
    v_exp_f32 v69, v69
    v_mfma_f32_16x16x32_bf16 v[180:183], a[192:195], v[132:135], v[180:183]
    v_mfma_f32_16x16x32_bf16 v[180:183], a[200:203], v[136:139], v[180:183]
    v_exp_f32 v70, v70
    v_mfma_f32_16x16x32_bf16 v[180:183], a[208:211], v[140:143], v[180:183]
    v_exp_f32 v71, v71
    v_mfma_f32_16x16x32_bf16 v[180:183], a[216:219], v[144:147], v[180:183]
    s_waitcnt lgkmcnt(0)
    v_perm_b32 v94, v69, v68, s35
    v_perm_b32 v95, v71, v70, s35
    v_mfma_f32_16x16x32_bf16 v[180:183], a[224:227], v[148:151], v[180:183]
    v_exp_f32 v72, v72
    v_mfma_f32_16x16x32_bf16 v[180:183], a[232:235], v[152:155], v[180:183]
    v_exp_f32 v73, v73
    v_mfma_f32_16x16x32_bf16 v[180:183], a[240:243], v[156:159], v[180:183]
    v_exp_f32 v74, v74
    v_mfma_f32_16x16x32_bf16 v[180:183], a[248:251], v[160:163], v[180:183]
    ds_write_b128 v3, v[92:95] offset:2048
    v_mfma_f32_16x16x32_bf16 v[76:79], a[112:115], v[32:35], 0
    v_exp_f32 v75, v75
    v_mfma_f32_16x16x32_bf16 v[76:79], a[116:119], v[36:39], v[76:79]
    v_perm_b32 v96, v73, v72, s35
    v_perm_b32 v97, v75, v74, s35
    v_mfma_f32_16x16x32_bf16 v[76:79], a[120:123], v[40:43], v[76:79]
    v_mul_f32 v167, v167, v19
    v_mul_f32 v168, v168, v19
    v_mfma_f32_16x16x32_bf16 v[76:79], a[124:127], v[44:47], v[76:79]
    v_mul_f32 v169, v169, v19
    v_mul_f32 v170, v170, v19
    v_mfma_f32_16x16x32_bf16 v[64:67], a[0:3], v[48:51], 0
    v_mul_f32 v171, v171, v19
    v_cvt_pk_bf16_f32 v208, v164, v165
    v_mfma_f32_16x16x32_bf16 v[64:67], a[4:7], v[52:55], v[64:67]
    v_cvt_pk_bf16_f32 v209, v166, v167
    v_cvt_pk_bf16_f32 v210, v168, v169
    v_mfma_f32_16x16x32_bf16 v[64:67], a[8:11], v[56:59], v[64:67]
    v_exp_f32 v76, v76
    v_mfma_f32_16x16x32_bf16 v[64:67], a[12:15], v[60:63], v[64:67]
    v_exp_f32 v77, v77
    v_mfma_f32_16x16x32_bf16 v[68:71], a[28:31], v[60:63], 0
    v_exp_f32 v78, v78
    v_mfma_f32_16x16x32_bf16 v[68:71], a[24:27], v[56:59], v[68:71]
    v_exp_f32 v79, v79
    v_mfma_f32_16x16x32_bf16 v[68:71], a[20:23], v[52:55], v[68:71]
    v_perm_b32 v98, v77, v76, s35
    v_perm_b32 v99, v79, v78, s35
    v_mfma_f32_16x16x32_bf16 v[68:71], a[16:19], v[48:51], v[68:71]
    ds_write_b128 v3, v[96:99] offset:3072
    v_mfma_f32_16x16x32_bf16 v[184:187], a[164:167], v[116:119], v[184:187]
    v_exp_f32 v64, v64
    v_mfma_f32_16x16x32_bf16 v[184:187], a[172:175], v[120:123], v[184:187]
    v_exp_f32 v65, v65
    v_mfma_f32_16x16x32_bf16 v[184:187], a[180:183], v[124:127], v[184:187]
    v_exp_f32 v66, v66
    v_mfma_f32_16x16x32_bf16 v[184:187], a[188:191], v[128:131], v[184:187]
    v_exp_f32 v67, v67
    v_mfma_f32_16x16x32_bf16 v[184:187], a[196:199], v[132:135], v[184:187]
    v_perm_b32 v100, v65, v64, s35
    v_perm_b32 v101, v67, v66, s35
    v_mfma_f32_16x16x32_bf16 v[184:187], a[204:207], v[136:139], v[184:187]
    ds_read_b128 v[116:119], v4 offset:36864
    ds_read_b128 v[120:123], v4 offset:37888
    v_mfma_f32_16x16x32_bf16 v[184:187], a[212:215], v[140:143], v[184:187]
    ds_read_b128 v[124:127], v4 offset:38912
    ds_read_b128 v[128:131], v4 offset:39936
    v_mfma_f32_16x16x32_bf16 v[184:187], a[220:223], v[144:147], v[184:187]
    ds_read_b128 v[132:135], v5 offset:36864
    ds_read_b128 v[136:139], v5 offset:37888
    v_mfma_f32_16x16x32_bf16 v[184:187], a[228:231], v[148:151], v[184:187]
    ds_read_b128 v[140:143], v5 offset:38912
    ds_read_b128 v[144:147], v5 offset:39936
    v_mfma_f32_16x16x32_bf16 v[184:187], a[236:239], v[152:155], v[184:187]
    v_exp_f32 v68, v68
    v_mfma_f32_16x16x32_bf16 v[184:187], a[244:247], v[156:159], v[184:187]
    v_exp_f32 v69, v69
    v_mfma_f32_16x16x32_bf16 v[184:187], a[252:255], v[160:163], v[184:187]
    v_exp_f32 v70, v70
    v_smfmac_f32_16x16x64_bf16 v[196:199], v[24:27], v[92:99], v23
    v_cvt_pk_bf16_f32 v211, v170, v171
    v_mfma_f32_16x16x32_bf16 v[72:75], a[32:35], v[48:51], 0
    v_exp_f32 v71, v71
    v_mfma_f32_16x16x32_bf16 v[72:75], a[36:39], v[52:55], v[72:75]
    v_perm_b32 v102, v69, v68, s35
    v_perm_b32 v103, v71, v70, s35
    v_mfma_f32_16x16x32_bf16 v[72:75], a[40:43], v[56:59], v[72:75]
    ds_read_b128 v[148:151], v6 offset:36864
    ds_read_b128 v[152:155], v6 offset:37888
    v_mfma_f32_16x16x32_bf16 v[72:75], a[44:47], v[60:63], v[72:75]
    ds_write_b128 v3, v[100:103] offset:4096
    v_mfma_f32_16x16x32_bf16 v[76:79], a[60:63], v[60:63], 0
    ds_read_b128 v[156:159], v6 offset:38912
    ds_read_b128 v[160:163], v6 offset:39936
    v_mfma_f32_16x16x32_bf16 v[76:79], a[56:59], v[56:59], v[76:79]
    v_mul_f32 v172, v172, v20
    v_mul_f32 v173, v173, v20
    v_mfma_f32_16x16x32_bf16 v[76:79], a[52:55], v[52:55], v[76:79]
    v_exp_f32 v72, v72
    v_mfma_f32_16x16x32_bf16 v[76:79], a[48:51], v[48:51], v[76:79]
    v_exp_f32 v73, v73
    v_mfma_f32_16x16x32_bf16 v[64:67], a[64:67], v[48:51], 0
    v_exp_f32 v74, v74
    v_mfma_f32_16x16x32_bf16 v[64:67], a[68:71], v[52:55], v[64:67]
    v_exp_f32 v75, v75
    v_mfma_f32_16x16x32_bf16 v[64:67], a[72:75], v[56:59], v[64:67]
    v_perm_b32 v104, v73, v72, s35
    v_perm_b32 v105, v75, v74, s35
    v_mfma_f32_16x16x32_bf16 v[64:67], a[76:79], v[60:63], v[64:67]
    s_waitcnt lgkmcnt(9)
    buffer_store_dwordx4 v[208:211], v10, s[20:23], s31 offen sc1 nt
    v_mfma_f32_16x16x32_bf16 v[188:191], a[160:163], v[116:119], v[188:191]
    v_exp_f32 v76, v76
    v_mfma_f32_16x16x32_bf16 v[188:191], a[168:171], v[120:123], v[188:191]
    v_exp_f32 v77, v77
    v_mfma_f32_16x16x32_bf16 v[188:191], a[176:179], v[124:127], v[188:191]
    v_exp_f32 v78, v78
    v_mfma_f32_16x16x32_bf16 v[188:191], a[184:187], v[128:131], v[188:191]
    s_waitcnt lgkmcnt(5)
    v_exp_f32 v79, v79
    v_mfma_f32_16x16x32_bf16 v[188:191], a[192:195], v[132:135], v[188:191]
    v_perm_b32 v106, v77, v76, s35
    v_perm_b32 v107, v79, v78, s35
    v_mfma_f32_16x16x32_bf16 v[188:191], a[200:203], v[136:139], v[188:191]
    v_exp_f32 v64, v64
    v_mfma_f32_16x16x32_bf16 v[188:191], a[208:211], v[140:143], v[188:191]
    v_exp_f32 v65, v65
    v_mfma_f32_16x16x32_bf16 v[188:191], a[216:219], v[144:147], v[188:191]
    s_waitcnt lgkmcnt(0)
    v_exp_f32 v66, v66
    v_mfma_f32_16x16x32_bf16 v[188:191], a[224:227], v[148:151], v[188:191]
    v_exp_f32 v67, v67
    v_mfma_f32_16x16x32_bf16 v[188:191], a[232:235], v[152:155], v[188:191]
    v_perm_b32 v108, v65, v64, s35
    v_perm_b32 v109, v67, v66, s35
    v_mfma_f32_16x16x32_bf16 v[188:191], a[240:243], v[156:159], v[188:191]
    v_mul_f32 v174, v174, v20
    v_mul_f32 v175, v175, v20
    v_mfma_f32_16x16x32_bf16 v[188:191], a[248:251], v[160:163], v[188:191]
    ds_write_b128 v3, v[104:107] offset:5120
    v_mfma_f32_16x16x32_bf16 v[68:71], a[80:83], v[48:51], 0
    ds_read_b128 v[200:203], v8 offset:29184
    v_mul_f32 v176, v176, v20
    v_mfma_f32_16x16x32_bf16 v[68:71], a[84:87], v[52:55], v[68:71]
    v_mul_f32 v177, v177, v20
    v_mul_f32 v178, v178, v20
    v_mfma_f32_16x16x32_bf16 v[68:71], a[88:91], v[56:59], v[68:71]
    v_mul_f32 v179, v179, v20
    v_cvt_pk_bf16_f32 v212, v172, v173
    v_mfma_f32_16x16x32_bf16 v[68:71], a[92:95], v[60:63], v[68:71]
    v_cvt_pk_bf16_f32 v213, v174, v175
    v_smfmac_f32_16x16x64_bf16 v[196:199], v[28:31], v[100:107], v23
    v_mfma_f32_16x16x32_bf16 v[72:75], a[108:111], v[60:63], 0
    v_cvt_pk_bf16_f32 v214, v176, v177
    v_cvt_pk_bf16_f32 v215, v178, v179
    v_mfma_f32_16x16x32_bf16 v[72:75], a[104:107], v[56:59], v[72:75]
    ds_read_b128 v[32:35], v2 offset:8192
    ds_read_b128 v[36:39], v2 offset:8704
    v_mfma_f32_16x16x32_bf16 v[72:75], a[100:103], v[52:55], v[72:75]
    v_exp_f32 v68, v68
    v_mfma_f32_16x16x32_bf16 v[72:75], a[96:99], v[48:51], v[72:75]
    v_exp_f32 v69, v69
    v_mfma_f32_16x16x32_bf16 v[76:79], a[112:115], v[48:51], 0
    s_sub_u32 s33, s33, 1
    v_exp_f32 v70, v70
    v_mfma_f32_16x16x32_bf16 v[76:79], a[116:119], v[52:55], v[76:79]
    v_exp_f32 v71, v71
    v_mfma_f32_16x16x32_bf16 v[76:79], a[120:123], v[56:59], v[76:79]
    v_perm_b32 v110, v69, v68, s35
    v_perm_b32 v111, v71, v70, s35
    v_mfma_f32_16x16x32_bf16 v[76:79], a[124:127], v[60:63], v[76:79]
    ds_write_b128 v3, v[108:111] offset:6144
    v_mfma_f32_16x16x32_bf16 v[192:195], a[164:167], v[116:119], v[192:195]
    ds_read_b128 v[40:43], v2 offset:10240
    ds_read_b128 v[44:47], v2 offset:10752
    v_mfma_f32_16x16x32_bf16 v[192:195], a[172:175], v[120:123], v[192:195]
    v_exp_f32 v72, v72
    v_mfma_f32_16x16x32_bf16 v[192:195], a[180:183], v[124:127], v[192:195]
    v_exp_f32 v73, v73
    v_mfma_f32_16x16x32_bf16 v[192:195], a[188:191], v[128:131], v[192:195]
    v_exp_f32 v74, v74
    v_mfma_f32_16x16x32_bf16 v[192:195], a[196:199], v[132:135], v[192:195]
    v_exp_f32 v75, v75
    v_mfma_f32_16x16x32_bf16 v[192:195], a[204:207], v[136:139], v[192:195]
    v_perm_b32 v112, v73, v72, s35
    v_perm_b32 v113, v75, v74, s35
    v_mfma_f32_16x16x32_bf16 v[192:195], a[212:215], v[140:143], v[192:195]
    v_exp_f32 v76, v76
    v_mfma_f32_16x16x32_bf16 v[192:195], a[220:223], v[144:147], v[192:195]
    v_exp_f32 v77, v77
    v_mfma_f32_16x16x32_bf16 v[192:195], a[228:231], v[148:151], v[192:195]
    buffer_load_dwordx4 v9, s[8:11], s29 offen offset:1024 lds
    v_mfma_f32_16x16x32_bf16 v[192:195], a[236:239], v[152:155], v[192:195]
    ds_read_b128 v[48:51], v2 offset:12288
    ds_read_b128 v[52:55], v2 offset:12800
    v_mfma_f32_16x16x32_bf16 v[192:195], a[244:247], v[156:159], v[192:195]
    ds_read_b128 v[56:59], v2 offset:14336
    ds_read_b128 v[60:63], v2 offset:14848
    v_mfma_f32_16x16x32_bf16 v[192:195], a[252:255], v[160:163], v[192:195]
    s_waitcnt lgkmcnt(4)
    buffer_store_dwordx4 v[212:215], v10, s[20:23], s32 offen sc1 nt
    s_cbranch_scc0 L_loopA0
L_tailA:
    v_mfma_f32_16x16x32_bf16 v[64:67], a[0:3], v[32:35], 0
    v_exp_f32 v78, v78
    v_mfma_f32_16x16x32_bf16 v[64:67], a[4:7], v[36:39], v[64:67]
    v_exp_f32 v79, v79
    v_mfma_f32_16x16x32_bf16 v[64:67], a[8:11], v[40:43], v[64:67]
    v_perm_b32 v114, v77, v76, s35
    v_perm_b32 v115, v79, v78, s35
    v_mfma_f32_16x16x32_bf16 v[64:67], a[12:15], v[44:47], v[64:67]
    v_add_f32 v200, v200, v201
    v_add_f32 v202, v202, v203
    v_smfmac_f32_16x16x64_bf16 v[196:199], v[28:31], v[108:115], v23
    v_add_f32 v17, v200, v202
    v_mfma_f32_16x16x32_bf16 v[68:71], a[28:31], v[44:47], 0
    v_rcp_f32 v19, v17
    v_mfma_f32_16x16x32_bf16 v[68:71], a[24:27], v[40:43], v[68:71]
    v_max3_u32 v11, v11, v17, v19
    v_mov_b32 v20, v19
    v_mfma_f32_16x16x32_bf16 v[68:71], a[20:23], v[36:39], v[68:71]
    v_add_f32 v198, v196, v197
    v_mov_b64 v[196:197], 0
    v_mfma_f32_16x16x32_bf16 v[68:71], a[16:19], v[32:35], v[68:71]
    ds_write_b128 v3, v[112:115] offset:7168
    v_mfma_f32_16x16x32_bf16 v[164:167], a[128:131], v[80:83], 0
    ds_write_b32 v7, v198 offset:28672
    v_mfma_f32_16x16x32_bf16 v[164:167], a[136:139], v[84:87], v[164:167]
    v_exp_f32 v64, v64
    v_mfma_f32_16x16x32_bf16 v[164:167], a[144:147], v[92:95], v[164:167]
    v_exp_f32 v65, v65
    v_mfma_f32_16x16x32_bf16 v[164:167], a[152:155], v[96:99], v[164:167]
    v_exp_f32 v66, v66
    v_mfma_f32_16x16x32_bf16 v[168:171], a[156:159], v[96:99], 0
    v_exp_f32 v67, v67
    v_mfma_f32_16x16x32_bf16 v[168:171], a[148:151], v[92:95], v[168:171]
    v_perm_b32 v88, v65, v64, s35
    v_perm_b32 v89, v67, v66, s35
    v_mfma_f32_16x16x32_bf16 v[168:171], a[140:143], v[84:87], v[168:171]
    s_waitcnt lgkmcnt(0)
    v_exp_f32 v68, v68
    v_mfma_f32_16x16x32_bf16 v[168:171], a[132:135], v[80:83], v[168:171]
    s_barrier
    v_mfma_f32_16x16x32_bf16 v[72:75], a[32:35], v[32:35], 0
    v_exp_f32 v69, v69
    v_mfma_f32_16x16x32_bf16 v[72:75], a[36:39], v[36:39], v[72:75]
    v_exp_f32 v70, v70
    v_mfma_f32_16x16x32_bf16 v[72:75], a[40:43], v[40:43], v[72:75]
    v_exp_f32 v71, v71
    v_mfma_f32_16x16x32_bf16 v[72:75], a[44:47], v[44:47], v[72:75]
    v_perm_b32 v90, v69, v68, s35
    v_perm_b32 v91, v71, v70, s35
    v_mfma_f32_16x16x32_bf16 v[76:79], a[60:63], v[44:47], 0
    v_permlane32_swap_b32 v19, v20
    v_mfma_f32_16x16x32_bf16 v[76:79], a[56:59], v[40:43], v[76:79]
    ds_read_b128 v[116:119], v4 offset:0
    ds_read_b128 v[120:123], v4 offset:1024
    v_mfma_f32_16x16x32_bf16 v[76:79], a[52:55], v[36:39], v[76:79]
    ds_read_b128 v[124:127], v4 offset:2048
    ds_read_b128 v[128:131], v4 offset:3072
    v_mfma_f32_16x16x32_bf16 v[76:79], a[48:51], v[32:35], v[76:79]
    ds_write_b128 v3, v[88:91] offset:32768
    v_mfma_f32_16x16x32_bf16 v[172:175], a[128:131], v[100:103], 0
    v_exp_f32 v72, v72
    v_mfma_f32_16x16x32_bf16 v[172:175], a[136:139], v[104:107], v[172:175]
    v_exp_f32 v73, v73
    v_mfma_f32_16x16x32_bf16 v[172:175], a[144:147], v[108:111], v[172:175]
    v_exp_f32 v74, v74
    v_mfma_f32_16x16x32_bf16 v[172:175], a[152:155], v[112:115], v[172:175]
    v_exp_f32 v75, v75
    v_mfma_f32_16x16x32_bf16 v[176:179], a[156:159], v[112:115], 0
    v_perm_b32 v84, v73, v72, s35
    v_perm_b32 v85, v75, v74, s35
    v_mfma_f32_16x16x32_bf16 v[176:179], a[148:151], v[108:111], v[176:179]
    s_add_u32 s31, s31, 0x2000
    ds_read_b128 v[132:135], v5 offset:0
    ds_read_b128 v[136:139], v5 offset:1024
    v_mfma_f32_16x16x32_bf16 v[176:179], a[140:143], v[104:107], v[176:179]
    v_exp_f32 v76, v76
    v_mfma_f32_16x16x32_bf16 v[176:179], a[132:135], v[100:103], v[176:179]
    v_exp_f32 v77, v77
    v_mfma_f32_16x16x32_bf16 v[64:67], a[64:67], v[32:35], 0
    v_exp_f32 v78, v78
    v_mfma_f32_16x16x32_bf16 v[64:67], a[68:71], v[36:39], v[64:67]
    s_add_u32 s32, s32, 0x2000
    v_exp_f32 v79, v79
    v_mfma_f32_16x16x32_bf16 v[64:67], a[72:75], v[40:43], v[64:67]
    v_perm_b32 v86, v77, v76, s35
    v_perm_b32 v87, v79, v78, s35
    v_mfma_f32_16x16x32_bf16 v[64:67], a[76:79], v[44:47], v[64:67]
    ds_write_b128 v3, v[84:87] offset:33792
    v_mfma_f32_16x16x32_bf16 v[68:71], a[92:95], v[44:47], 0
    ds_read_b128 v[140:143], v5 offset:2048
    ds_read_b128 v[144:147], v5 offset:3072
    v_mfma_f32_16x16x32_bf16 v[68:71], a[88:91], v[40:43], v[68:71]
    v_mul_f32 v180, v180, v19
    v_mul_f32 v181, v181, v19
    v_mfma_f32_16x16x32_bf16 v[68:71], a[84:87], v[36:39], v[68:71]
    v_exp_f32 v64, v64
    v_mfma_f32_16x16x32_bf16 v[68:71], a[80:83], v[32:35], v[68:71]
    v_exp_f32 v65, v65
    v_smfmac_f32_16x16x64_bf16 v[196:199], v[24:27], v[84:91], v23
    v_mul_f32 v182, v182, v19
    v_mfma_f32_16x16x32_bf16 v[72:75], a[96:99], v[32:35], 0
    v_exp_f32 v66, v66
    v_mfma_f32_16x16x32_bf16 v[72:75], a[100:103], v[36:39], v[72:75]
    ds_read_b128 v[148:151], v6 offset:0
    ds_read_b128 v[152:155], v6 offset:1024
    v_mfma_f32_16x16x32_bf16 v[72:75], a[104:107], v[40:43], v[72:75]
    ds_read_b128 v[156:159], v6 offset:2048
    ds_read_b128 v[160:163], v6 offset:3072
    v_mfma_f32_16x16x32_bf16 v[72:75], a[108:111], v[44:47], v[72:75]
    s_waitcnt lgkmcnt(10)
    v_mfma_f32_16x16x32_bf16 v[164:167], a[160:163], v[116:119], v[164:167]
    v_exp_f32 v67, v67
    v_mfma_f32_16x16x32_bf16 v[164:167], a[168:171], v[120:123], v[164:167]
    v_perm_b32 v92, v65, v64, s35
    v_perm_b32 v93, v67, v66, s35
    v_mfma_f32_16x16x32_bf16 v[164:167], a[176:179], v[124:127], v[164:167]
    v_exp_f32 v68, v68
    v_mfma_f32_16x16x32_bf16 v[164:167], a[184:187], v[128:131], v[164:167]
    s_waitcnt lgkmcnt(4)
    v_exp_f32 v69, v69
    v_mfma_f32_16x16x32_bf16 v[164:167], a[192:195], v[132:135], v[164:167]
    v_mfma_f32_16x16x32_bf16 v[164:167], a[200:203], v[136:139], v[164:167]
    v_exp_f32 v70, v70
    v_mfma_f32_16x16x32_bf16 v[164:167], a[208:211], v[140:143], v[164:167]
    v_exp_f32 v71, v71
    v_mfma_f32_16x16x32_bf16 v[164:167], a[216:219], v[144:147], v[164:167]
    s_waitcnt lgkmcnt(0)
    v_perm_b32 v94, v69, v68, s35
    v_perm_b32 v95, v71, v70, s35
    v_mfma_f32_16x16x32_bf16 v[164:167], a[224:227], v[148:151], v[164:167]
    v_exp_f32 v72, v72
    v_mfma_f32_16x16x32_bf16 v[164:167], a[232:235], v[152:155], v[164:167]
    v_exp_f32 v73, v73
    v_mfma_f32_16x16x32_bf16 v[164:167], a[240:243], v[156:159], v[164:167]
    v_exp_f32 v74, v74
    v_mfma_f32_16x16x32_bf16 v[164:167], a[248:251], v[160:163], v[164:167]
    ds_write_b128 v3, v[92:95] offset:34816
    v_mfma_f32_16x16x32_bf16 v[76:79], a[112:115], v[32:35], 0
    v_exp_f32 v75, v75
    v_mfma_f32_16x16x32_bf16 v[76:79], a[116:119], v[36:39], v[76:79]
    v_perm_b32 v96, v73, v72, s35
    v_perm_b32 v97, v75, v74, s35
    v_mfma_f32_16x16x32_bf16 v[76:79], a[120:123], v[40:43], v[76:79]
    v_mul_f32 v183, v183, v19
    v_mul_f32 v184, v184, v19
    v_mfma_f32_16x16x32_bf16 v[76:79], a[124:127], v[44:47], v[76:79]
    v_mul_f32 v185, v185, v19
    v_mul_f32 v186, v186, v19
    v_mfma_f32_16x16x32_bf16 v[64:67], a[0:3], v[48:51], 0
    v_mul_f32 v187, v187, v19
    v_cvt_pk_bf16_f32 v208, v180, v181
    v_mfma_f32_16x16x32_bf16 v[64:67], a[4:7], v[52:55], v[64:67]
    v_cvt_pk_bf16_f32 v209, v182, v183
    v_cvt_pk_bf16_f32 v210, v184, v185
    v_mfma_f32_16x16x32_bf16 v[64:67], a[8:11], v[56:59], v[64:67]
    v_exp_f32 v76, v76
    v_mfma_f32_16x16x32_bf16 v[64:67], a[12:15], v[60:63], v[64:67]
    v_exp_f32 v77, v77
    v_mfma_f32_16x16x32_bf16 v[68:71], a[28:31], v[60:63], 0
    v_exp_f32 v78, v78
    v_mfma_f32_16x16x32_bf16 v[68:71], a[24:27], v[56:59], v[68:71]
    v_exp_f32 v79, v79
    v_mfma_f32_16x16x32_bf16 v[68:71], a[20:23], v[52:55], v[68:71]
    v_perm_b32 v98, v77, v76, s35
    v_perm_b32 v99, v79, v78, s35
    v_mfma_f32_16x16x32_bf16 v[68:71], a[16:19], v[48:51], v[68:71]
    ds_write_b128 v3, v[96:99] offset:35840
    v_mfma_f32_16x16x32_bf16 v[168:171], a[164:167], v[116:119], v[168:171]
    v_exp_f32 v64, v64
    v_mfma_f32_16x16x32_bf16 v[168:171], a[172:175], v[120:123], v[168:171]
    v_exp_f32 v65, v65
    v_mfma_f32_16x16x32_bf16 v[168:171], a[180:183], v[124:127], v[168:171]
    v_exp_f32 v66, v66
    v_mfma_f32_16x16x32_bf16 v[168:171], a[188:191], v[128:131], v[168:171]
    v_exp_f32 v67, v67
    v_mfma_f32_16x16x32_bf16 v[168:171], a[196:199], v[132:135], v[168:171]
    v_perm_b32 v100, v65, v64, s35
    v_perm_b32 v101, v67, v66, s35
    v_mfma_f32_16x16x32_bf16 v[168:171], a[204:207], v[136:139], v[168:171]
    ds_read_b128 v[116:119], v4 offset:4096
    ds_read_b128 v[120:123], v4 offset:5120
    v_mfma_f32_16x16x32_bf16 v[168:171], a[212:215], v[140:143], v[168:171]
    ds_read_b128 v[124:127], v4 offset:6144
    ds_read_b128 v[128:131], v4 offset:7168
    v_mfma_f32_16x16x32_bf16 v[168:171], a[220:223], v[144:147], v[168:171]
    ds_read_b128 v[132:135], v5 offset:4096
    ds_read_b128 v[136:139], v5 offset:5120
    v_mfma_f32_16x16x32_bf16 v[168:171], a[228:231], v[148:151], v[168:171]
    ds_read_b128 v[140:143], v5 offset:6144
    ds_read_b128 v[144:147], v5 offset:7168
    v_mfma_f32_16x16x32_bf16 v[168:171], a[236:239], v[152:155], v[168:171]
    v_exp_f32 v68, v68
    v_mfma_f32_16x16x32_bf16 v[168:171], a[244:247], v[156:159], v[168:171]
    v_exp_f32 v69, v69
    v_mfma_f32_16x16x32_bf16 v[168:171], a[252:255], v[160:163], v[168:171]
    v_exp_f32 v70, v70
    v_smfmac_f32_16x16x64_bf16 v[196:199], v[24:27], v[92:99], v23
    v_cvt_pk_bf16_f32 v211, v186, v187
    v_mfma_f32_16x16x32_bf16 v[72:75], a[32:35], v[48:51], 0
    v_exp_f32 v71, v71
    v_mfma_f32_16x16x32_bf16 v[72:75], a[36:39], v[52:55], v[72:75]
    v_perm_b32 v102, v69, v68, s35
    v_perm_b32 v103, v71, v70, s35
    v_mfma_f32_16x16x32_bf16 v[72:75], a[40:43], v[56:59], v[72:75]
    ds_read_b128 v[148:151], v6 offset:4096
    ds_read_b128 v[152:155], v6 offset:5120
    v_mfma_f32_16x16x32_bf16 v[72:75], a[44:47], v[60:63], v[72:75]
    ds_write_b128 v3, v[100:103] offset:36864
    v_mfma_f32_16x16x32_bf16 v[76:79], a[60:63], v[60:63], 0
    ds_read_b128 v[156:159], v6 offset:6144
    ds_read_b128 v[160:163], v6 offset:7168
    v_mfma_f32_16x16x32_bf16 v[76:79], a[56:59], v[56:59], v[76:79]
    v_mul_f32 v188, v188, v20
    v_mul_f32 v189, v189, v20
    v_mfma_f32_16x16x32_bf16 v[76:79], a[52:55], v[52:55], v[76:79]
    v_exp_f32 v72, v72
    v_mfma_f32_16x16x32_bf16 v[76:79], a[48:51], v[48:51], v[76:79]
    v_exp_f32 v73, v73
    v_mfma_f32_16x16x32_bf16 v[64:67], a[64:67], v[48:51], 0
    v_exp_f32 v74, v74
    v_mfma_f32_16x16x32_bf16 v[64:67], a[68:71], v[52:55], v[64:67]
    v_exp_f32 v75, v75
    v_mfma_f32_16x16x32_bf16 v[64:67], a[72:75], v[56:59], v[64:67]
L_s6:
    s_cbranch_execz L_ce4A
L_s6_n:
    v_perm_b32 v104, v73, v72, s35
    v_perm_b32 v105, v75, v74, s35
    v_mfma_f32_16x16x32_bf16 v[64:67], a[76:79], v[60:63], v[64:67]
    s_waitcnt lgkmcnt(9)
    buffer_store_dwordx4 v[208:211], v10, s[20:23], s31 offen sc1 nt
    v_mfma_f32_16x16x32_bf16 v[172:175], a[160:163], v[116:119], v[172:175]
    v_exp_f32 v76, v76
    v_mfma_f32_16x16x32_bf16 v[172:175], a[168:171], v[120:123], v[172:175]
    v_exp_f32 v77, v77
    v_mfma_f32_16x16x32_bf16 v[172:175], a[176:179], v[124:127], v[172:175]
    v_exp_f32 v78, v78
    v_mfma_f32_16x16x32_bf16 v[172:175], a[184:187], v[128:131], v[172:175]
    s_waitcnt lgkmcnt(5)
    v_exp_f32 v79, v79
    v_mfma_f32_16x16x32_bf16 v[172:175], a[192:195], v[132:135], v[172:175]
    v_perm_b32 v106, v77, v76, s35
    v_perm_b32 v107, v79, v78, s35
    v_mfma_f32_16x16x32_bf16 v[172:175], a[200:203], v[136:139], v[172:175]
    v_exp_f32 v64, v64
    v_mfma_f32_16x16x32_bf16 v[172:175], a[208:211], v[140:143], v[172:175]
    v_exp_f32 v65, v65
    v_mfma_f32_16x16x32_bf16 v[172:175], a[216:219], v[144:147], v[172:175]
    s_waitcnt lgkmcnt(0)
    v_exp_f32 v66, v66
    v_mfma_f32_16x16x32_bf16 v[172:175], a[224:227], v[148:151], v[172:175]
    v_exp_f32 v67, v67
    v_mfma_f32_16x16x32_bf16 v[172:175], a[232:235], v[152:155], v[172:175]
    v_perm_b32 v108, v65, v64, s35
    v_perm_b32 v109, v67, v66, s35
    v_mfma_f32_16x16x32_bf16 v[172:175], a[240:243], v[156:159], v[172:175]
    v_mul_f32 v190, v190, v20
    v_mul_f32 v191, v191, v20
    v_mfma_f32_16x16x32_bf16 v[172:175], a[248:251], v[160:163], v[172:175]
    ds_write_b128 v3, v[104:107] offset:37888
    v_mfma_f32_16x16x32_bf16 v[68:71], a[80:83], v[48:51], 0
    ds_read_b128 v[200:203], v8 offset:28672
    v_mul_f32 v192, v192, v20
    v_mfma_f32_16x16x32_bf16 v[68:71], a[84:87], v[52:55], v[68:71]
    v_mul_f32 v193, v193, v20
    v_mul_f32 v194, v194, v20
    v_mfma_f32_16x16x32_bf16 v[68:71], a[88:91], v[56:59], v[68:71]
    v_mul_f32 v195, v195, v20
    v_cvt_pk_bf16_f32 v212, v188, v189
    v_mfma_f32_16x16x32_bf16 v[68:71], a[92:95], v[60:63], v[68:71]
    v_cvt_pk_bf16_f32 v213, v190, v191
    v_smfmac_f32_16x16x64_bf16 v[196:199], v[28:31], v[100:107], v23
    v_mfma_f32_16x16x32_bf16 v[72:75], a[108:111], v[60:63], 0
    v_cvt_pk_bf16_f32 v214, v192, v193
    v_cvt_pk_bf16_f32 v215, v194, v195
    v_mfma_f32_16x16x32_bf16 v[72:75], a[104:107], v[56:59], v[72:75]
    v_exp_f32 v68, v68
    v_mfma_f32_16x16x32_bf16 v[72:75], a[100:103], v[52:55], v[72:75]
    v_exp_f32 v69, v69
    v_mfma_f32_16x16x32_bf16 v[72:75], a[96:99], v[48:51], v[72:75]
    buffer_store_dwordx4 v[212:215], v10, s[20:23], s32 offen sc1 nt
    v_mfma_f32_16x16x32_bf16 v[76:79], a[112:115], v[48:51], 0
    v_exp_f32 v70, v70
    v_mfma_f32_16x16x32_bf16 v[76:79], a[116:119], v[52:55], v[76:79]
    v_exp_f32 v71, v71
    v_mfma_f32_16x16x32_bf16 v[76:79], a[120:123], v[56:59], v[76:79]
    v_perm_b32 v110, v69, v68, s35
    v_perm_b32 v111, v71, v70, s35
    v_mfma_f32_16x16x32_bf16 v[76:79], a[124:127], v[60:63], v[76:79]
    ds_write_b128 v3, v[108:111] offset:38912
    v_mfma_f32_16x16x32_bf16 v[176:179], a[164:167], v[116:119], v[176:179]
    v_mfma_f32_16x16x32_bf16 v[176:179], a[172:175], v[120:123], v[176:179]
    v_exp_f32 v72, v72
    v_mfma_f32_16x16x32_bf16 v[176:179], a[180:183], v[124:127], v[176:179]
    v_exp_f32 v73, v73
    v_mfma_f32_16x16x32_bf16 v[176:179], a[188:191], v[128:131], v[176:179]
    v_exp_f32 v74, v74
    v_mfma_f32_16x16x32_bf16 v[176:179], a[196:199], v[132:135], v[176:179]
    v_exp_f32 v75, v75
    v_mfma_f32_16x16x32_bf16 v[176:179], a[204:207], v[136:139], v[176:179]
    v_perm_b32 v112, v73, v72, s35
    v_perm_b32 v113, v75, v74, s35
    v_mfma_f32_16x16x32_bf16 v[176:179], a[212:215], v[140:143], v[176:179]
    v_exp_f32 v76, v76
    v_mfma_f32_16x16x32_bf16 v[176:179], a[220:223], v[144:147], v[176:179]
    v_exp_f32 v77, v77
    v_mfma_f32_16x16x32_bf16 v[176:179], a[228:231], v[148:151], v[176:179]
    v_exp_f32 v78, v78
    v_mfma_f32_16x16x32_bf16 v[176:179], a[236:239], v[152:155], v[176:179]
    v_exp_f32 v79, v79
    v_mfma_f32_16x16x32_bf16 v[176:179], a[244:247], v[156:159], v[176:179]
    v_perm_b32 v114, v77, v76, s35
    v_perm_b32 v115, v79, v78, s35
    v_mfma_f32_16x16x32_bf16 v[176:179], a[252:255], v[160:163], v[176:179]
    ds_write_b128 v3, v[112:115] offset:39936
    v_smfmac_f32_16x16x64_bf16 v[196:199], v[28:31], v[108:115], v23
    s_waitcnt lgkmcnt(2)
    v_add_f32 v200, v200, v201
    v_mfma_f32_16x16x32_bf16 v[180:183], a[128:131], v[88:91], 0
    v_add_f32 v202, v202, v203
    v_add_f32 v17, v200, v202
    v_mfma_f32_16x16x32_bf16 v[180:183], a[136:139], v[84:87], v[180:183]
    v_rcp_f32 v19, v17
    v_mfma_f32_16x16x32_bf16 v[180:183], a[144:147], v[92:95], v[180:183]
    v_add_f32 v198, v196, v197
    v_max3_u32 v11, v11, v17, v19
    v_mfma_f32_16x16x32_bf16 v[180:183], a[152:155], v[96:99], v[180:183]
    ds_write_b32 v7, v198 offset:29184
    v_mfma_f32_16x16x32_bf16 v[184:187], a[156:159], v[96:99], 0
    v_mov_b32 v20, v19
    s_add_u32 s31, s31, 0x2000
    v_mfma_f32_16x16x32_bf16 v[184:187], a[148:151], v[92:95], v[184:187]
    v_permlane32_swap_b32 v19, v20
    v_mfma_f32_16x16x32_bf16 v[184:187], a[140:143], v[84:87], v[184:187]
    s_add_u32 s32, s32, 0x2000
    v_mul_f32 v164, v164, v19
    v_mfma_f32_16x16x32_bf16 v[184:187], a[132:135], v[88:91], v[184:187]
    s_waitcnt lgkmcnt(0)
    s_barrier
    ds_read_b128 v[116:119], v4 offset:32768
    v_mfma_f32_16x16x32_bf16 v[188:191], a[128:131], v[100:103], 0
    ds_read_b128 v[120:123], v4 offset:33792
    v_mul_f32 v165, v165, v19
    v_mfma_f32_16x16x32_bf16 v[188:191], a[136:139], v[104:107], v[188:191]
    ds_read_b128 v[124:127], v4 offset:34816
    v_mul_f32 v166, v166, v19
    v_mfma_f32_16x16x32_bf16 v[188:191], a[144:147], v[108:111], v[188:191]
    ds_read_b128 v[128:131], v4 offset:35840
    v_mul_f32 v167, v167, v19
    v_mfma_f32_16x16x32_bf16 v[188:191], a[152:155], v[112:115], v[188:191]
    v_cvt_pk_bf16_f32 v208, v164, v165
    v_cvt_pk_bf16_f32 v209, v166, v167
    v_mfma_f32_16x16x32_bf16 v[192:195], a[156:159], v[112:115], 0
    ds_read_b128 v[200:203], v8 offset:29184
    v_mul_f32 v168, v168, v19
    v_mfma_f32_16x16x32_bf16 v[192:195], a[148:151], v[108:111], v[192:195]
    v_mul_f32 v169, v169, v19
    v_mul_f32 v170, v170, v19
    v_mfma_f32_16x16x32_bf16 v[192:195], a[140:143], v[104:107], v[192:195]
    v_mul_f32 v171, v171, v19
    v_cvt_pk_bf16_f32 v210, v168, v169
    v_mfma_f32_16x16x32_bf16 v[192:195], a[132:135], v[100:103], v[192:195]
    s_waitcnt lgkmcnt(1)
    ds_read_b128 v[132:135], v5 offset:32768
    v_cvt_pk_bf16_f32 v211, v170, v171
    v_mfma_f32_16x16x32_bf16 v[180:183], a[160:163], v[116:119], v[180:183]
    ds_read_b128 v[136:139], v5 offset:33792
    v_mul_f32 v172, v172, v20
    v_mfma_f32_16x16x32_bf16 v[180:183], a[168:171], v[120:123], v[180:183]
    ds_read_b128 v[140:143], v5 offset:34816
    v_mul_f32 v173, v173, v20
    v_mfma_f32_16x16x32_bf16 v[180:183], a[176:179], v[124:127], v[180:183]
    ds_read_b128 v[144:147], v5 offset:35840
    v_mul_f32 v174, v174, v20
    v_mfma_f32_16x16x32_bf16 v[180:183], a[184:187], v[128:131], v[180:183]
    buffer_store_dwordx4 v[208:211], v10, s[20:23], s31 offen sc1 nt
    v_mfma_f32_16x16x32_bf16 v[184:187], a[188:191], v[128:131], v[184:187]
    v_mul_f32 v175, v175, v20
    v_cvt_pk_bf16_f32 v212, v172, v173
    v_mfma_f32_16x16x32_bf16 v[184:187], a[180:183], v[124:127], v[184:187]
    v_cvt_pk_bf16_f32 v213, v174, v175
    v_mul_f32 v176, v176, v20
    v_mfma_f32_16x16x32_bf16 v[184:187], a[172:175], v[120:123], v[184:187]
    v_mul_f32 v177, v177, v20
    v_mul_f32 v178, v178, v20
    v_mfma_f32_16x16x32_bf16 v[184:187], a[164:167], v[116:119], v[184:187]
    s_waitcnt lgkmcnt(0)
    ds_read_b128 v[148:151], v6 offset:32768
    v_mul_f32 v179, v179, v20
    v_mfma_f32_16x16x32_bf16 v[184:187], a[196:199], v[132:135], v[184:187]
    ds_read_b128 v[152:155], v6 offset:33792
    v_cvt_pk_bf16_f32 v214, v176, v177
    v_mfma_f32_16x16x32_bf16 v[184:187], a[204:207], v[136:139], v[184:187]
    ds_read_b128 v[156:159], v6 offset:34816
    v_cvt_pk_bf16_f32 v215, v178, v179
    v_mfma_f32_16x16x32_bf16 v[184:187], a[212:215], v[140:143], v[184:187]
    ds_read_b128 v[160:163], v6 offset:35840
    v_add_f32 v200, v200, v201
    v_mfma_f32_16x16x32_bf16 v[184:187], a[220:223], v[144:147], v[184:187]
    buffer_store_dwordx4 v[212:215], v10, s[20:23], s32 offen sc1 nt
    v_mfma_f32_16x16x32_bf16 v[180:183], a[216:219], v[144:147], v[180:183]
    v_add_f32 v202, v202, v203
    v_add_f32 v17, v200, v202
    v_mfma_f32_16x16x32_bf16 v[180:183], a[208:211], v[140:143], v[180:183]
    v_rcp_f32 v19, v17
    v_mfma_f32_16x16x32_bf16 v[180:183], a[200:203], v[136:139], v[180:183]
    v_max3_u32 v11, v11, v17, v19
    v_mov_b32 v20, v19
    v_mfma_f32_16x16x32_bf16 v[180:183], a[192:195], v[132:135], v[180:183]
    s_waitcnt lgkmcnt(0)
    ds_read_b128 v[216:219], v4 offset:36864
    s_add_u32 s31, s31, 0x2000
    v_mfma_f32_16x16x32_bf16 v[180:183], a[224:227], v[148:151], v[180:183]
    ds_read_b128 v[220:223], v4 offset:37888
    s_add_u32 s32, s32, 0x2000
    v_mfma_f32_16x16x32_bf16 v[180:183], a[232:235], v[152:155], v[180:183]
    ds_read_b128 v[224:227], v4 offset:38912
    v_mfma_f32_16x16x32_bf16 v[180:183], a[240:243], v[156:159], v[180:183]
    ds_read_b128 v[228:231], v4 offset:39936
    v_mfma_f32_16x16x32_bf16 v[180:183], a[248:251], v[160:163], v[180:183]
    v_permlane32_swap_b32 v19, v20
    v_mfma_f32_16x16x32_bf16 v[184:187], a[252:255], v[160:163], v[184:187]
    v_mfma_f32_16x16x32_bf16 v[184:187], a[244:247], v[156:159], v[184:187]
    v_mfma_f32_16x16x32_bf16 v[184:187], a[236:239], v[152:155], v[184:187]
    v_mul_f32 v180, v180, v19
    v_mul_f32 v181, v181, v19
    v_mfma_f32_16x16x32_bf16 v[184:187], a[228:231], v[148:151], v[184:187]
    s_waitcnt lgkmcnt(0)
    ds_read_b128 v[232:235], v5 offset:36864
    v_mul_f32 v182, v182, v19
    v_mfma_f32_16x16x32_bf16 v[188:191], a[160:163], v[216:219], v[188:191]
    ds_read_b128 v[236:239], v5 offset:37888
    v_mul_f32 v183, v183, v19
    v_mfma_f32_16x16x32_bf16 v[188:191], a[168:171], v[220:223], v[188:191]
    ds_read_b128 v[240:243], v5 offset:38912
    v_cvt_pk_bf16_f32 v248, v180, v181
    v_mfma_f32_16x16x32_bf16 v[188:191], a[176:179], v[224:227], v[188:191]
    ds_read_b128 v[244:247], v5 offset:39936
    v_cvt_pk_bf16_f32 v249, v182, v183
    v_mfma_f32_16x16x32_bf16 v[188:191], a[184:187], v[228:231], v[188:191]
    v_mul_f32 v184, v184, v19
    v_mul_f32 v185, v185, v19
    v_mfma_f32_16x16x32_bf16 v[192:195], a[188:191], v[228:231], v[192:195]
    v_mul_f32 v186, v186, v19
    v_mul_f32 v187, v187, v19
    v_mfma_f32_16x16x32_bf16 v[192:195], a[180:183], v[224:227], v[192:195]
    v_cvt_pk_bf16_f32 v250, v184, v185
    v_cvt_pk_bf16_f32 v251, v186, v187
    v_mfma_f32_16x16x32_bf16 v[192:195], a[172:175], v[220:223], v[192:195]
    v_mfma_f32_16x16x32_bf16 v[192:195], a[164:167], v[216:219], v[192:195]
    s_waitcnt lgkmcnt(0)
    ds_read_b128 v[32:35], v6 offset:36864
    v_mfma_f32_16x16x32_bf16 v[192:195], a[196:199], v[232:235], v[192:195]
    ds_read_b128 v[36:39], v6 offset:37888
    v_mfma_f32_16x16x32_bf16 v[192:195], a[204:207], v[236:239], v[192:195]
    ds_read_b128 v[40:43], v6 offset:38912
    v_mfma_f32_16x16x32_bf16 v[192:195], a[212:215], v[240:243], v[192:195]
    ds_read_b128 v[44:47], v6 offset:39936
    v_mfma_f32_16x16x32_bf16 v[192:195], a[220:223], v[244:247], v[192:195]
    buffer_store_dwordx4 v[248:251], v10, s[20:23], s31 offen sc1 nt
    v_mfma_f32_16x16x32_bf16 v[188:191], a[216:219], v[244:247], v[188:191]
    v_mfma_f32_16x16x32_bf16 v[188:191], a[208:211], v[240:243], v[188:191]
    v_mfma_f32_16x16x32_bf16 v[188:191], a[200:203], v[236:239], v[188:191]
    v_mfma_f32_16x16x32_bf16 v[188:191], a[192:195], v[232:235], v[188:191]
    s_waitcnt lgkmcnt(0)
    v_mfma_f32_16x16x32_bf16 v[188:191], a[224:227], v[32:35], v[188:191]
    v_mfma_f32_16x16x32_bf16 v[188:191], a[232:235], v[36:39], v[188:191]
    v_mfma_f32_16x16x32_bf16 v[188:191], a[240:243], v[40:43], v[188:191]
    v_mfma_f32_16x16x32_bf16 v[188:191], a[248:251], v[44:47], v[188:191]
    v_mfma_f32_16x16x32_bf16 v[192:195], a[252:255], v[44:47], v[192:195]
    v_mfma_f32_16x16x32_bf16 v[192:195], a[244:247], v[40:43], v[192:195]
    v_mfma_f32_16x16x32_bf16 v[192:195], a[236:239], v[36:39], v[192:195]
    v_mul_f32 v188, v188, v20
    v_mul_f32 v189, v189, v20
    v_mfma_f32_16x16x32_bf16 v[192:195], a[228:231], v[32:35], v[192:195]
    v_mul_f32 v190, v190, v20
    v_mul_f32 v191, v191, v20
    v_cvt_pk_bf16_f32 v252, v188, v189
    v_cvt_pk_bf16_f32 v253, v190, v191
    s_nop 3
    v_mul_f32 v192, v192, v20
    v_mul_f32 v193, v193, v20
    v_mul_f32 v194, v194, v20
    v_mul_f32 v195, v195, v20
    v_cvt_pk_bf16_f32 v254, v192, v193
    v_cvt_pk_bf16_f32 v255, v194, v195
    buffer_store_dwordx4 v[252:255], v10, s[20:23], s32 offen sc1 nt
    v_cmp_lt_u32 vcc, 0x53800000, v11
    s_nop 4
    s_cmp_lg_u64 vcc, 0
    s_cbranch_scc1 L_slow0
    s_endpgm
.p2align 12
L_copyB:
L_sB:
    s_cbranch_execz L_cep
L_sB_n:
    v_mfma_f32_16x16x32_bf16 v[64:67], a[0:3], v[32:35], 0
    v_mfma_f32_16x16x32_bf16 v[64:67], a[4:7], v[36:39], v[64:67]
    v_mfma_f32_16x16x32_bf16 v[64:67], a[8:11], v[40:43], v[64:67]
    v_mfma_f32_16x16x32_bf16 v[64:67], a[12:15], v[44:47], v[64:67]
    v_mfma_f32_16x16x32_bf16 v[68:71], a[28:31], v[44:47], 0
    v_mfma_f32_16x16x32_bf16 v[68:71], a[24:27], v[40:43], v[68:71]
    s_add_u32 m0, s27, 98304
    s_nop 0
    v_mfma_f32_16x16x32_bf16 v[68:71], a[20:23], v[36:39], v[68:71]
    buffer_load_dwordx4 v21, s[16:19], s26 offen offset:1024 lds
    v_mfma_f32_16x16x32_bf16 v[68:71], a[16:19], v[32:35], v[68:71]
    v_exp_f32 v64, v64
    v_exp_f32 v65, v65
    v_exp_f32 v66, v66
    v_exp_f32 v67, v67
    v_perm_b32 v232, v65, v64, s35
    v_perm_b32 v233, v67, v66, s35
    buffer_load_dwordx4 v21, s[16:19], s26 offen offset:2048 lds
    s_waitcnt vmcnt(8)
    s_barrier
    v_exp_f32 v68, v68
    v_exp_f32 v69, v69
    v_exp_f32 v70, v70
    v_exp_f32 v71, v71
    v_mfma_f32_16x16x32_bf16 v[72:75], a[0:3], v[48:51], 0
    v_perm_b32 v234, v69, v68, s35
    v_perm_b32 v235, v71, v70, s35
    v_mfma_f32_16x16x32_bf16 v[72:75], a[4:7], v[52:55], v[72:75]
    ds_read_b128 v[32:35], v2 offset:8192
    ds_read_b128 v[36:39], v2 offset:8704
    v_mfma_f32_16x16x32_bf16 v[72:75], a[8:11], v[56:59], v[72:75]
    ds_read_b128 v[40:43], v2 offset:10240
    ds_read_b128 v[44:47], v2 offset:10752
    v_mfma_f32_16x16x32_bf16 v[72:75], a[12:15], v[60:63], v[72:75]
    ds_write_b128 v3, v[232:235] offset:32768
    v_mfma_f32_16x16x32_bf16 v[76:79], a[28:31], v[60:63], 0
    v_mfma_f32_16x16x32_bf16 v[76:79], a[24:27], v[56:59], v[76:79]
    v_mfma_f32_16x16x32_bf16 v[76:79], a[20:23], v[52:55], v[76:79]
    v_exp_f32 v72, v72
    v_mfma_f32_16x16x32_bf16 v[76:79], a[16:19], v[48:51], v[76:79]
    v_exp_f32 v73, v73
    v_exp_f32 v74, v74
    buffer_load_dwordx4 v21, s[16:19], s26 offen offset:3072 lds
    v_exp_f32 v75, v75
    v_perm_b32 v236, v73, v72, s35
    v_perm_b32 v237, v75, v74, s35
    s_nop 1
    v_exp_f32 v76, v76
    v_exp_f32 v77, v77
    v_exp_f32 v78, v78
    v_exp_f32 v79, v79
    s_waitcnt lgkmcnt(1)
    v_perm_b32 v238, v77, v76, s35
    v_perm_b32 v239, v79, v78, s35
    v_mfma_f32_16x16x32_bf16 v[64:67], a[0:3], v[32:35], 0
    v_mfma_f32_16x16x32_bf16 v[64:67], a[4:7], v[36:39], v[64:67]
    v_mfma_f32_16x16x32_bf16 v[64:67], a[8:11], v[40:43], v[64:67]
    v_mfma_f32_16x16x32_bf16 v[64:67], a[12:15], v[44:47], v[64:67]
    ds_write_b128 v3, v[236:239] offset:33792
    v_mfma_f32_16x16x32_bf16 v[68:71], a[28:31], v[44:47], 0
    ds_read_b128 v[48:51], v2 offset:12288
    ds_read_b128 v[52:55], v2 offset:12800
    v_mfma_f32_16x16x32_bf16 v[68:71], a[24:27], v[40:43], v[68:71]
    ds_read_b128 v[56:59], v2 offset:14336
    ds_read_b128 v[60:63], v2 offset:14848
    v_mfma_f32_16x16x32_bf16 v[68:71], a[20:23], v[36:39], v[68:71]
    v_exp_f32 v64, v64
    v_mfma_f32_16x16x32_bf16 v[68:71], a[16:19], v[32:35], v[68:71]
    v_exp_f32 v65, v65
    v_smfmac_f32_16x16x64_bf16 v[148:151], v[28:31], v[232:239], v23
    s_add_u32 m0, s27, 102400
    s_add_u32 s26, s26, 0x1000
    buffer_load_dwordx4 v21, s[16:19], s26 offen offset:0 lds
    v_exp_f32 v66, v66
    v_exp_f32 v67, v67
    v_perm_b32 v232, v65, v64, s35
    v_perm_b32 v233, v67, v66, s35
    s_waitcnt vmcnt(8) lgkmcnt(4)
    s_barrier
    v_exp_f32 v68, v68
    v_exp_f32 v69, v69
    v_exp_f32 v70, v70
    s_waitcnt lgkmcnt(0)
    v_exp_f32 v71, v71
    v_mfma_f32_16x16x32_bf16 v[72:75], a[0:3], v[48:51], 0
    v_perm_b32 v234, v69, v68, s35
    v_perm_b32 v235, v71, v70, s35
    v_mfma_f32_16x16x32_bf16 v[72:75], a[4:7], v[52:55], v[72:75]
    ds_read_b128 v[32:35], v2 offset:32768
    ds_read_b128 v[36:39], v2 offset:33280
    v_mfma_f32_16x16x32_bf16 v[72:75], a[8:11], v[56:59], v[72:75]
    ds_read_b128 v[40:43], v2 offset:34816
    ds_read_b128 v[44:47], v2 offset:35328
    v_mfma_f32_16x16x32_bf16 v[72:75], a[12:15], v[60:63], v[72:75]
    ds_write_b128 v3, v[232:235] offset:34816
    v_mfma_f32_16x16x32_bf16 v[76:79], a[28:31], v[60:63], 0
    v_mfma_f32_16x16x32_bf16 v[76:79], a[24:27], v[56:59], v[76:79]
    v_mfma_f32_16x16x32_bf16 v[76:79], a[20:23], v[52:55], v[76:79]
    v_exp_f32 v72, v72
    v_mfma_f32_16x16x32_bf16 v[76:79], a[16:19], v[48:51], v[76:79]
    v_exp_f32 v73, v73
    v_exp_f32 v74, v74
    buffer_load_dwordx4 v21, s[16:19], s26 offen offset:1024 lds
    v_exp_f32 v75, v75
    v_perm_b32 v236, v73, v72, s35
    v_perm_b32 v237, v75, v74, s35
    s_nop 1
    v_exp_f32 v76, v76
    v_exp_f32 v77, v77
    v_exp_f32 v78, v78
    v_exp_f32 v79, v79
    s_waitcnt lgkmcnt(1)
    v_perm_b32 v238, v77, v76, s35
    v_perm_b32 v239, v79, v78, s35
    v_mfma_f32_16x16x32_bf16 v[64:67], a[0:3], v[32:35], 0
    v_mfma_f32_16x16x32_bf16 v[64:67], a[4:7], v[36:39], v[64:67]
    v_mfma_f32_16x16x32_bf16 v[64:67], a[8:11], v[40:43], v[64:67]
    v_mfma_f32_16x16x32_bf16 v[64:67], a[12:15], v[44:47], v[64:67]
    ds_write_b128 v3, v[236:239] offset:35840
    v_mfma_f32_16x16x32_bf16 v[68:71], a[28:31], v[44:47], 0
    ds_read_b128 v[48:51], v2 offset:36864
    ds_read_b128 v[52:55], v2 offset:37376
    v_mfma_f32_16x16x32_bf16 v[68:71], a[24:27], v[40:43], v[68:71]
    ds_read_b128 v[56:59], v2 offset:38912
    ds_read_b128 v[60:63], v2 offset:39424
    v_mfma_f32_16x16x32_bf16 v[68:71], a[20:23], v[36:39], v[68:71]
    v_exp_f32 v64, v64
    v_mfma_f32_16x16x32_bf16 v[68:71], a[16:19], v[32:35], v[68:71]
    v_exp_f32 v65, v65
    v_smfmac_f32_16x16x64_bf16 v[152:155], v[28:31], v[232:239], v23
    buffer_load_dwordx4 v21, s[16:19], s26 offen offset:2048 lds
    v_exp_f32 v66, v66
    v_exp_f32 v67, v67
    v_perm_b32 v232, v65, v64, s35
    v_perm_b32 v233, v67, v66, s35
    s_waitcnt vmcnt(8) lgkmcnt(4)
    s_barrier
    v_exp_f32 v68, v68
    v_exp_f32 v69, v69
    v_exp_f32 v70, v70
    s_waitcnt lgkmcnt(0)
    v_exp_f32 v71, v71
    v_mfma_f32_16x16x32_bf16 v[72:75], a[0:3], v[48:51], 0
    v_perm_b32 v234, v69, v68, s35
    v_perm_b32 v235, v71, v70, s35
    v_mfma_f32_16x16x32_bf16 v[72:75], a[4:7], v[52:55], v[72:75]
    ds_read_b128 v[32:35], v2 offset:40960
    ds_read_b128 v[36:39], v2 offset:41472
    v_mfma_f32_16x16x32_bf16 v[72:75], a[8:11], v[56:59], v[72:75]
    ds_read_b128 v[40:43], v2 offset:43008
    ds_read_b128 v[44:47], v2 offset:43520
    v_mfma_f32_16x16x32_bf16 v[72:75], a[12:15], v[60:63], v[72:75]
    ds_write_b128 v3, v[232:235] offset:36864
    v_mfma_f32_16x16x32_bf16 v[76:79], a[28:31], v[60:63], 0
    v_mfma_f32_16x16x32_bf16 v[76:79], a[24:27], v[56:59], v[76:79]
    v_mfma_f32_16x16x32_bf16 v[76:79], a[20:23], v[52:55], v[76:79]
    v_exp_f32 v72, v72
    v_mfma_f32_16x16x32_bf16 v[76:79], a[16:19], v[48:51], v[76:79]
    v_exp_f32 v73, v73
    v_exp_f32 v74, v74
    buffer_load_dwordx4 v21, s[16:19], s26 offen offset:3072 lds
    v_exp_f32 v75, v75
    v_perm_b32 v236, v73, v72, s35
    v_perm_b32 v237, v75, v74, s35
    s_nop 1
    v_exp_f32 v76, v76
    v_exp_f32 v77, v77
    v_exp_f32 v78, v78
    v_exp_f32 v79, v79
    s_waitcnt lgkmcnt(1)
    v_perm_b32 v238, v77, v76, s35
    v_perm_b32 v239, v79, v78, s35
    v_mfma_f32_16x16x32_bf16 v[64:67], a[0:3], v[32:35], 0
    v_mfma_f32_16x16x32_bf16 v[64:67], a[4:7], v[36:39], v[64:67]
    v_mfma_f32_16x16x32_bf16 v[64:67], a[8:11], v[40:43], v[64:67]
    v_mfma_f32_16x16x32_bf16 v[64:67], a[12:15], v[44:47], v[64:67]
    ds_write_b128 v3, v[236:239] offset:37888
    v_mfma_f32_16x16x32_bf16 v[68:71], a[28:31], v[44:47], 0
    ds_read_b128 v[48:51], v2 offset:45056
    ds_read_b128 v[52:55], v2 offset:45568
    v_mfma_f32_16x16x32_bf16 v[68:71], a[24:27], v[40:43], v[68:71]
    ds_read_b128 v[56:59], v2 offset:47104
    ds_read_b128 v[60:63], v2 offset:47616
    v_mfma_f32_16x16x32_bf16 v[68:71], a[20:23], v[36:39], v[68:71]
    v_exp_f32 v64, v64
    v_mfma_f32_16x16x32_bf16 v[68:71], a[16:19], v[32:35], v[68:71]
    v_exp_f32 v65, v65
    v_smfmac_f32_16x16x64_bf16 v[156:159], v[28:31], v[232:239], v23
    s_add_u32 m0, s24, 57344
    s_mov_b32 s29, 0xa000
    buffer_load_dwordx4 v9, s[8:11], s29 offen lds
    v_exp_f32 v66, v66
    v_exp_f32 v67, v67
    v_perm_b32 v232, v65, v64, s35
    v_perm_b32 v233, v67, v66, s35
    s_waitcnt vmcnt(8) lgkmcnt(4)
    s_barrier
    v_exp_f32 v68, v68
    v_exp_f32 v69, v69
    v_exp_f32 v70, v70
    s_waitcnt lgkmcnt(0)
    v_exp_f32 v71, v71
    v_mfma_f32_16x16x32_bf16 v[72:75], a[0:3], v[48:51], 0
    v_perm_b32 v234, v69, v68, s35
    v_perm_b32 v235, v71, v70, s35
    v_mfma_f32_16x16x32_bf16 v[72:75], a[4:7], v[52:55], v[72:75]
    ds_read_b128 v[32:35], v2 offset:49152
    ds_read_b128 v[36:39], v2 offset:49664
    v_mfma_f32_16x16x32_bf16 v[72:75], a[8:11], v[56:59], v[72:75]
    ds_read_b128 v[40:43], v2 offset:51200
    ds_read_b128 v[44:47], v2 offset:51712
    v_mfma_f32_16x16x32_bf16 v[72:75], a[12:15], v[60:63], v[72:75]
    ds_write_b128 v3, v[232:235] offset:38912
    v_mfma_f32_16x16x32_bf16 v[76:79], a[28:31], v[60:63], 0
    ds_read_b128 v[216:219], v3 offset:32768
    ds_read_b128 v[208:211], v4 offset:32768
    v_mfma_f32_16x16x32_bf16 v[76:79], a[24:27], v[56:59], v[76:79]
    v_mfma_f32_16x16x32_bf16 v[76:79], a[20:23], v[52:55], v[76:79]
    v_exp_f32 v72, v72
    v_mfma_f32_16x16x32_bf16 v[76:79], a[16:19], v[48:51], v[76:79]
    v_exp_f32 v73, v73
    v_exp_f32 v74, v74
    buffer_load_dwordx4 v9, s[8:11], s29 offen offset:1024 lds
    v_exp_f32 v75, v75
    v_perm_b32 v236, v73, v72, s35
    v_perm_b32 v237, v75, v74, s35
    s_nop 1
    v_exp_f32 v76, v76
    v_exp_f32 v77, v77
    v_exp_f32 v78, v78
    v_exp_f32 v79, v79
    s_waitcnt lgkmcnt(3)
    v_perm_b32 v238, v77, v76, s35
    v_perm_b32 v239, v79, v78, s35
    v_mfma_f32_16x16x32_bf16 v[64:67], a[0:3], v[32:35], 0
    ds_read_b128 v[240:243], v5 offset:32768
    ds_read_b128 v[248:251], v6 offset:32768
    v_mfma_f32_16x16x32_bf16 v[64:67], a[4:7], v[36:39], v[64:67]
    ds_read_b128 v[220:223], v3 offset:33792
    ds_read_b128 v[212:215], v4 offset:33792
    v_mfma_f32_16x16x32_bf16 v[64:67], a[8:11], v[40:43], v[64:67]
    ds_read_b128 v[244:247], v5 offset:33792
    ds_read_b128 v[252:255], v6 offset:33792
    v_mfma_f32_16x16x32_bf16 v[64:67], a[12:15], v[44:47], v[64:67]
    ds_write_b128 v3, v[236:239] offset:39936
    v_mfma_f32_16x16x32_bf16 v[68:71], a[28:31], v[44:47], 0
    ds_read_b128 v[48:51], v2 offset:53248
    ds_read_b128 v[52:55], v2 offset:53760
    v_mfma_f32_16x16x32_bf16 v[68:71], a[24:27], v[40:43], v[68:71]
    ds_read_b128 v[56:59], v2 offset:55296
    ds_read_b128 v[60:63], v2 offset:55808
    v_mfma_f32_16x16x32_bf16 v[68:71], a[20:23], v[36:39], v[68:71]
    v_exp_f32 v64, v64
    v_mfma_f32_16x16x32_bf16 v[68:71], a[16:19], v[32:35], v[68:71]
    s_add_u32 s25, s25, 0x1000
    buffer_load_dwordx4 a[32:35], v10, s[12:15], s25 offen offset:0
    buffer_load_dwordx4 a[36:39], v10, s[12:15], s25 offen offset:64
    s_mov_b64 exec, 0
    s_bitcmp0_b32 s28, 0
    s_cbranch_scc1 L_s10
    s_branch L_s11
L_ce4B:
    s_mov_b64 exec, -1
    buffer_load_dwordx4 a[40:43], v10, s[12:15], s25 offen offset:128
    buffer_load_dwordx4 a[44:47], v10, s[12:15], s25 offen offset:192
    s_add_u32 s25, s25, 0x1000
    buffer_load_dwordx4 a[48:51], v10, s[12:15], s25 offen offset:0
    buffer_load_dwordx4 a[52:55], v10, s[12:15], s25 offen offset:64
    s_waitcnt vmcnt(8) lgkmcnt(4)
    s_barrier
    ds_read_b64_tr_b16 a[128:129], v13 offset:0
    ds_read_b64_tr_b16 a[130:131], v13 offset:4096
    ds_read_b64_tr_b16 a[132:133], v13 offset:8
    ds_read_b64_tr_b16 a[134:135], v13 offset:4104
    ds_read_b64_tr_b16 a[160:161], v14 offset:0
    ds_read_b64_tr_b16 a[162:163], v14 offset:4096
    ds_read_b64_tr_b16 a[164:165], v14 offset:8
    ds_read_b64_tr_b16 a[166:167], v14 offset:4104
    ds_read_b64_tr_b16 a[192:193], v15 offset:0
    ds_read_b64_tr_b16 a[194:195], v15 offset:4096
    ds_read_b64_tr_b16 a[196:197], v15 offset:8
    ds_read_b64_tr_b16 a[198:199], v15 offset:4104
    ds_read_b64_tr_b16 a[224:225], v16 offset:0
    ds_read_b64_tr_b16 a[226:227], v16 offset:4096
    ds_read_b64_tr_b16 a[228:229], v16 offset:8
    ds_read_b64_tr_b16 a[230:231], v16 offset:4104
    v_exp_f32 v65, v65
    v_smfmac_f32_16x16x64_bf16 v[160:163], v[28:31], v[232:239], v23
    s_waitcnt lgkmcnt(0)
    buffer_load_dwordx4 a[56:59], v10, s[12:15], s25 offen offset:128
    buffer_load_dwordx4 a[60:63], v10, s[12:15], s25 offen offset:192
    s_add_u32 m0, s27, 131072
    s_add_u32 s26, s26, 0x1000
    buffer_load_dwordx4 v21, s[16:19], s26 offen offset:0 lds
    s_waitcnt vmcnt(8)
    v_mfma_f32_16x16x16_bf16 v[200:203], v[88:89], a[32:33], 0
    v_mfma_f32_16x16x16_bf16 v[200:203], v[90:91], a[32:33], v[200:203]
    v_mfma_f32_16x16x32_bf16 v[80:83], a[128:131], v[216:219], 0
    v_exp_f32 v66, v66
    v_mfma_f32_16x16x32_bf16 v[80:83], a[160:163], v[208:211], v[80:83]
    v_exp_f32 v67, v67
    v_mfma_f32_16x16x32_bf16 v[80:83], a[192:195], v[240:243], v[80:83]
    v_perm_b32 v232, v65, v64, s35
    v_perm_b32 v233, v67, v66, s35
    v_mfma_f32_16x16x32_bf16 v[80:83], a[224:227], v[248:251], v[80:83]
    v_mfma_f32_16x16x32_bf16 v[84:87], a[228:231], v[248:251], 0
    v_exp_f32 v68, v68
    v_mfma_f32_16x16x32_bf16 v[84:87], a[196:199], v[240:243], v[84:87]
    v_exp_f32 v69, v69
    v_mfma_f32_16x16x32_bf16 v[84:87], a[164:167], v[208:211], v[84:87]
    v_exp_f32 v70, v70
    v_mfma_f32_16x16x32_bf16 v[84:87], a[132:135], v[216:219], v[84:87]
    v_exp_f32 v71, v71
    v_mfma_f32_16x16x16_bf16 v[204:207], v[88:89], a[34:35], 0
    v_cvt_pk_bf16_f32 v200, v200, v201
    v_cvt_pk_bf16_f32 v202, v202, v203
    v_mfma_f32_16x16x16_bf16 v[204:207], v[90:91], a[34:35], v[204:207]
    v_accvgpr_write_b32 a32, v200
    v_accvgpr_write_b32 a33, v202
    v_mfma_f32_16x16x32_bf16 v[72:75], a[0:3], v[48:51], 0
    v_perm_b32 v234, v69, v68, s35
    v_perm_b32 v235, v71, v70, s35
    v_mfma_f32_16x16x32_bf16 v[72:75], a[4:7], v[52:55], v[72:75]
    buffer_load_dwordx4 v21, s[16:19], s26 offen offset:1024 lds
    v_mfma_f32_16x16x32_bf16 v[72:75], a[8:11], v[56:59], v[72:75]
    v_mfma_f32_16x16x32_bf16 v[72:75], a[12:15], v[60:63], v[72:75]
    ds_write_b128 v3, v[232:235] offset:32768
    v_mfma_f32_16x16x32_bf16 v[76:79], a[28:31], v[60:63], 0
    ds_read_b128 v[216:219], v3 offset:34816
    ds_read_b128 v[208:211], v4 offset:34816
    v_mfma_f32_16x16x32_bf16 v[76:79], a[24:27], v[56:59], v[76:79]
    v_mfma_f32_16x16x32_bf16 v[76:79], a[20:23], v[52:55], v[76:79]
    v_exp_f32 v72, v72
    v_mfma_f32_16x16x32_bf16 v[76:79], a[16:19], v[48:51], v[76:79]
    v_exp_f32 v73, v73
    s_barrier
    ds_read_b128 v[32:35], v2 offset:57344
    ds_read_b128 v[36:39], v2 offset:57856
    ds_read_b128 v[40:43], v2 offset:59392
    ds_read_b128 v[44:47], v2 offset:59904
    s_waitcnt vmcnt(8)
    v_mfma_f32_16x16x16_bf16 v[200:203], v[88:89], a[36:37], 0
    v_cvt_pk_bf16_f32 v204, v204, v205
    v_cvt_pk_bf16_f32 v206, v206, v207
    v_mfma_f32_16x16x16_bf16 v[200:203], v[90:91], a[36:37], v[200:203]
    v_accvgpr_write_b32 a34, v204
    v_accvgpr_write_b32 a35, v206
    v_mfma_f32_16x16x32_bf16 v[92:95], a[128:131], v[220:223], 0
    v_exp_f32 v74, v74
    v_mfma_f32_16x16x32_bf16 v[92:95], a[160:163], v[212:215], v[92:95]
    v_exp_f32 v75, v75
    v_mfma_f32_16x16x32_bf16 v[92:95], a[192:195], v[244:247], v[92:95]
    v_perm_b32 v236, v73, v72, s35
    v_perm_b32 v237, v75, v74, s35
    v_mfma_f32_16x16x32_bf16 v[92:95], a[224:227], v[252:255], v[92:95]
    v_exp_f32 v76, v76
    v_mfma_f32_16x16x16_bf16 v[204:207], v[88:89], a[38:39], 0
    v_cvt_pk_bf16_f32 v200, v200, v201
    v_cvt_pk_bf16_f32 v202, v202, v203
    v_mfma_f32_16x16x16_bf16 v[204:207], v[90:91], a[38:39], v[204:207]
    v_accvgpr_write_b32 a36, v200
    v_accvgpr_write_b32 a37, v202
    v_mfma_f32_16x16x32_bf16 v[96:99], a[228:231], v[252:255], 0
    v_exp_f32 v77, v77
    v_mfma_f32_16x16x32_bf16 v[96:99], a[196:199], v[244:247], v[96:99]
    v_exp_f32 v78, v78
    v_mfma_f32_16x16x32_bf16 v[96:99], a[164:167], v[212:215], v[96:99]
    v_exp_f32 v79, v79
    v_mfma_f32_16x16x32_bf16 v[96:99], a[132:135], v[220:223], v[96:99]
    s_waitcnt lgkmcnt(0)
    v_perm_b32 v238, v77, v76, s35
    v_perm_b32 v239, v79, v78, s35
    buffer_load_dwordx4 v21, s[16:19], s26 offen offset:2048 lds
    s_waitcnt vmcnt(8)
    v_mfma_f32_16x16x16_bf16 v[200:203], v[88:89], a[40:41], 0
    v_cvt_pk_bf16_f32 v204, v204, v205
    v_cvt_pk_bf16_f32 v206, v206, v207
    v_mfma_f32_16x16x16_bf16 v[200:203], v[90:91], a[40:41], v[200:203]
    v_accvgpr_write_b32 a38, v204
    v_accvgpr_write_b32 a39, v206
    v_mfma_f32_16x16x32_bf16 v[64:67], a[0:3], v[32:35], 0
    ds_read_b128 v[240:243], v5 offset:34816
    ds_read_b128 v[248:251], v6 offset:34816
    v_mfma_f32_16x16x32_bf16 v[64:67], a[4:7], v[36:39], v[64:67]
    ds_read_b128 v[220:223], v3 offset:35840
    ds_read_b128 v[212:215], v4 offset:35840
    v_mfma_f32_16x16x32_bf16 v[64:67], a[8:11], v[40:43], v[64:67]
    ds_read_b128 v[244:247], v5 offset:35840
    ds_read_b128 v[252:255], v6 offset:35840
    v_mfma_f32_16x16x32_bf16 v[64:67], a[12:15], v[44:47], v[64:67]
    ds_write_b128 v3, v[236:239] offset:33792
    v_mfma_f32_16x16x16_bf16 v[204:207], v[88:89], a[42:43], 0
    v_cvt_pk_bf16_f32 v200, v200, v201
    v_cvt_pk_bf16_f32 v202, v202, v203
    v_mfma_f32_16x16x16_bf16 v[204:207], v[90:91], a[42:43], v[204:207]
    v_accvgpr_write_b32 a40, v200
    v_accvgpr_write_b32 a41, v202
    v_mfma_f32_16x16x32_bf16 v[68:71], a[28:31], v[44:47], 0
    ds_read_b128 v[48:51], v2 offset:61440
    ds_read_b128 v[52:55], v2 offset:61952
    v_mfma_f32_16x16x32_bf16 v[68:71], a[24:27], v[40:43], v[68:71]
    ds_read_b128 v[56:59], v2 offset:63488
    ds_read_b128 v[60:63], v2 offset:64000
    v_mfma_f32_16x16x32_bf16 v[68:71], a[20:23], v[36:39], v[68:71]
    v_exp_f32 v64, v64
    v_mfma_f32_16x16x32_bf16 v[68:71], a[16:19], v[32:35], v[68:71]
    v_exp_f32 v65, v65
    v_smfmac_f32_16x16x64_bf16 v[224:227], v[28:31], v[232:239], v23
    s_waitcnt lgkmcnt(9)
    buffer_load_dwordx4 v21, s[16:19], s26 offen offset:3072 lds
    s_waitcnt vmcnt(8)
    v_mfma_f32_16x16x16_bf16 v[200:203], v[88:89], a[44:45], 0
    v_cvt_pk_bf16_f32 v204, v204, v205
    v_cvt_pk_bf16_f32 v206, v206, v207
    v_mfma_f32_16x16x16_bf16 v[200:203], v[90:91], a[44:45], v[200:203]
    v_accvgpr_write_b32 a42, v204
    v_accvgpr_write_b32 a43, v206
    v_mfma_f32_16x16x32_bf16 v[100:103], a[128:131], v[216:219], 0
    v_exp_f32 v66, v66
    v_mfma_f32_16x16x32_bf16 v[100:103], a[160:163], v[208:211], v[100:103]
    v_exp_f32 v67, v67
    v_mfma_f32_16x16x32_bf16 v[100:103], a[192:195], v[240:243], v[100:103]
    v_perm_b32 v232, v65, v64, s35
    v_perm_b32 v233, v67, v66, s35
    v_mfma_f32_16x16x32_bf16 v[100:103], a[224:227], v[248:251], v[100:103]
    s_waitcnt lgkmcnt(4)
    s_barrier
    v_mfma_f32_16x16x32_bf16 v[104:107], a[228:231], v[248:251], 0
    v_exp_f32 v68, v68
    v_mfma_f32_16x16x32_bf16 v[104:107], a[196:199], v[240:243], v[104:107]
    v_exp_f32 v69, v69
    v_mfma_f32_16x16x32_bf16 v[104:107], a[164:167], v[208:211], v[104:107]
    v_exp_f32 v70, v70
    v_mfma_f32_16x16x32_bf16 v[104:107], a[132:135], v[216:219], v[104:107]
    s_waitcnt lgkmcnt(0)
    v_exp_f32 v71, v71
    v_mfma_f32_16x16x16_bf16 v[204:207], v[88:89], a[46:47], 0
    v_cvt_pk_bf16_f32 v200, v200, v201
    v_cvt_pk_bf16_f32 v202, v202, v203
    v_mfma_f32_16x16x16_bf16 v[204:207], v[90:91], a[46:47], v[204:207]
    v_accvgpr_write_b32 a44, v200
    v_accvgpr_write_b32 a45, v202
    v_mfma_f32_16x16x32_bf16 v[72:75], a[0:3], v[48:51], 0
    v_perm_b32 v234, v69, v68, s35
    v_perm_b32 v235, v71, v70, s35
    v_mfma_f32_16x16x32_bf16 v[72:75], a[4:7], v[52:55], v[72:75]
    ds_read_b128 v[32:35], v2 offset:0
    ds_read_b128 v[36:39], v2 offset:512
    v_mfma_f32_16x16x32_bf16 v[72:75], a[8:11], v[56:59], v[72:75]
    ds_read_b128 v[40:43], v2 offset:2048
    ds_read_b128 v[44:47], v2 offset:2560
    v_mfma_f32_16x16x32_bf16 v[72:75], a[12:15], v[60:63], v[72:75]
    ds_write_b128 v3, v[232:235] offset:34816
    v_mfma_f32_16x16x32_bf16 v[76:79], a[28:31], v[60:63], 0
    ds_read_b128 v[216:219], v3 offset:36864
    ds_read_b128 v[208:211], v4 offset:36864
    v_mfma_f32_16x16x32_bf16 v[76:79], a[24:27], v[56:59], v[76:79]
    s_add_u32 m0, s27, 135168
    s_add_u32 s26, s26, 0x1000
    v_mfma_f32_16x16x32_bf16 v[76:79], a[20:23], v[52:55], v[76:79]
    buffer_load_dwordx4 v21, s[16:19], s26 offen offset:0 lds
    v_mfma_f32_16x16x32_bf16 v[76:79], a[16:19], v[48:51], v[76:79]
    v_exp_f32 v72, v72
    v_exp_f32 v73, v73
    s_waitcnt vmcnt(8)
    v_mfma_f32_16x16x16_bf16 v[200:203], v[88:89], a[48:49], 0
    v_cvt_pk_bf16_f32 v204, v204, v205
    v_cvt_pk_bf16_f32 v206, v206, v207
    v_mfma_f32_16x16x16_bf16 v[200:203], v[90:91], a[48:49], v[200:203]
    v_accvgpr_write_b32 a46, v204
    v_accvgpr_write_b32 a47, v206
    v_mfma_f32_16x16x32_bf16 v[108:111], a[128:131], v[220:223], 0
    v_exp_f32 v74, v74
    v_mfma_f32_16x16x32_bf16 v[108:111], a[160:163], v[212:215], v[108:111]
    v_exp_f32 v75, v75
    v_mfma_f32_16x16x32_bf16 v[108:111], a[192:195], v[244:247], v[108:111]
    v_perm_b32 v236, v73, v72, s35
    v_perm_b32 v237, v75, v74, s35
    v_mfma_f32_16x16x32_bf16 v[108:111], a[224:227], v[252:255], v[108:111]
    v_exp_f32 v76, v76
    v_mfma_f32_16x16x16_bf16 v[204:207], v[88:89], a[50:51], 0
    v_cvt_pk_bf16_f32 v200, v200, v201
    v_cvt_pk_bf16_f32 v202, v202, v203
    v_mfma_f32_16x16x16_bf16 v[204:207], v[90:91], a[50:51], v[204:207]
    v_accvgpr_write_b32 a48, v200
    v_accvgpr_write_b32 a49, v202
    v_mfma_f32_16x16x32_bf16 v[112:115], a[228:231], v[252:255], 0
    v_exp_f32 v77, v77
    v_mfma_f32_16x16x32_bf16 v[112:115], a[196:199], v[244:247], v[112:115]
    v_exp_f32 v78, v78
    v_mfma_f32_16x16x32_bf16 v[112:115], a[164:167], v[212:215], v[112:115]
    v_exp_f32 v79, v79
    v_mfma_f32_16x16x32_bf16 v[112:115], a[132:135], v[220:223], v[112:115]
    s_waitcnt lgkmcnt(3)
    v_perm_b32 v238, v77, v76, s35
    v_perm_b32 v239, v79, v78, s35
    buffer_load_dwordx4 v21, s[16:19], s26 offen offset:1024 lds
    s_waitcnt vmcnt(8)
    v_mfma_f32_16x16x16_bf16 v[200:203], v[88:89], a[52:53], 0
    v_cvt_pk_bf16_f32 v204, v204, v205
    v_cvt_pk_bf16_f32 v206, v206, v207
    v_mfma_f32_16x16x16_bf16 v[200:203], v[90:91], a[52:53], v[200:203]
    v_accvgpr_write_b32 a50, v204
    v_accvgpr_write_b32 a51, v206
    v_mfma_f32_16x16x16_bf16 v[204:207], v[88:89], a[54:55], 0
    s_nop 4
    v_cvt_pk_bf16_f32 v200, v200, v201
    v_cvt_pk_bf16_f32 v202, v202, v203
    v_mfma_f32_16x16x16_bf16 v[204:207], v[90:91], a[54:55], v[204:207]
    v_accvgpr_write_b32 a52, v200
    v_accvgpr_write_b32 a53, v202
    buffer_load_dwordx4 v21, s[16:19], s26 offen offset:2048 lds
    s_waitcnt vmcnt(8)
    v_mfma_f32_16x16x16_bf16 v[200:203], v[88:89], a[56:57], 0
    s_nop 2
    v_cvt_pk_bf16_f32 v204, v204, v205
    v_cvt_pk_bf16_f32 v206, v206, v207
    v_mfma_f32_16x16x16_bf16 v[200:203], v[90:91], a[56:57], v[200:203]
    v_accvgpr_write_b32 a54, v204
    v_accvgpr_write_b32 a55, v206
    v_mfma_f32_16x16x16_bf16 v[204:207], v[88:89], a[58:59], 0
    s_nop 4
    v_cvt_pk_bf16_f32 v200, v200, v201
    v_cvt_pk_bf16_f32 v202, v202, v203
    v_mfma_f32_16x16x16_bf16 v[204:207], v[90:91], a[58:59], v[204:207]
    v_accvgpr_write_b32 a56, v200
    v_accvgpr_write_b32 a57, v202
    buffer_load_dwordx4 v21, s[16:19], s26 offen offset:3072 lds
    s_waitcnt vmcnt(8)
    v_mfma_f32_16x16x16_bf16 v[200:203], v[88:89], a[60:61], 0
    s_nop 2
    v_cvt_pk_bf16_f32 v204, v204, v205
    v_cvt_pk_bf16_f32 v206, v206, v207
    v_mfma_f32_16x16x16_bf16 v[200:203], v[90:91], a[60:61], v[200:203]
    v_accvgpr_write_b32 a58, v204
    v_accvgpr_write_b32 a59, v206
    v_mfma_f32_16x16x16_bf16 v[204:207], v[88:89], a[62:63], 0
    s_nop 4
    v_cvt_pk_bf16_f32 v200, v200, v201
    v_cvt_pk_bf16_f32 v202, v202, v203
    v_mfma_f32_16x16x16_bf16 v[204:207], v[90:91], a[62:63], v[204:207]
    v_accvgpr_write_b32 a60, v200
    v_accvgpr_write_b32 a61, v202
    s_nop 5
    v_cvt_pk_bf16_f32 v204, v204, v205
    v_cvt_pk_bf16_f32 v206, v206, v207
    v_accvgpr_write_b32 a62, v204
    v_accvgpr_write_b32 a63, v206
    v_mfma_f32_16x16x32_bf16 v[64:67], a[32:35], v[32:35], 0
    ds_read_b128 v[240:243], v5 offset:36864
    ds_read_b128 v[248:251], v6 offset:36864
    v_mfma_f32_16x16x32_bf16 v[64:67], a[36:39], v[36:39], v[64:67]
    ds_read_b128 v[220:223], v3 offset:37888
    ds_read_b128 v[212:215], v4 offset:37888
    v_mfma_f32_16x16x32_bf16 v[64:67], a[40:43], v[40:43], v[64:67]
    ds_read_b128 v[244:247], v5 offset:37888
    ds_read_b128 v[252:255], v6 offset:37888
    v_mfma_f32_16x16x32_bf16 v[64:67], a[44:47], v[44:47], v[64:67]
    ds_write_b128 v3, v[236:239] offset:35840
    v_mfma_f32_16x16x32_bf16 v[68:71], a[60:63], v[44:47], 0
    ds_read_b128 v[48:51], v2 offset:4096
    ds_read_b128 v[52:55], v2 offset:4608
    v_mfma_f32_16x16x32_bf16 v[68:71], a[56:59], v[40:43], v[68:71]
    ds_read_b128 v[56:59], v2 offset:6144
    ds_read_b128 v[60:63], v2 offset:6656
    v_mfma_f32_16x16x32_bf16 v[68:71], a[52:55], v[36:39], v[68:71]
    v_exp_f32 v64, v64
    v_mfma_f32_16x16x32_bf16 v[68:71], a[48:51], v[32:35], v[68:71]
    v_exp_f32 v65, v65
    v_smfmac_f32_16x16x64_bf16 v[228:231], v[28:31], v[232:239], v23
    s_waitcnt lgkmcnt(9)
    s_add_u32 s25, s25, 0x1000
    buffer_load_dwordx4 a[64:67], v10, s[12:15], s25 offen offset:0
    v_mfma_f32_16x16x32_bf16 v[116:119], a[128:131], v[216:219], 0
    v_exp_f32 v66, v66
    v_mfma_f32_16x16x32_bf16 v[116:119], a[160:163], v[208:211], v[116:119]
    v_exp_f32 v67, v67
    v_mfma_f32_16x16x32_bf16 v[116:119], a[192:195], v[240:243], v[116:119]
    v_perm_b32 v232, v65, v64, s35
    v_perm_b32 v233, v67, v66, s35
    v_mfma_f32_16x16x32_bf16 v[116:119], a[224:227], v[248:251], v[116:119]
    s_waitcnt lgkmcnt(4)
    s_barrier
    v_mfma_f32_16x16x32_bf16 v[120:123], a[228:231], v[248:251], 0
    v_exp_f32 v68, v68
    v_mfma_f32_16x16x32_bf16 v[120:123], a[196:199], v[240:243], v[120:123]
    v_exp_f32 v69, v69
    v_mfma_f32_16x16x32_bf16 v[120:123], a[164:167], v[208:211], v[120:123]
    v_exp_f32 v70, v70
    v_mfma_f32_16x16x32_bf16 v[120:123], a[132:135], v[216:219], v[120:123]
L_s7:
    s_cbranch_execz L_cep
L_s7_n:
    s_waitcnt lgkmcnt(0)
    v_exp_f32 v71, v71
    v_mfma_f32_16x16x32_bf16 v[72:75], a[32:35], v[48:51], 0
    v_perm_b32 v234, v69, v68, s35
    v_perm_b32 v235, v71, v70, s35
    v_mfma_f32_16x16x32_bf16 v[72:75], a[36:39], v[52:55], v[72:75]
    ds_read_b128 v[32:35], v2 offset:8192
    ds_read_b128 v[36:39], v2 offset:8704
    v_mfma_f32_16x16x32_bf16 v[72:75], a[40:43], v[56:59], v[72:75]
    ds_read_b128 v[40:43], v2 offset:10240
    ds_read_b128 v[44:47], v2 offset:10752
    v_mfma_f32_16x16x32_bf16 v[72:75], a[44:47], v[60:63], v[72:75]
    ds_write_b128 v3, v[232:235] offset:36864
    v_mfma_f32_16x16x32_bf16 v[76:79], a[60:63], v[60:63], 0
    ds_read_b128 v[216:219], v3 offset:38912
    ds_read_b128 v[208:211], v4 offset:38912
    v_mfma_f32_16x16x32_bf16 v[76:79], a[56:59], v[56:59], v[76:79]
    buffer_load_dwordx4 a[68:71], v10, s[12:15], s25 offen offset:64
    v_mfma_f32_16x16x32_bf16 v[76:79], a[52:55], v[52:55], v[76:79]
    v_exp_f32 v72, v72
    v_mfma_f32_16x16x32_bf16 v[76:79], a[48:51], v[48:51], v[76:79]
    v_exp_f32 v73, v73
    v_mfma_f32_16x16x32_bf16 v[124:127], a[128:131], v[220:223], 0
    v_exp_f32 v74, v74
    v_mfma_f32_16x16x32_bf16 v[124:127], a[160:163], v[212:215], v[124:127]
    v_exp_f32 v75, v75
    v_mfma_f32_16x16x32_bf16 v[124:127], a[192:195], v[244:247], v[124:127]
    v_perm_b32 v236, v73, v72, s35
    v_perm_b32 v237, v75, v74, s35
    v_mfma_f32_16x16x32_bf16 v[124:127], a[224:227], v[252:255], v[124:127]
    v_exp_f32 v76, v76
    v_mfma_f32_16x16x32_bf16 v[128:131], a[228:231], v[252:255], 0
    v_exp_f32 v77, v77
    v_mfma_f32_16x16x32_bf16 v[128:131], a[196:199], v[244:247], v[128:131]
    v_exp_f32 v78, v78
    v_mfma_f32_16x16x32_bf16 v[128:131], a[164:167], v[212:215], v[128:131]
    v_exp_f32 v79, v79
    v_mfma_f32_16x16x32_bf16 v[128:131], a[132:135], v[220:223], v[128:131]
    s_waitcnt lgkmcnt(3)
    v_perm_b32 v238, v77, v76, s35
    v_perm_b32 v239, v79, v78, s35
    v_mfma_f32_16x16x32_bf16 v[64:67], a[32:35], v[32:35], 0
    ds_read_b128 v[240:243], v5 offset:38912
    ds_read_b128 v[248:251], v6 offset:38912
    v_mfma_f32_16x16x32_bf16 v[64:67], a[36:39], v[36:39], v[64:67]
    ds_read_b128 v[220:223], v3 offset:39936
    ds_read_b128 v[212:215], v4 offset:39936
    v_mfma_f32_16x16x32_bf16 v[64:67], a[40:43], v[40:43], v[64:67]
    ds_read_b128 v[244:247], v5 offset:39936
    ds_read_b128 v[252:255], v6 offset:39936
    v_mfma_f32_16x16x32_bf16 v[64:67], a[44:47], v[44:47], v[64:67]
    ds_write_b128 v3, v[236:239] offset:37888
    v_mfma_f32_16x16x32_bf16 v[68:71], a[60:63], v[44:47], 0
    ds_read_b128 v[48:51], v2 offset:12288
    ds_read_b128 v[52:55], v2 offset:12800
    v_mfma_f32_16x16x32_bf16 v[68:71], a[56:59], v[40:43], v[68:71]
    ds_read_b128 v[56:59], v2 offset:14336
    ds_read_b128 v[60:63], v2 offset:14848
    v_mfma_f32_16x16x32_bf16 v[68:71], a[52:55], v[36:39], v[68:71]
    v_exp_f32 v64, v64
    v_mfma_f32_16x16x32_bf16 v[68:71], a[48:51], v[32:35], v[68:71]
    v_exp_f32 v65, v65
    v_smfmac_f32_16x16x64_bf16 v[148:151], v[28:31], v[232:239], v23
    s_waitcnt lgkmcnt(9)
    buffer_load_dwordx4 a[72:75], v10, s[12:15], s25 offen offset:128
    v_mfma_f32_16x16x32_bf16 v[132:135], a[128:131], v[216:219], 0
    v_exp_f32 v66, v66
    v_mfma_f32_16x16x32_bf16 v[132:135], a[160:163], v[208:211], v[132:135]
    v_exp_f32 v67, v67
    v_mfma_f32_16x16x32_bf16 v[132:135], a[192:195], v[240:243], v[132:135]
    v_perm_b32 v232, v65, v64, s35
    v_perm_b32 v233, v67, v66, s35
    v_mfma_f32_16x16x32_bf16 v[132:135], a[224:227], v[248:251], v[132:135]
    s_waitcnt lgkmcnt(4)
    s_barrier
    v_mfma_f32_16x16x32_bf16 v[136:139], a[228:231], v[248:251], 0
    v_exp_f32 v68, v68
    v_mfma_f32_16x16x32_bf16 v[136:139], a[196:199], v[240:243], v[136:139]
    v_exp_f32 v69, v69
    v_mfma_f32_16x16x32_bf16 v[136:139], a[164:167], v[208:211], v[136:139]
    v_exp_f32 v70, v70
    v_mfma_f32_16x16x32_bf16 v[136:139], a[132:135], v[216:219], v[136:139]
    s_waitcnt lgkmcnt(0)
    v_exp_f32 v71, v71
    v_mfma_f32_16x16x32_bf16 v[72:75], a[32:35], v[48:51], 0
    v_perm_b32 v234, v69, v68, s35
    v_perm_b32 v235, v71, v70, s35
    v_mfma_f32_16x16x32_bf16 v[72:75], a[36:39], v[52:55], v[72:75]
    ds_read_b128 v[32:35], v2 offset:32768
    ds_read_b128 v[36:39], v2 offset:33280
    v_mfma_f32_16x16x32_bf16 v[72:75], a[40:43], v[56:59], v[72:75]
    ds_read_b128 v[40:43], v2 offset:34816
    ds_read_b128 v[44:47], v2 offset:35328
    v_mfma_f32_16x16x32_bf16 v[72:75], a[44:47], v[60:63], v[72:75]
    ds_write_b128 v3, v[232:235] offset:38912
    v_mfma_f32_16x16x32_bf16 v[76:79], a[60:63], v[60:63], 0
    ds_read_b128 v[216:219], v3 offset:32768
    ds_read_b128 v[208:211], v4 offset:32768
    v_mfma_f32_16x16x32_bf16 v[76:79], a[56:59], v[56:59], v[76:79]
    buffer_load_dwordx4 a[76:79], v10, s[12:15], s25 offen offset:192
    v_mfma_f32_16x16x32_bf16 v[76:79], a[52:55], v[52:55], v[76:79]
    v_exp_f32 v72, v72
    v_mfma_f32_16x16x32_bf16 v[76:79], a[48:51], v[48:51], v[76:79]
    v_exp_f32 v73, v73
    v_mfma_f32_16x16x32_bf16 v[140:143], a[128:131], v[220:223], 0
    v_exp_f32 v74, v74
    v_mfma_f32_16x16x32_bf16 v[140:143], a[160:163], v[212:215], v[140:143]
    v_exp_f32 v75, v75
    v_mfma_f32_16x16x32_bf16 v[140:143], a[192:195], v[244:247], v[140:143]
    v_perm_b32 v236, v73, v72, s35
    v_perm_b32 v237, v75, v74, s35
    v_mfma_f32_16x16x32_bf16 v[140:143], a[224:227], v[252:255], v[140:143]
    v_exp_f32 v76, v76
    v_mfma_f32_16x16x32_bf16 v[144:147], a[228:231], v[252:255], 0
    v_exp_f32 v77, v77
    v_mfma_f32_16x16x32_bf16 v[144:147], a[196:199], v[244:247], v[144:147]
    v_exp_f32 v78, v78
    v_mfma_f32_16x16x32_bf16 v[144:147], a[164:167], v[212:215], v[144:147]
    v_exp_f32 v79, v79
    v_mfma_f32_16x16x32_bf16 v[144:147], a[132:135], v[220:223], v[144:147]
    s_waitcnt lgkmcnt(3)
    v_perm_b32 v238, v77, v76, s35
    v_perm_b32 v239, v79, v78, s35
    v_mfma_f32_16x16x32_bf16 v[64:67], a[32:35], v[32:35], 0
    ds_read_b128 v[240:243], v5 offset:32768
    ds_read_b128 v[248:251], v6 offset:32768
    v_mfma_f32_16x16x32_bf16 v[64:67], a[36:39], v[36:39], v[64:67]
    ds_read_b128 v[220:223], v3 offset:33792
    ds_read_b128 v[212:215], v4 offset:33792
    v_mfma_f32_16x16x32_bf16 v[64:67], a[40:43], v[40:43], v[64:67]
    ds_read_b128 v[244:247], v5 offset:33792
    ds_read_b128 v[252:255], v6 offset:33792
    v_mfma_f32_16x16x32_bf16 v[64:67], a[44:47], v[44:47], v[64:67]
    ds_write_b128 v3, v[236:239] offset:39936
    v_mfma_f32_16x16x32_bf16 v[68:71], a[60:63], v[44:47], 0
    ds_read_b128 v[48:51], v2 offset:36864
    ds_read_b128 v[52:55], v2 offset:37376
    v_mfma_f32_16x16x32_bf16 v[68:71], a[56:59], v[40:43], v[68:71]
    ds_read_b128 v[56:59], v2 offset:38912
    ds_read_b128 v[60:63], v2 offset:39424
    v_mfma_f32_16x16x32_bf16 v[68:71], a[52:55], v[36:39], v[68:71]
    v_exp_f32 v64, v64
    v_mfma_f32_16x16x32_bf16 v[68:71], a[48:51], v[32:35], v[68:71]
    v_exp_f32 v65, v65
    v_smfmac_f32_16x16x64_bf16 v[152:155], v[28:31], v[232:239], v23
    s_waitcnt lgkmcnt(9)
    s_add_u32 s25, s25, 0x1000
    buffer_load_dwordx4 a[80:83], v10, s[12:15], s25 offen offset:0
    v_mfma_f32_16x16x32_bf16 v[164:167], a[128:131], v[216:219], 0
    v_exp_f32 v66, v66
    v_mfma_f32_16x16x32_bf16 v[164:167], a[160:163], v[208:211], v[164:167]
    v_exp_f32 v67, v67
    v_mfma_f32_16x16x32_bf16 v[164:167], a[192:195], v[240:243], v[164:167]
    v_perm_b32 v232, v65, v64, s35
    v_perm_b32 v233, v67, v66, s35
    v_mfma_f32_16x16x32_bf16 v[164:167], a[224:227], v[248:251], v[164:167]
    s_waitcnt lgkmcnt(4)
    s_barrier
    v_mfma_f32_16x16x32_bf16 v[168:171], a[228:231], v[248:251], 0
    v_exp_f32 v68, v68
    v_mfma_f32_16x16x32_bf16 v[168:171], a[196:199], v[240:243], v[168:171]
    v_exp_f32 v69, v69
    v_mfma_f32_16x16x32_bf16 v[168:171], a[164:167], v[208:211], v[168:171]
    v_exp_f32 v70, v70
    v_mfma_f32_16x16x32_bf16 v[168:171], a[132:135], v[216:219], v[168:171]
    s_waitcnt lgkmcnt(0)
    v_exp_f32 v71, v71
    v_mfma_f32_16x16x32_bf16 v[72:75], a[32:35], v[48:51], 0
    v_perm_b32 v234, v69, v68, s35
    v_perm_b32 v235, v71, v70, s35
    v_mfma_f32_16x16x32_bf16 v[72:75], a[36:39], v[52:55], v[72:75]
    ds_read_b128 v[32:35], v2 offset:40960
    ds_read_b128 v[36:39], v2 offset:41472
    v_mfma_f32_16x16x32_bf16 v[72:75], a[40:43], v[56:59], v[72:75]
    ds_read_b128 v[40:43], v2 offset:43008
    ds_read_b128 v[44:47], v2 offset:43520
    v_mfma_f32_16x16x32_bf16 v[72:75], a[44:47], v[60:63], v[72:75]
    ds_write_b128 v3, v[232:235] offset:32768
    v_mfma_f32_16x16x32_bf16 v[76:79], a[60:63], v[60:63], 0
    ds_read_b128 v[216:219], v3 offset:34816
    ds_read_b128 v[208:211], v4 offset:34816
    v_mfma_f32_16x16x32_bf16 v[76:79], a[56:59], v[56:59], v[76:79]
    buffer_load_dwordx4 a[84:87], v10, s[12:15], s25 offen offset:64
    v_mfma_f32_16x16x32_bf16 v[76:79], a[52:55], v[52:55], v[76:79]
    v_exp_f32 v72, v72
    v_mfma_f32_16x16x32_bf16 v[76:79], a[48:51], v[48:51], v[76:79]
    v_exp_f32 v73, v73
    v_mfma_f32_16x16x32_bf16 v[172:175], a[128:131], v[220:223], 0
    v_exp_f32 v74, v74
    v_mfma_f32_16x16x32_bf16 v[172:175], a[160:163], v[212:215], v[172:175]
    v_exp_f32 v75, v75
    v_mfma_f32_16x16x32_bf16 v[172:175], a[192:195], v[244:247], v[172:175]
    v_perm_b32 v236, v73, v72, s35
    v_perm_b32 v237, v75, v74, s35
    v_mfma_f32_16x16x32_bf16 v[172:175], a[224:227], v[252:255], v[172:175]
    v_exp_f32 v76, v76
    v_mfma_f32_16x16x32_bf16 v[176:179], a[228:231], v[252:255], 0
    v_exp_f32 v77, v77
    v_mfma_f32_16x16x32_bf16 v[176:179], a[196:199], v[244:247], v[176:179]
    v_exp_f32 v78, v78
    v_mfma_f32_16x16x32_bf16 v[176:179], a[164:167], v[212:215], v[176:179]
    v_exp_f32 v79, v79
    v_mfma_f32_16x16x32_bf16 v[176:179], a[132:135], v[220:223], v[176:179]
    s_waitcnt lgkmcnt(3)
    v_perm_b32 v238, v77, v76, s35
    v_perm_b32 v239, v79, v78, s35
    v_mfma_f32_16x16x32_bf16 v[64:67], a[32:35], v[32:35], 0
    ds_read_b128 v[240:243], v5 offset:34816
    ds_read_b128 v[248:251], v6 offset:34816
    v_mfma_f32_16x16x32_bf16 v[64:67], a[36:39], v[36:39], v[64:67]
    ds_read_b128 v[220:223], v3 offset:35840
    ds_read_b128 v[212:215], v4 offset:35840
    v_mfma_f32_16x16x32_bf16 v[64:67], a[40:43], v[40:43], v[64:67]
    ds_read_b128 v[244:247], v5 offset:35840
    ds_read_b128 v[252:255], v6 offset:35840
    v_mfma_f32_16x16x32_bf16 v[64:67], a[44:47], v[44:47], v[64:67]
    ds_write_b128 v3, v[236:239] offset:33792
    v_mfma_f32_16x16x32_bf16 v[68:71], a[60:63], v[44:47], 0
    ds_read_b128 v[48:51], v2 offset:45056
    ds_read_b128 v[52:55], v2 offset:45568
    v_mfma_f32_16x16x32_bf16 v[68:71], a[56:59], v[40:43], v[68:71]
    ds_read_b128 v[56:59], v2 offset:47104
    ds_read_b128 v[60:63], v2 offset:47616
    v_mfma_f32_16x16x32_bf16 v[68:71], a[52:55], v[36:39], v[68:71]
    v_exp_f32 v64, v64
    v_mfma_f32_16x16x32_bf16 v[68:71], a[48:51], v[32:35], v[68:71]
    v_exp_f32 v65, v65
    v_smfmac_f32_16x16x64_bf16 v[156:159], v[28:31], v[232:239], v23
    s_waitcnt lgkmcnt(9)
    buffer_load_dwordx4 a[88:91], v10, s[12:15], s25 offen offset:128
    v_mfma_f32_16x16x32_bf16 v[180:183], a[128:131], v[216:219], 0
    v_exp_f32 v66, v66
    v_mfma_f32_16x16x32_bf16 v[180:183], a[160:163], v[208:211], v[180:183]
    v_exp_f32 v67, v67
    v_mfma_f32_16x16x32_bf16 v[180:183], a[192:195], v[240:243], v[180:183]
    v_perm_b32 v232, v65, v64, s35
    v_perm_b32 v233, v67, v66, s35
    v_mfma_f32_16x16x32_bf16 v[180:183], a[224:227], v[248:251], v[180:183]
    buffer_load_dwordx4 a[92:95], v10, s[12:15], s25 offen offset:192
    s_waitcnt vmcnt(8) lgkmcnt(4)
    s_barrier
    ds_read_b64_tr_b16 a[136:137], v13 offset:32768
    ds_read_b64_tr_b16 a[138:139], v13 offset:36864
    ds_read_b64_tr_b16 a[140:141], v13 offset:32776
    v_mfma_f32_16x16x32_bf16 v[184:187], a[228:231], v[248:251], 0
    v_exp_f32 v68, v68
    v_mfma_f32_16x16x32_bf16 v[184:187], a[196:199], v[240:243], v[184:187]
    v_exp_f32 v69, v69
    v_mfma_f32_16x16x32_bf16 v[184:187], a[164:167], v[208:211], v[184:187]
    v_exp_f32 v70, v70
    v_mfma_f32_16x16x32_bf16 v[184:187], a[132:135], v[216:219], v[184:187]
    s_waitcnt lgkmcnt(3)
    ds_read_b64_tr_b16 a[142:143], v13 offset:36872
    ds_read_b64_tr_b16 a[168:169], v14 offset:32768
    ds_read_b64_tr_b16 a[170:171], v14 offset:36864
    v_exp_f32 v71, v71
    v_mfma_f32_16x16x32_bf16 v[72:75], a[32:35], v[48:51], 0
    v_perm_b32 v234, v69, v68, s35
    v_perm_b32 v235, v71, v70, s35
    v_mfma_f32_16x16x32_bf16 v[72:75], a[36:39], v[52:55], v[72:75]
    ds_read_b128 v[32:35], v2 offset:49152
    ds_read_b128 v[36:39], v2 offset:49664
    v_mfma_f32_16x16x32_bf16 v[72:75], a[40:43], v[56:59], v[72:75]
    ds_read_b128 v[40:43], v2 offset:51200
    ds_read_b128 v[44:47], v2 offset:51712
    v_mfma_f32_16x16x32_bf16 v[72:75], a[44:47], v[60:63], v[72:75]
    ds_write_b128 v3, v[232:235] offset:34816
    v_mfma_f32_16x16x32_bf16 v[76:79], a[60:63], v[60:63], 0
    ds_read_b128 v[216:219], v3 offset:36864
    ds_read_b128 v[208:211], v4 offset:36864
    v_mfma_f32_16x16x32_bf16 v[76:79], a[56:59], v[56:59], v[76:79]
    ds_read_b64_tr_b16 a[172:173], v14 offset:32776
    ds_read_b64_tr_b16 a[174:175], v14 offset:36872
    v_mfma_f32_16x16x32_bf16 v[76:79], a[52:55], v[52:55], v[76:79]
    v_exp_f32 v72, v72
    v_mfma_f32_16x16x32_bf16 v[76:79], a[48:51], v[48:51], v[76:79]
    ds_read_b64_tr_b16 a[200:201], v15 offset:32768
    ds_read_b64_tr_b16 a[202:203], v15 offset:36864
    ds_read_b64_tr_b16 a[204:205], v15 offset:32776
    v_exp_f32 v73, v73
    s_add_u32 m0, s27, 98304
    s_add_u32 s26, s26, 0x1000
    buffer_load_dwordx4 v21, s[16:19], s26 offen offset:0 lds
    s_waitcnt vmcnt(8)
    v_mfma_f32_16x16x16_bf16 v[200:203], v[88:89], a[64:65], 0
    v_mfma_f32_16x16x16_bf16 v[200:203], v[90:91], a[64:65], v[200:203]
    v_mfma_f32_16x16x32_bf16 v[188:191], a[128:131], v[220:223], 0
    v_exp_f32 v74, v74
    v_mfma_f32_16x16x32_bf16 v[188:191], a[160:163], v[212:215], v[188:191]
    v_exp_f32 v75, v75
    v_mfma_f32_16x16x32_bf16 v[188:191], a[192:195], v[244:247], v[188:191]
    v_perm_b32 v236, v73, v72, s35
    v_perm_b32 v237, v75, v74, s35
    v_mfma_f32_16x16x32_bf16 v[188:191], a[224:227], v[252:255], v[188:191]
    ds_read_b64_tr_b16 a[206:207], v15 offset:36872
    ds_read_b64_tr_b16 a[232:233], v16 offset:32768
    ds_read_b64_tr_b16 a[234:235], v16 offset:36864
    v_exp_f32 v76, v76
    v_mfma_f32_16x16x16_bf16 v[204:207], v[88:89], a[66:67], 0
    v_cvt_pk_bf16_f32 v200, v200, v201
    v_cvt_pk_bf16_f32 v202, v202, v203
    v_mfma_f32_16x16x16_bf16 v[204:207], v[90:91], a[66:67], v[204:207]
    v_accvgpr_write_b32 a64, v200
    v_accvgpr_write_b32 a65, v202
    v_mfma_f32_16x16x32_bf16 v[192:195], a[228:231], v[252:255], 0
    v_exp_f32 v77, v77
    v_mfma_f32_16x16x32_bf16 v[192:195], a[196:199], v[244:247], v[192:195]
    v_exp_f32 v78, v78
    v_mfma_f32_16x16x32_bf16 v[192:195], a[164:167], v[212:215], v[192:195]
    v_exp_f32 v79, v79
    v_mfma_f32_16x16x32_bf16 v[192:195], a[132:135], v[220:223], v[192:195]
    s_waitcnt lgkmcnt(11)
    ds_read_b64_tr_b16 a[236:237], v16 offset:32776
    ds_read_b64_tr_b16 a[238:239], v16 offset:36872
    v_perm_b32 v238, v77, v76, s35
    v_perm_b32 v239, v79, v78, s35
    buffer_load_dwordx4 v21, s[16:19], s26 offen offset:1024 lds
    s_waitcnt vmcnt(8)
    v_mfma_f32_16x16x16_bf16 v[200:203], v[88:89], a[68:69], 0
    v_cvt_pk_bf16_f32 v204, v204, v205
    v_cvt_pk_bf16_f32 v206, v206, v207
    v_mfma_f32_16x16x16_bf16 v[200:203], v[90:91], a[68:69], v[200:203]
    v_accvgpr_write_b32 a66, v204
    v_accvgpr_write_b32 a67, v206
    v_mfma_f32_16x16x32_bf16 v[64:67], a[32:35], v[32:35], 0
    ds_read_b128 v[240:243], v5 offset:36864
    ds_read_b128 v[248:251], v6 offset:36864
    v_mfma_f32_16x16x32_bf16 v[64:67], a[36:39], v[36:39], v[64:67]
    ds_read_b128 v[220:223], v3 offset:37888
    ds_read_b128 v[212:215], v4 offset:37888
    v_mfma_f32_16x16x32_bf16 v[64:67], a[40:43], v[40:43], v[64:67]
    ds_read_b128 v[244:247], v5 offset:37888
    ds_read_b128 v[252:255], v6 offset:37888
    v_mfma_f32_16x16x32_bf16 v[64:67], a[44:47], v[44:47], v[64:67]
    ds_write_b128 v3, v[236:239] offset:35840
    v_mfma_f32_16x16x16_bf16 v[204:207], v[88:89], a[70:71], 0
    v_cvt_pk_bf16_f32 v200, v200, v201
    v_cvt_pk_bf16_f32 v202, v202, v203
    v_mfma_f32_16x16x16_bf16 v[204:207], v[90:91], a[70:71], v[204:207]
    v_accvgpr_write_b32 a68, v200
    v_accvgpr_write_b32 a69, v202
    v_mfma_f32_16x16x32_bf16 v[68:71], a[60:63], v[44:47], 0
    ds_read_b128 v[48:51], v2 offset:53248
    ds_read_b128 v[52:55], v2 offset:53760
    v_mfma_f32_16x16x32_bf16 v[68:71], a[56:59], v[40:43], v[68:71]
    ds_read_b128 v[56:59], v2 offset:55296
    ds_read_b128 v[60:63], v2 offset:55808
    v_mfma_f32_16x16x32_bf16 v[68:71], a[52:55], v[36:39], v[68:71]
    v_exp_f32 v64, v64
    v_mfma_f32_16x16x32_bf16 v[68:71], a[48:51], v[32:35], v[68:71]
    v_exp_f32 v65, v65
    v_smfmac_f32_16x16x64_bf16 v[160:163], v[28:31], v[232:239], v23
    s_waitcnt lgkmcnt(9)
    buffer_load_dwordx4 v21, s[16:19], s26 offen offset:2048 lds
    s_waitcnt vmcnt(8)
    v_mfma_f32_16x16x16_bf16 v[200:203], v[88:89], a[72:73], 0
    v_cvt_pk_bf16_f32 v204, v204, v205
    v_cvt_pk_bf16_f32 v206, v206, v207
    v_mfma_f32_16x16x16_bf16 v[200:203], v[90:91], a[72:73], v[200:203]
    v_accvgpr_write_b32 a70, v204
    v_accvgpr_write_b32 a71, v206
    v_mfma_f32_16x16x32_bf16 v[80:83], a[136:139], v[216:219], v[80:83]
    v_exp_f32 v66, v66
    v_mfma_f32_16x16x32_bf16 v[80:83], a[168:171], v[208:211], v[80:83]
    v_exp_f32 v67, v67
    v_mfma_f32_16x16x32_bf16 v[80:83], a[200:203], v[240:243], v[80:83]
    v_perm_b32 v232, v65, v64, s35
    v_perm_b32 v233, v67, v66, s35
    v_mfma_f32_16x16x32_bf16 v[80:83], a[232:235], v[248:251], v[80:83]
    s_waitcnt lgkmcnt(4)
    s_barrier
    v_mfma_f32_16x16x32_bf16 v[84:87], a[236:239], v[248:251], v[84:87]
    v_exp_f32 v68, v68
    v_mfma_f32_16x16x32_bf16 v[84:87], a[204:207], v[240:243], v[84:87]
    v_exp_f32 v69, v69
    v_mfma_f32_16x16x32_bf16 v[84:87], a[172:175], v[208:211], v[84:87]
    v_exp_f32 v70, v70
    v_mfma_f32_16x16x32_bf16 v[84:87], a[140:143], v[216:219], v[84:87]
    s_waitcnt lgkmcnt(0)
    v_exp_f32 v71, v71
    v_mfma_f32_16x16x16_bf16 v[204:207], v[88:89], a[74:75], 0
    v_cvt_pk_bf16_f32 v200, v200, v201
    v_cvt_pk_bf16_f32 v202, v202, v203
    v_mfma_f32_16x16x16_bf16 v[204:207], v[90:91], a[74:75], v[204:207]
    v_accvgpr_write_b32 a72, v200
    v_accvgpr_write_b32 a73, v202
    v_mfma_f32_16x16x32_bf16 v[72:75], a[32:35], v[48:51], 0
    v_perm_b32 v234, v69, v68, s35
    v_perm_b32 v235, v71, v70, s35
    v_mfma_f32_16x16x32_bf16 v[72:75], a[36:39], v[52:55], v[72:75]
    ds_read_b128 v[32:35], v2 offset:57344
    ds_read_b128 v[36:39], v2 offset:57856
    v_mfma_f32_16x16x32_bf16 v[72:75], a[40:43], v[56:59], v[72:75]
    ds_read_b128 v[40:43], v2 offset:59392
    ds_read_b128 v[44:47], v2 offset:59904
    v_mfma_f32_16x16x32_bf16 v[72:75], a[44:47], v[60:63], v[72:75]
    ds_write_b128 v3, v[232:235] offset:36864
    v_mfma_f32_16x16x32_bf16 v[76:79], a[60:63], v[60:63], 0
    ds_read_b128 v[216:219], v3 offset:38912
    ds_read_b128 v[208:211], v4 offset:38912
    v_mfma_f32_16x16x32_bf16 v[76:79], a[56:59], v[56:59], v[76:79]
    buffer_load_dwordx4 v21, s[16:19], s26 offen offset:3072 lds
    v_mfma_f32_16x16x32_bf16 v[76:79], a[52:55], v[52:55], v[76:79]
    v_exp_f32 v72, v72
    v_mfma_f32_16x16x32_bf16 v[76:79], a[48:51], v[48:51], v[76:79]
    v_exp_f32 v73, v73
    s_waitcnt vmcnt(8)
    v_mfma_f32_16x16x16_bf16 v[200:203], v[88:89], a[76:77], 0
    v_cvt_pk_bf16_f32 v204, v204, v205
    v_cvt_pk_bf16_f32 v206, v206, v207
    v_mfma_f32_16x16x16_bf16 v[200:203], v[90:91], a[76:77], v[200:203]
    v_accvgpr_write_b32 a74, v204
    v_accvgpr_write_b32 a75, v206
    v_mfma_f32_16x16x32_bf16 v[92:95], a[136:139], v[220:223], v[92:95]
    v_exp_f32 v74, v74
    v_mfma_f32_16x16x32_bf16 v[92:95], a[168:171], v[212:215], v[92:95]
    v_exp_f32 v75, v75
    v_mfma_f32_16x16x32_bf16 v[92:95], a[200:203], v[244:247], v[92:95]
    v_perm_b32 v236, v73, v72, s35
    v_perm_b32 v237, v75, v74, s35
    v_mfma_f32_16x16x32_bf16 v[92:95], a[232:235], v[252:255], v[92:95]
    v_exp_f32 v76, v76
    v_mfma_f32_16x16x16_bf16 v[204:207], v[88:89], a[78:79], 0
    v_cvt_pk_bf16_f32 v200, v200, v201
    v_cvt_pk_bf16_f32 v202, v202, v203
    v_mfma_f32_16x16x16_bf16 v[204:207], v[90:91], a[78:79], v[204:207]
    v_accvgpr_write_b32 a76, v200
    v_accvgpr_write_b32 a77, v202
    v_mfma_f32_16x16x32_bf16 v[96:99], a[236:239], v[252:255], v[96:99]
    v_exp_f32 v77, v77
    v_mfma_f32_16x16x32_bf16 v[96:99], a[204:207], v[244:247], v[96:99]
    v_exp_f32 v78, v78
    v_mfma_f32_16x16x32_bf16 v[96:99], a[172:175], v[212:215], v[96:99]
    v_exp_f32 v79, v79
    v_mfma_f32_16x16x32_bf16 v[96:99], a[140:143], v[220:223], v[96:99]
    s_waitcnt lgkmcnt(3)
    v_perm_b32 v238, v77, v76, s35
    v_perm_b32 v239, v79, v78, s35
    s_add_u32 m0, s27, 102400
    s_add_u32 s26, s26, 0x1000
    buffer_load_dwordx4 v21, s[16:19], s26 offen offset:0 lds
    s_waitcnt vmcnt(8)
    v_mfma_f32_16x16x16_bf16 v[200:203], v[88:89], a[80:81], 0
    v_cvt_pk_bf16_f32 v204, v204, v205
    v_cvt_pk_bf16_f32 v206, v206, v207
    v_mfma_f32_16x16x16_bf16 v[200:203], v[90:91], a[80:81], v[200:203]
    v_accvgpr_write_b32 a78, v204
    v_accvgpr_write_b32 a79, v206
    v_mfma_f32_16x16x32_bf16 v[64:67], a[32:35], v[32:35], 0
    ds_read_b128 v[240:243], v5 offset:38912
    ds_read_b128 v[248:251], v6 offset:38912
    v_mfma_f32_16x16x32_bf16 v[64:67], a[36:39], v[36:39], v[64:67]
    ds_read_b128 v[220:223], v3 offset:39936
    ds_read_b128 v[212:215], v4 offset:39936
    v_mfma_f32_16x16x32_bf16 v[64:67], a[40:43], v[40:43], v[64:67]
    ds_read_b128 v[244:247], v5 offset:39936
    ds_read_b128 v[252:255], v6 offset:39936
    v_mfma_f32_16x16x32_bf16 v[64:67], a[44:47], v[44:47], v[64:67]
    ds_write_b128 v3, v[236:239] offset:37888
    v_mfma_f32_16x16x16_bf16 v[204:207], v[88:89], a[82:83], 0
    v_cvt_pk_bf16_f32 v200, v200, v201
    v_cvt_pk_bf16_f32 v202, v202, v203
    v_mfma_f32_16x16x16_bf16 v[204:207], v[90:91], a[82:83], v[204:207]
    v_accvgpr_write_b32 a80, v200
    v_accvgpr_write_b32 a81, v202
    v_mfma_f32_16x16x32_bf16 v[68:71], a[60:63], v[44:47], 0
    ds_read_b128 v[48:51], v2 offset:61440
    ds_read_b128 v[52:55], v2 offset:61952
    v_mfma_f32_16x16x32_bf16 v[68:71], a[56:59], v[40:43], v[68:71]
    ds_read_b128 v[56:59], v2 offset:63488
    ds_read_b128 v[60:63], v2 offset:64000
    v_mfma_f32_16x16x32_bf16 v[68:71], a[52:55], v[36:39], v[68:71]
    v_exp_f32 v64, v64
    v_mfma_f32_16x16x32_bf16 v[68:71], a[48:51], v[32:35], v[68:71]
    v_exp_f32 v65, v65
    v_smfmac_f32_16x16x64_bf16 v[224:227], v[28:31], v[232:239], v23
    s_waitcnt lgkmcnt(9)
    buffer_load_dwordx4 v21, s[16:19], s26 offen offset:1024 lds
    s_waitcnt vmcnt(8)
    v_mfma_f32_16x16x16_bf16 v[200:203], v[88:89], a[84:85], 0
    v_cvt_pk_bf16_f32 v204, v204, v205
    v_cvt_pk_bf16_f32 v206, v206, v207
    v_mfma_f32_16x16x16_bf16 v[200:203], v[90:91], a[84:85], v[200:203]
    v_accvgpr_write_b32 a82, v204
    v_accvgpr_write_b32 a83, v206
    v_mfma_f32_16x16x32_bf16 v[100:103], a[136:139], v[216:219], v[100:103]
    v_exp_f32 v66, v66
    v_mfma_f32_16x16x32_bf16 v[100:103], a[168:171], v[208:211], v[100:103]
    v_exp_f32 v67, v67
    v_mfma_f32_16x16x32_bf16 v[100:103], a[200:203], v[240:243], v[100:103]
    v_perm_b32 v232, v65, v64, s35
    v_perm_b32 v233, v67, v66, s35
    v_mfma_f32_16x16x32_bf16 v[100:103], a[232:235], v[248:251], v[100:103]
    s_waitcnt lgkmcnt(4)
    s_barrier
    v_mfma_f32_16x16x32_bf16 v[104:107], a[236:239], v[248:251], v[104:107]
    v_exp_f32 v68, v68
    v_mfma_f32_16x16x32_bf16 v[104:107], a[204:207], v[240:243], v[104:107]
    v_exp_f32 v69, v69
    v_mfma_f32_16x16x32_bf16 v[104:107], a[172:175], v[208:211], v[104:107]
    v_exp_f32 v70, v70
    v_mfma_f32_16x16x32_bf16 v[104:107], a[140:143], v[216:219], v[104:107]
    s_waitcnt lgkmcnt(0)
    v_exp_f32 v71, v71
    v_mfma_f32_16x16x16_bf16 v[204:207], v[88:89], a[86:87], 0
    v_cvt_pk_bf16_f32 v200, v200, v201
    v_cvt_pk_bf16_f32 v202, v202, v203
    v_mfma_f32_16x16x16_bf16 v[204:207], v[90:91], a[86:87], v[204:207]
    v_accvgpr_write_b32 a84, v200
    v_accvgpr_write_b32 a85, v202
    v_mfma_f32_16x16x32_bf16 v[72:75], a[32:35], v[48:51], 0
    v_perm_b32 v234, v69, v68, s35
    v_perm_b32 v235, v71, v70, s35
    v_mfma_f32_16x16x32_bf16 v[72:75], a[36:39], v[52:55], v[72:75]
    ds_read_b128 v[32:35], v2 offset:0
    ds_read_b128 v[36:39], v2 offset:512
    v_mfma_f32_16x16x32_bf16 v[72:75], a[40:43], v[56:59], v[72:75]
    ds_read_b128 v[40:43], v2 offset:2048
    ds_read_b128 v[44:47], v2 offset:2560
    v_mfma_f32_16x16x32_bf16 v[72:75], a[44:47], v[60:63], v[72:75]
    ds_write_b128 v3, v[232:235] offset:38912
    v_mfma_f32_16x16x32_bf16 v[76:79], a[60:63], v[60:63], 0
    ds_read_b128 v[216:219], v3 offset:32768
    ds_read_b128 v[208:211], v4 offset:32768
    v_mfma_f32_16x16x32_bf16 v[76:79], a[56:59], v[56:59], v[76:79]
    buffer_load_dwordx4 v21, s[16:19], s26 offen offset:2048 lds
    v_mfma_f32_16x16x32_bf16 v[76:79], a[52:55], v[52:55], v[76:79]
    v_exp_f32 v72, v72
    v_mfma_f32_16x16x32_bf16 v[76:79], a[48:51], v[48:51], v[76:79]
    v_exp_f32 v73, v73
    s_waitcnt vmcnt(8)
    v_mfma_f32_16x16x16_bf16 v[200:203], v[88:89], a[88:89], 0
    v_cvt_pk_bf16_f32 v204, v204, v205
    v_cvt_pk_bf16_f32 v206, v206, v207
    v_mfma_f32_16x16x16_bf16 v[200:203], v[90:91], a[88:89], v[200:203]
    v_accvgpr_write_b32 a86, v204
    v_accvgpr_write_b32 a87, v206
    v_mfma_f32_16x16x32_bf16 v[108:111], a[136:139], v[220:223], v[108:111]
    v_exp_f32 v74, v74
    v_mfma_f32_16x16x32_bf16 v[108:111], a[168:171], v[212:215], v[108:111]
    v_exp_f32 v75, v75
    v_mfma_f32_16x16x32_bf16 v[108:111], a[200:203], v[244:247], v[108:111]
    v_perm_b32 v236, v73, v72, s35
    v_perm_b32 v237, v75, v74, s35
    v_mfma_f32_16x16x32_bf16 v[108:111], a[232:235], v[252:255], v[108:111]
    v_exp_f32 v76, v76
    v_mfma_f32_16x16x16_bf16 v[204:207], v[88:89], a[90:91], 0
    v_cvt_pk_bf16_f32 v200, v200, v201
    v_cvt_pk_bf16_f32 v202, v202, v203
    v_mfma_f32_16x16x16_bf16 v[204:207], v[90:91], a[90:91], v[204:207]
    v_accvgpr_write_b32 a88, v200
    v_accvgpr_write_b32 a89, v202
    v_mfma_f32_16x16x32_bf16 v[112:115], a[236:239], v[252:255], v[112:115]
    v_exp_f32 v77, v77
    v_mfma_f32_16x16x32_bf16 v[112:115], a[204:207], v[244:247], v[112:115]
    v_exp_f32 v78, v78
    v_mfma_f32_16x16x32_bf16 v[112:115], a[172:175], v[212:215], v[112:115]
    v_exp_f32 v79, v79
    v_mfma_f32_16x16x32_bf16 v[112:115], a[140:143], v[220:223], v[112:115]
    s_waitcnt lgkmcnt(3)
    v_perm_b32 v238, v77, v76, s35
    v_perm_b32 v239, v79, v78, s35
    buffer_load_dwordx4 v21, s[16:19], s26 offen offset:3072 lds
    s_waitcnt vmcnt(8)
    v_mfma_f32_16x16x16_bf16 v[200:203], v[88:89], a[92:93], 0
    v_cvt_pk_bf16_f32 v204, v204, v205
    v_cvt_pk_bf16_f32 v206, v206, v207
    v_mfma_f32_16x16x16_bf16 v[200:203], v[90:91], a[92:93], v[200:203]
    v_accvgpr_write_b32 a90, v204
    v_accvgpr_write_b32 a91, v206
    v_mfma_f32_16x16x16_bf16 v[204:207], v[88:89], a[94:95], 0
    s_nop 4
    v_cvt_pk_bf16_f32 v200, v200, v201
    v_cvt_pk_bf16_f32 v202, v202, v203
    v_mfma_f32_16x16x16_bf16 v[204:207], v[90:91], a[94:95], v[204:207]
L_s8:
    s_cbranch_execz L_cek3
L_s8_n:
    v_accvgpr_write_b32 a92, v200
    v_accvgpr_write_b32 a93, v202
    s_nop 5
    v_cvt_pk_bf16_f32 v204, v204, v205
    v_cvt_pk_bf16_f32 v206, v206, v207
    v_accvgpr_write_b32 a94, v204
    v_accvgpr_write_b32 a95, v206
    v_mfma_f32_16x16x32_bf16 v[64:67], a[64:67], v[32:35], 0
    ds_read_b128 v[240:243], v5 offset:32768
    ds_read_b128 v[248:251], v6 offset:32768
    v_mfma_f32_16x16x32_bf16 v[64:67], a[68:71], v[36:39], v[64:67]
    ds_read_b128 v[220:223], v3 offset:33792
    ds_read_b128 v[212:215], v4 offset:33792
    v_mfma_f32_16x16x32_bf16 v[64:67], a[72:75], v[40:43], v[64:67]
    ds_read_b128 v[244:247], v5 offset:33792
    ds_read_b128 v[252:255], v6 offset:33792
    v_mfma_f32_16x16x32_bf16 v[64:67], a[76:79], v[44:47], v[64:67]
    ds_write_b128 v3, v[236:239] offset:39936
    v_mfma_f32_16x16x32_bf16 v[68:71], a[92:95], v[44:47], 0
    ds_read_b128 v[48:51], v2 offset:4096
    ds_read_b128 v[52:55], v2 offset:4608
    v_mfma_f32_16x16x32_bf16 v[68:71], a[88:91], v[40:43], v[68:71]
    ds_read_b128 v[56:59], v2 offset:6144
    ds_read_b128 v[60:63], v2 offset:6656
    v_mfma_f32_16x16x32_bf16 v[68:71], a[84:87], v[36:39], v[68:71]
    v_exp_f32 v64, v64
    v_mfma_f32_16x16x32_bf16 v[68:71], a[80:83], v[32:35], v[68:71]
    v_exp_f32 v65, v65
    v_smfmac_f32_16x16x64_bf16 v[228:231], v[28:31], v[232:239], v23
    s_waitcnt lgkmcnt(9)
    s_add_u32 s25, s25, 0x1000
    buffer_load_dwordx4 a[96:99], v10, s[12:15], s25 offen offset:0
    v_mfma_f32_16x16x32_bf16 v[116:119], a[136:139], v[216:219], v[116:119]
    v_exp_f32 v66, v66
    v_mfma_f32_16x16x32_bf16 v[116:119], a[168:171], v[208:211], v[116:119]
    v_exp_f32 v67, v67
    v_mfma_f32_16x16x32_bf16 v[116:119], a[200:203], v[240:243], v[116:119]
    v_perm_b32 v232, v65, v64, s35
    v_perm_b32 v233, v67, v66, s35
    v_mfma_f32_16x16x32_bf16 v[116:119], a[232:235], v[248:251], v[116:119]
    s_waitcnt lgkmcnt(4)
    s_barrier
    v_mfma_f32_16x16x32_bf16 v[120:123], a[236:239], v[248:251], v[120:123]
    v_exp_f32 v68, v68
    v_mfma_f32_16x16x32_bf16 v[120:123], a[204:207], v[240:243], v[120:123]
    v_exp_f32 v69, v69
    v_mfma_f32_16x16x32_bf16 v[120:123], a[172:175], v[208:211], v[120:123]
    v_exp_f32 v70, v70
    v_mfma_f32_16x16x32_bf16 v[120:123], a[140:143], v[216:219], v[120:123]
    s_waitcnt lgkmcnt(0)
    v_exp_f32 v71, v71
    v_mfma_f32_16x16x32_bf16 v[72:75], a[64:67], v[48:51], 0
    v_perm_b32 v234, v69, v68, s35
    v_perm_b32 v235, v71, v70, s35
    v_mfma_f32_16x16x32_bf16 v[72:75], a[68:71], v[52:55], v[72:75]
    ds_read_b128 v[32:35], v2 offset:8192
    ds_read_b128 v[36:39], v2 offset:8704
    v_mfma_f32_16x16x32_bf16 v[72:75], a[72:75], v[56:59], v[72:75]
    ds_read_b128 v[40:43], v2 offset:10240
    ds_read_b128 v[44:47], v2 offset:10752
    v_mfma_f32_16x16x32_bf16 v[72:75], a[76:79], v[60:63], v[72:75]
    ds_write_b128 v3, v[232:235] offset:32768
    v_mfma_f32_16x16x32_bf16 v[76:79], a[92:95], v[60:63], 0
    ds_read_b128 v[216:219], v3 offset:34816
    ds_read_b128 v[208:211], v4 offset:34816
    v_mfma_f32_16x16x32_bf16 v[76:79], a[88:91], v[56:59], v[76:79]
    buffer_load_dwordx4 a[100:103], v10, s[12:15], s25 offen offset:64
    v_mfma_f32_16x16x32_bf16 v[76:79], a[84:87], v[52:55], v[76:79]
    v_exp_f32 v72, v72
    v_mfma_f32_16x16x32_bf16 v[76:79], a[80:83], v[48:51], v[76:79]
    v_exp_f32 v73, v73
    v_mfma_f32_16x16x32_bf16 v[124:127], a[136:139], v[220:223], v[124:127]
    v_exp_f32 v74, v74
    v_mfma_f32_16x16x32_bf16 v[124:127], a[168:171], v[212:215], v[124:127]
    v_exp_f32 v75, v75
    v_mfma_f32_16x16x32_bf16 v[124:127], a[200:203], v[244:247], v[124:127]
    v_perm_b32 v236, v73, v72, s35
    v_perm_b32 v237, v75, v74, s35
    v_mfma_f32_16x16x32_bf16 v[124:127], a[232:235], v[252:255], v[124:127]
    v_exp_f32 v76, v76
    v_mfma_f32_16x16x32_bf16 v[128:131], a[236:239], v[252:255], v[128:131]
    v_exp_f32 v77, v77
    v_mfma_f32_16x16x32_bf16 v[128:131], a[204:207], v[244:247], v[128:131]
    v_exp_f32 v78, v78
    v_mfma_f32_16x16x32_bf16 v[128:131], a[172:175], v[212:215], v[128:131]
    v_exp_f32 v79, v79
    v_mfma_f32_16x16x32_bf16 v[128:131], a[140:143], v[220:223], v[128:131]
    s_waitcnt lgkmcnt(3)
    v_perm_b32 v238, v77, v76, s35
    v_perm_b32 v239, v79, v78, s35
    v_mfma_f32_16x16x32_bf16 v[64:67], a[64:67], v[32:35], 0
    ds_read_b128 v[240:243], v5 offset:34816
    ds_read_b128 v[248:251], v6 offset:34816
    v_mfma_f32_16x16x32_bf16 v[64:67], a[68:71], v[36:39], v[64:67]
    ds_read_b128 v[220:223], v3 offset:35840
    ds_read_b128 v[212:215], v4 offset:35840
    v_mfma_f32_16x16x32_bf16 v[64:67], a[72:75], v[40:43], v[64:67]
    ds_read_b128 v[244:247], v5 offset:35840
    ds_read_b128 v[252:255], v6 offset:35840
    v_mfma_f32_16x16x32_bf16 v[64:67], a[76:79], v[44:47], v[64:67]
    ds_write_b128 v3, v[236:239] offset:33792
    v_mfma_f32_16x16x32_bf16 v[68:71], a[92:95], v[44:47], 0
    ds_read_b128 v[48:51], v2 offset:12288
    ds_read_b128 v[52:55], v2 offset:12800
    v_mfma_f32_16x16x32_bf16 v[68:71], a[88:91], v[40:43], v[68:71]
    ds_read_b128 v[56:59], v2 offset:14336
    ds_read_b128 v[60:63], v2 offset:14848
    v_mfma_f32_16x16x32_bf16 v[68:71], a[84:87], v[36:39], v[68:71]
    v_exp_f32 v64, v64
    v_mfma_f32_16x16x32_bf16 v[68:71], a[80:83], v[32:35], v[68:71]
    v_exp_f32 v65, v65
    v_smfmac_f32_16x16x64_bf16 v[148:151], v[28:31], v[232:239], v23
    s_waitcnt lgkmcnt(9)
    buffer_load_dwordx4 a[104:107], v10, s[12:15], s25 offen offset:128
    v_mfma_f32_16x16x32_bf16 v[132:135], a[136:139], v[216:219], v[132:135]
    v_exp_f32 v66, v66
    v_mfma_f32_16x16x32_bf16 v[132:135], a[168:171], v[208:211], v[132:135]
    v_exp_f32 v67, v67
    v_mfma_f32_16x16x32_bf16 v[132:135], a[200:203], v[240:243], v[132:135]
    v_perm_b32 v232, v65, v64, s35
    v_perm_b32 v233, v67, v66, s35
    v_mfma_f32_16x16x32_bf16 v[132:135], a[232:235], v[248:251], v[132:135]
    s_waitcnt lgkmcnt(4)
    s_barrier
    v_mfma_f32_16x16x32_bf16 v[136:139], a[236:239], v[248:251], v[136:139]
    v_exp_f32 v68, v68
    v_mfma_f32_16x16x32_bf16 v[136:139], a[204:207], v[240:243], v[136:139]
    v_exp_f32 v69, v69
    v_mfma_f32_16x16x32_bf16 v[136:139], a[172:175], v[208:211], v[136:139]
    v_exp_f32 v70, v70
    v_mfma_f32_16x16x32_bf16 v[136:139], a[140:143], v[216:219], v[136:139]
    s_waitcnt lgkmcnt(0)
    v_exp_f32 v71, v71
    v_mfma_f32_16x16x32_bf16 v[72:75], a[64:67], v[48:51], 0
    v_perm_b32 v234, v69, v68, s35
    v_perm_b32 v235, v71, v70, s35
    v_mfma_f32_16x16x32_bf16 v[72:75], a[68:71], v[52:55], v[72:75]
    ds_read_b128 v[32:35], v2 offset:32768
    ds_read_b128 v[36:39], v2 offset:33280
    v_mfma_f32_16x16x32_bf16 v[72:75], a[72:75], v[56:59], v[72:75]
    ds_read_b128 v[40:43], v2 offset:34816
    ds_read_b128 v[44:47], v2 offset:35328
    v_mfma_f32_16x16x32_bf16 v[72:75], a[76:79], v[60:63], v[72:75]
    ds_write_b128 v3, v[232:235] offset:34816
    v_mfma_f32_16x16x32_bf16 v[76:79], a[92:95], v[60:63], 0
    ds_read_b128 v[216:219], v3 offset:36864
    ds_read_b128 v[208:211], v4 offset:36864
    v_mfma_f32_16x16x32_bf16 v[76:79], a[88:91], v[56:59], v[76:79]
    buffer_load_dwordx4 a[108:111], v10, s[12:15], s25 offen offset:192
    v_mfma_f32_16x16x32_bf16 v[76:79], a[84:87], v[52:55], v[76:79]
    v_exp_f32 v72, v72
    v_mfma_f32_16x16x32_bf16 v[76:79], a[80:83], v[48:51], v[76:79]
    v_exp_f32 v73, v73
    v_mfma_f32_16x16x32_bf16 v[140:143], a[136:139], v[220:223], v[140:143]
    v_exp_f32 v74, v74
    v_mfma_f32_16x16x32_bf16 v[140:143], a[168:171], v[212:215], v[140:143]
    v_exp_f32 v75, v75
    v_mfma_f32_16x16x32_bf16 v[140:143], a[200:203], v[244:247], v[140:143]
    v_perm_b32 v236, v73, v72, s35
    v_perm_b32 v237, v75, v74, s35
    v_mfma_f32_16x16x32_bf16 v[140:143], a[232:235], v[252:255], v[140:143]
    v_exp_f32 v76, v76
    v_mfma_f32_16x16x32_bf16 v[144:147], a[236:239], v[252:255], v[144:147]
    v_exp_f32 v77, v77
    v_mfma_f32_16x16x32_bf16 v[144:147], a[204:207], v[244:247], v[144:147]
    v_exp_f32 v78, v78
    v_mfma_f32_16x16x32_bf16 v[144:147], a[172:175], v[212:215], v[144:147]
    v_exp_f32 v79, v79
    v_mfma_f32_16x16x32_bf16 v[144:147], a[140:143], v[220:223], v[144:147]
    s_waitcnt lgkmcnt(3)
    v_perm_b32 v238, v77, v76, s35
    v_perm_b32 v239, v79, v78, s35
    v_mfma_f32_16x16x32_bf16 v[64:67], a[64:67], v[32:35], 0
    ds_read_b128 v[240:243], v5 offset:36864
    ds_read_b128 v[248:251], v6 offset:36864
    v_mfma_f32_16x16x32_bf16 v[64:67], a[68:71], v[36:39], v[64:67]
    ds_read_b128 v[220:223], v3 offset:37888
    ds_read_b128 v[212:215], v4 offset:37888
    v_mfma_f32_16x16x32_bf16 v[64:67], a[72:75], v[40:43], v[64:67]
    ds_read_b128 v[244:247], v5 offset:37888
    ds_read_b128 v[252:255], v6 offset:37888
    v_mfma_f32_16x16x32_bf16 v[64:67], a[76:79], v[44:47], v[64:67]
    ds_write_b128 v3, v[236:239] offset:35840
    v_mfma_f32_16x16x32_bf16 v[68:71], a[92:95], v[44:47], 0
    ds_read_b128 v[48:51], v2 offset:36864
    ds_read_b128 v[52:55], v2 offset:37376
    v_mfma_f32_16x16x32_bf16 v[68:71], a[88:91], v[40:43], v[68:71]
    ds_read_b128 v[56:59], v2 offset:38912
    ds_read_b128 v[60:63], v2 offset:39424
    v_mfma_f32_16x16x32_bf16 v[68:71], a[84:87], v[36:39], v[68:71]
    v_exp_f32 v64, v64
    v_mfma_f32_16x16x32_bf16 v[68:71], a[80:83], v[32:35], v[68:71]
    v_exp_f32 v65, v65
    v_smfmac_f32_16x16x64_bf16 v[152:155], v[28:31], v[232:239], v23
    s_waitcnt lgkmcnt(9)
    s_add_u32 s25, s25, 0x1000
    buffer_load_dwordx4 a[112:115], v10, s[12:15], s25 offen offset:0
    v_mfma_f32_16x16x32_bf16 v[164:167], a[136:139], v[216:219], v[164:167]
    v_exp_f32 v66, v66
    v_mfma_f32_16x16x32_bf16 v[164:167], a[168:171], v[208:211], v[164:167]
    v_exp_f32 v67, v67
    v_mfma_f32_16x16x32_bf16 v[164:167], a[200:203], v[240:243], v[164:167]
    v_perm_b32 v232, v65, v64, s35
    v_perm_b32 v233, v67, v66, s35
    v_mfma_f32_16x16x32_bf16 v[164:167], a[232:235], v[248:251], v[164:167]
    s_waitcnt lgkmcnt(4)
    s_barrier
    v_mfma_f32_16x16x32_bf16 v[168:171], a[236:239], v[248:251], v[168:171]
    v_exp_f32 v68, v68
    v_mfma_f32_16x16x32_bf16 v[168:171], a[204:207], v[240:243], v[168:171]
    v_exp_f32 v69, v69
    v_mfma_f32_16x16x32_bf16 v[168:171], a[172:175], v[208:211], v[168:171]
    v_exp_f32 v70, v70
    v_mfma_f32_16x16x32_bf16 v[168:171], a[140:143], v[216:219], v[168:171]
    s_waitcnt lgkmcnt(0)
    v_exp_f32 v71, v71
    v_mfma_f32_16x16x32_bf16 v[72:75], a[64:67], v[48:51], 0
    v_perm_b32 v234, v69, v68, s35
    v_perm_b32 v235, v71, v70, s35
    v_mfma_f32_16x16x32_bf16 v[72:75], a[68:71], v[52:55], v[72:75]
    ds_read_b128 v[32:35], v2 offset:40960
    ds_read_b128 v[36:39], v2 offset:41472
    v_mfma_f32_16x16x32_bf16 v[72:75], a[72:75], v[56:59], v[72:75]
    ds_read_b128 v[40:43], v2 offset:43008
    ds_read_b128 v[44:47], v2 offset:43520
    v_mfma_f32_16x16x32_bf16 v[72:75], a[76:79], v[60:63], v[72:75]
    ds_write_b128 v3, v[232:235] offset:36864
    v_mfma_f32_16x16x32_bf16 v[76:79], a[92:95], v[60:63], 0
    ds_read_b128 v[216:219], v3 offset:38912
    ds_read_b128 v[208:211], v4 offset:38912
    v_mfma_f32_16x16x32_bf16 v[76:79], a[88:91], v[56:59], v[76:79]
    buffer_load_dwordx4 a[116:119], v10, s[12:15], s25 offen offset:64
    v_mfma_f32_16x16x32_bf16 v[76:79], a[84:87], v[52:55], v[76:79]
    v_exp_f32 v72, v72
    v_mfma_f32_16x16x32_bf16 v[76:79], a[80:83], v[48:51], v[76:79]
    v_exp_f32 v73, v73
    v_mfma_f32_16x16x32_bf16 v[172:175], a[136:139], v[220:223], v[172:175]
    v_exp_f32 v74, v74
    v_mfma_f32_16x16x32_bf16 v[172:175], a[168:171], v[212:215], v[172:175]
    v_exp_f32 v75, v75
    v_mfma_f32_16x16x32_bf16 v[172:175], a[200:203], v[244:247], v[172:175]
    v_perm_b32 v236, v73, v72, s35
    v_perm_b32 v237, v75, v74, s35
    v_mfma_f32_16x16x32_bf16 v[172:175], a[232:235], v[252:255], v[172:175]
    v_exp_f32 v76, v76
    v_mfma_f32_16x16x32_bf16 v[176:179], a[236:239], v[252:255], v[176:179]
    v_exp_f32 v77, v77
    v_mfma_f32_16x16x32_bf16 v[176:179], a[204:207], v[244:247], v[176:179]
    v_exp_f32 v78, v78
    v_mfma_f32_16x16x32_bf16 v[176:179], a[172:175], v[212:215], v[176:179]
    v_exp_f32 v79, v79
    v_mfma_f32_16x16x32_bf16 v[176:179], a[140:143], v[220:223], v[176:179]
    s_waitcnt lgkmcnt(3)
    v_perm_b32 v238, v77, v76, s35
    v_perm_b32 v239, v79, v78, s35
    v_mfma_f32_16x16x32_bf16 v[64:67], a[64:67], v[32:35], 0
    ds_read_b128 v[240:243], v5 offset:38912
    ds_read_b128 v[248:251], v6 offset:38912
    v_mfma_f32_16x16x32_bf16 v[64:67], a[68:71], v[36:39], v[64:67]
    ds_read_b128 v[220:223], v3 offset:39936
    ds_read_b128 v[212:215], v4 offset:39936
    v_mfma_f32_16x16x32_bf16 v[64:67], a[72:75], v[40:43], v[64:67]
    ds_read_b128 v[244:247], v5 offset:39936
    ds_read_b128 v[252:255], v6 offset:39936
    v_mfma_f32_16x16x32_bf16 v[64:67], a[76:79], v[44:47], v[64:67]
    ds_write_b128 v3, v[236:239] offset:37888
    v_mfma_f32_16x16x32_bf16 v[68:71], a[92:95], v[44:47], 0
    ds_read_b128 v[48:51], v2 offset:45056
    ds_read_b128 v[52:55], v2 offset:45568
    v_mfma_f32_16x16x32_bf16 v[68:71], a[88:91], v[40:43], v[68:71]
    ds_read_b128 v[56:59], v2 offset:47104
    ds_read_b128 v[60:63], v2 offset:47616
    v_mfma_f32_16x16x32_bf16 v[68:71], a[84:87], v[36:39], v[68:71]
    v_exp_f32 v64, v64
    v_mfma_f32_16x16x32_bf16 v[68:71], a[80:83], v[32:35], v[68:71]
    v_exp_f32 v65, v65
    v_smfmac_f32_16x16x64_bf16 v[156:159], v[28:31], v[232:239], v23
    s_waitcnt lgkmcnt(9)
    buffer_load_dwordx4 a[120:123], v10, s[12:15], s25 offen offset:128
    v_mfma_f32_16x16x32_bf16 v[180:183], a[136:139], v[216:219], v[180:183]
    v_exp_f32 v66, v66
    v_mfma_f32_16x16x32_bf16 v[180:183], a[168:171], v[208:211], v[180:183]
    v_exp_f32 v67, v67
    v_mfma_f32_16x16x32_bf16 v[180:183], a[200:203], v[240:243], v[180:183]
    v_perm_b32 v232, v65, v64, s35
    v_perm_b32 v233, v67, v66, s35
    v_mfma_f32_16x16x32_bf16 v[180:183], a[232:235], v[248:251], v[180:183]
    buffer_load_dwordx4 a[124:127], v10, s[12:15], s25 offen offset:192
    s_waitcnt vmcnt(8) lgkmcnt(4)
    s_barrier
    ds_read_b64_tr_b16 a[144:145], v13 offset:0
    ds_read_b64_tr_b16 a[146:147], v13 offset:4096
    ds_read_b64_tr_b16 a[148:149], v13 offset:8
    v_mfma_f32_16x16x32_bf16 v[184:187], a[236:239], v[248:251], v[184:187]
    v_exp_f32 v68, v68
    v_mfma_f32_16x16x32_bf16 v[184:187], a[204:207], v[240:243], v[184:187]
    v_exp_f32 v69, v69
    v_mfma_f32_16x16x32_bf16 v[184:187], a[172:175], v[208:211], v[184:187]
    v_exp_f32 v70, v70
    v_mfma_f32_16x16x32_bf16 v[184:187], a[140:143], v[216:219], v[184:187]
    s_waitcnt lgkmcnt(3)
    ds_read_b64_tr_b16 a[150:151], v13 offset:4104
    ds_read_b64_tr_b16 a[176:177], v14 offset:0
    ds_read_b64_tr_b16 a[178:179], v14 offset:4096
    v_exp_f32 v71, v71
    v_mfma_f32_16x16x32_bf16 v[72:75], a[64:67], v[48:51], 0
    v_perm_b32 v234, v69, v68, s35
    v_perm_b32 v235, v71, v70, s35
    v_mfma_f32_16x16x32_bf16 v[72:75], a[68:71], v[52:55], v[72:75]
    ds_read_b128 v[32:35], v2 offset:49152
    ds_read_b128 v[36:39], v2 offset:49664
    v_mfma_f32_16x16x32_bf16 v[72:75], a[72:75], v[56:59], v[72:75]
    ds_read_b128 v[40:43], v2 offset:51200
    ds_read_b128 v[44:47], v2 offset:51712
    v_mfma_f32_16x16x32_bf16 v[72:75], a[76:79], v[60:63], v[72:75]
    ds_write_b128 v3, v[232:235] offset:38912
    v_mfma_f32_16x16x32_bf16 v[76:79], a[92:95], v[60:63], 0
    ds_read_b128 v[216:219], v3 offset:32768
    ds_read_b128 v[208:211], v4 offset:32768
    v_mfma_f32_16x16x32_bf16 v[76:79], a[88:91], v[56:59], v[76:79]
    ds_read_b64_tr_b16 a[180:181], v14 offset:8
    ds_read_b64_tr_b16 a[182:183], v14 offset:4104
    v_mfma_f32_16x16x32_bf16 v[76:79], a[84:87], v[52:55], v[76:79]
    v_exp_f32 v72, v72
    v_mfma_f32_16x16x32_bf16 v[76:79], a[80:83], v[48:51], v[76:79]
    ds_read_b64_tr_b16 a[208:209], v15 offset:0
    ds_read_b64_tr_b16 a[210:211], v15 offset:4096
    ds_read_b64_tr_b16 a[212:213], v15 offset:8
    v_exp_f32 v73, v73
    s_add_u32 m0, s27, 131072
    s_add_u32 s26, s26, 0x1000
    buffer_load_dwordx4 v21, s[16:19], s26 offen offset:0 lds
    s_waitcnt vmcnt(8)
    v_mfma_f32_16x16x16_bf16 v[200:203], v[88:89], a[96:97], 0
    v_mfma_f32_16x16x16_bf16 v[200:203], v[90:91], a[96:97], v[200:203]
    v_mfma_f32_16x16x32_bf16 v[188:191], a[136:139], v[220:223], v[188:191]
    v_exp_f32 v74, v74
    v_mfma_f32_16x16x32_bf16 v[188:191], a[168:171], v[212:215], v[188:191]
    v_exp_f32 v75, v75
    v_mfma_f32_16x16x32_bf16 v[188:191], a[200:203], v[244:247], v[188:191]
    v_perm_b32 v236, v73, v72, s35
    v_perm_b32 v237, v75, v74, s35
    v_mfma_f32_16x16x32_bf16 v[188:191], a[232:235], v[252:255], v[188:191]
    ds_read_b64_tr_b16 a[214:215], v15 offset:4104
    ds_read_b64_tr_b16 a[240:241], v16 offset:0
    ds_read_b64_tr_b16 a[242:243], v16 offset:4096
    v_exp_f32 v76, v76
    v_mfma_f32_16x16x16_bf16 v[204:207], v[88:89], a[98:99], 0
    v_cvt_pk_bf16_f32 v200, v200, v201
    v_cvt_pk_bf16_f32 v202, v202, v203
    v_mfma_f32_16x16x16_bf16 v[204:207], v[90:91], a[98:99], v[204:207]
    v_accvgpr_write_b32 a96, v200
    v_accvgpr_write_b32 a97, v202
    v_mfma_f32_16x16x32_bf16 v[192:195], a[236:239], v[252:255], v[192:195]
    v_exp_f32 v77, v77
    v_mfma_f32_16x16x32_bf16 v[192:195], a[204:207], v[244:247], v[192:195]
    v_exp_f32 v78, v78
    v_mfma_f32_16x16x32_bf16 v[192:195], a[172:175], v[212:215], v[192:195]
    v_exp_f32 v79, v79
    v_mfma_f32_16x16x32_bf16 v[192:195], a[140:143], v[220:223], v[192:195]
    s_waitcnt lgkmcnt(11)
    ds_read_b64_tr_b16 a[244:245], v16 offset:8
    ds_read_b64_tr_b16 a[246:247], v16 offset:4104
    v_perm_b32 v238, v77, v76, s35
    v_perm_b32 v239, v79, v78, s35
    buffer_load_dwordx4 v21, s[16:19], s26 offen offset:1024 lds
    s_waitcnt vmcnt(8)
    v_mfma_f32_16x16x16_bf16 v[200:203], v[88:89], a[100:101], 0
    v_cvt_pk_bf16_f32 v204, v204, v205
    v_cvt_pk_bf16_f32 v206, v206, v207
    v_mfma_f32_16x16x16_bf16 v[200:203], v[90:91], a[100:101], v[200:203]
    v_accvgpr_write_b32 a98, v204
    v_accvgpr_write_b32 a99, v206
    v_mfma_f32_16x16x32_bf16 v[64:67], a[64:67], v[32:35], 0
    ds_read_b128 v[240:243], v5 offset:32768
    ds_read_b128 v[248:251], v6 offset:32768
    v_mfma_f32_16x16x32_bf16 v[64:67], a[68:71], v[36:39], v[64:67]
    ds_read_b128 v[220:223], v3 offset:33792
    ds_read_b128 v[212:215], v4 offset:33792
    v_mfma_f32_16x16x32_bf16 v[64:67], a[72:75], v[40:43], v[64:67]
    ds_read_b128 v[244:247], v5 offset:33792
    ds_read_b128 v[252:255], v6 offset:33792
    v_mfma_f32_16x16x32_bf16 v[64:67], a[76:79], v[44:47], v[64:67]
    ds_write_b128 v3, v[236:239] offset:39936
    v_mfma_f32_16x16x16_bf16 v[204:207], v[88:89], a[102:103], 0
    v_cvt_pk_bf16_f32 v200, v200, v201
    v_cvt_pk_bf16_f32 v202, v202, v203
    v_mfma_f32_16x16x16_bf16 v[204:207], v[90:91], a[102:103], v[204:207]
    v_accvgpr_write_b32 a100, v200
    v_accvgpr_write_b32 a101, v202
    v_mfma_f32_16x16x32_bf16 v[68:71], a[92:95], v[44:47], 0
    ds_read_b128 v[48:51], v2 offset:53248
    ds_read_b128 v[52:55], v2 offset:53760
    v_mfma_f32_16x16x32_bf16 v[68:71], a[88:91], v[40:43], v[68:71]
    ds_read_b128 v[56:59], v2 offset:55296
    ds_read_b128 v[60:63], v2 offset:55808
    v_mfma_f32_16x16x32_bf16 v[68:71], a[84:87], v[36:39], v[68:71]
    v_exp_f32 v64, v64
    v_mfma_f32_16x16x32_bf16 v[68:71], a[80:83], v[32:35], v[68:71]
    v_exp_f32 v65, v65
    v_smfmac_f32_16x16x64_bf16 v[160:163], v[28:31], v[232:239], v23
    s_waitcnt lgkmcnt(9)
    buffer_load_dwordx4 v21, s[16:19], s26 offen offset:2048 lds
    s_waitcnt vmcnt(8)
    v_mfma_f32_16x16x16_bf16 v[200:203], v[88:89], a[104:105], 0
    v_cvt_pk_bf16_f32 v204, v204, v205
    v_cvt_pk_bf16_f32 v206, v206, v207
    v_mfma_f32_16x16x16_bf16 v[200:203], v[90:91], a[104:105], v[200:203]
    v_accvgpr_write_b32 a102, v204
    v_accvgpr_write_b32 a103, v206
    v_mfma_f32_16x16x32_bf16 v[80:83], a[144:147], v[216:219], v[80:83]
    v_exp_f32 v66, v66
    v_mfma_f32_16x16x32_bf16 v[80:83], a[176:179], v[208:211], v[80:83]
    v_exp_f32 v67, v67
    v_mfma_f32_16x16x32_bf16 v[80:83], a[208:211], v[240:243], v[80:83]
    v_perm_b32 v232, v65, v64, s35
    v_perm_b32 v233, v67, v66, s35
    v_mfma_f32_16x16x32_bf16 v[80:83], a[240:243], v[248:251], v[80:83]
    s_waitcnt lgkmcnt(4)
    s_barrier
    v_mfma_f32_16x16x32_bf16 v[84:87], a[244:247], v[248:251], v[84:87]
    v_exp_f32 v68, v68
    v_mfma_f32_16x16x32_bf16 v[84:87], a[212:215], v[240:243], v[84:87]
    v_exp_f32 v69, v69
    v_mfma_f32_16x16x32_bf16 v[84:87], a[180:183], v[208:211], v[84:87]
    v_exp_f32 v70, v70
    v_mfma_f32_16x16x32_bf16 v[84:87], a[148:151], v[216:219], v[84:87]
    s_waitcnt lgkmcnt(0)
    v_exp_f32 v71, v71
    v_mfma_f32_16x16x16_bf16 v[204:207], v[88:89], a[106:107], 0
    v_cvt_pk_bf16_f32 v200, v200, v201
    v_cvt_pk_bf16_f32 v202, v202, v203
    v_mfma_f32_16x16x16_bf16 v[204:207], v[90:91], a[106:107], v[204:207]
    v_accvgpr_write_b32 a104, v200
    v_accvgpr_write_b32 a105, v202
    v_mfma_f32_16x16x32_bf16 v[72:75], a[64:67], v[48:51], 0
    v_perm_b32 v234, v69, v68, s35
    v_perm_b32 v235, v71, v70, s35
    v_mfma_f32_16x16x32_bf16 v[72:75], a[68:71], v[52:55], v[72:75]
    ds_read_b128 v[32:35], v2 offset:57344
    ds_read_b128 v[36:39], v2 offset:57856
    v_mfma_f32_16x16x32_bf16 v[72:75], a[72:75], v[56:59], v[72:75]
    ds_read_b128 v[40:43], v2 offset:59392
    ds_read_b128 v[44:47], v2 offset:59904
    v_mfma_f32_16x16x32_bf16 v[72:75], a[76:79], v[60:63], v[72:75]
    ds_write_b128 v3, v[232:235] offset:32768
    v_mfma_f32_16x16x32_bf16 v[76:79], a[92:95], v[60:63], 0
    ds_read_b128 v[216:219], v3 offset:34816
    ds_read_b128 v[208:211], v4 offset:34816
    v_mfma_f32_16x16x32_bf16 v[76:79], a[88:91], v[56:59], v[76:79]
    buffer_load_dwordx4 v21, s[16:19], s26 offen offset:3072 lds
    v_mfma_f32_16x16x32_bf16 v[76:79], a[84:87], v[52:55], v[76:79]
    v_exp_f32 v72, v72
    v_mfma_f32_16x16x32_bf16 v[76:79], a[80:83], v[48:51], v[76:79]
    v_exp_f32 v73, v73
    s_waitcnt vmcnt(8)
    v_mfma_f32_16x16x16_bf16 v[200:203], v[88:89], a[108:109], 0
    v_cvt_pk_bf16_f32 v204, v204, v205
    v_cvt_pk_bf16_f32 v206, v206, v207
    v_mfma_f32_16x16x16_bf16 v[200:203], v[90:91], a[108:109], v[200:203]
    v_accvgpr_write_b32 a106, v204
    v_accvgpr_write_b32 a107, v206
    v_mfma_f32_16x16x32_bf16 v[92:95], a[144:147], v[220:223], v[92:95]
    v_exp_f32 v74, v74
    v_mfma_f32_16x16x32_bf16 v[92:95], a[176:179], v[212:215], v[92:95]
    v_exp_f32 v75, v75
    v_mfma_f32_16x16x32_bf16 v[92:95], a[208:211], v[244:247], v[92:95]
    v_perm_b32 v236, v73, v72, s35
    v_perm_b32 v237, v75, v74, s35
    v_mfma_f32_16x16x32_bf16 v[92:95], a[240:243], v[252:255], v[92:95]
    v_exp_f32 v76, v76
    v_mfma_f32_16x16x16_bf16 v[204:207], v[88:89], a[110:111], 0
    v_cvt_pk_bf16_f32 v200, v200, v201
    v_cvt_pk_bf16_f32 v202, v202, v203
    v_mfma_f32_16x16x16_bf16 v[204:207], v[90:91], a[110:111], v[204:207]
    v_accvgpr_write_b32 a108, v200
    v_accvgpr_write_b32 a109, v202
    v_mfma_f32_16x16x32_bf16 v[96:99], a[244:247], v[252:255], v[96:99]
    v_exp_f32 v77, v77
    v_mfma_f32_16x16x32_bf16 v[96:99], a[212:215], v[244:247], v[96:99]
    v_exp_f32 v78, v78
    v_mfma_f32_16x16x32_bf16 v[96:99], a[180:183], v[212:215], v[96:99]
    v_exp_f32 v79, v79
    v_mfma_f32_16x16x32_bf16 v[96:99], a[148:151], v[220:223], v[96:99]
    s_waitcnt lgkmcnt(3)
    v_perm_b32 v238, v77, v76, s35
    v_perm_b32 v239, v79, v78, s35
    s_add_u32 m0, s27, 135168
    s_add_u32 s26, s26, 0x1000
    buffer_load_dwordx4 v21, s[16:19], s26 offen offset:0 lds
    s_waitcnt vmcnt(8)
    v_mfma_f32_16x16x16_bf16 v[200:203], v[88:89], a[112:113], 0
    v_cvt_pk_bf16_f32 v204, v204, v205
    v_cvt_pk_bf16_f32 v206, v206, v207
    v_mfma_f32_16x16x16_bf16 v[200:203], v[90:91], a[112:113], v[200:203]
    v_accvgpr_write_b32 a110, v204
    v_accvgpr_write_b32 a111, v206
    v_mfma_f32_16x16x32_bf16 v[64:67], a[64:67], v[32:35], 0
    ds_read_b128 v[240:243], v5 offset:34816
    ds_read_b128 v[248:251], v6 offset:34816
    v_mfma_f32_16x16x32_bf16 v[64:67], a[68:71], v[36:39], v[64:67]
    ds_read_b128 v[220:223], v3 offset:35840
    ds_read_b128 v[212:215], v4 offset:35840
    v_mfma_f32_16x16x32_bf16 v[64:67], a[72:75], v[40:43], v[64:67]
    ds_read_b128 v[244:247], v5 offset:35840
    ds_read_b128 v[252:255], v6 offset:35840
    v_mfma_f32_16x16x32_bf16 v[64:67], a[76:79], v[44:47], v[64:67]
    ds_write_b128 v3, v[236:239] offset:33792
    v_mfma_f32_16x16x16_bf16 v[204:207], v[88:89], a[114:115], 0
    v_cvt_pk_bf16_f32 v200, v200, v201
    v_cvt_pk_bf16_f32 v202, v202, v203
    v_mfma_f32_16x16x16_bf16 v[204:207], v[90:91], a[114:115], v[204:207]
    v_accvgpr_write_b32 a112, v200
    v_accvgpr_write_b32 a113, v202
    v_mfma_f32_16x16x32_bf16 v[68:71], a[92:95], v[44:47], 0
    ds_read_b128 v[48:51], v2 offset:61440
    ds_read_b128 v[52:55], v2 offset:61952
    v_mfma_f32_16x16x32_bf16 v[68:71], a[88:91], v[40:43], v[68:71]
    ds_read_b128 v[56:59], v2 offset:63488
    ds_read_b128 v[60:63], v2 offset:64000
    v_mfma_f32_16x16x32_bf16 v[68:71], a[84:87], v[36:39], v[68:71]
    v_exp_f32 v64, v64
    v_mfma_f32_16x16x32_bf16 v[68:71], a[80:83], v[32:35], v[68:71]
    v_exp_f32 v65, v65
    v_smfmac_f32_16x16x64_bf16 v[224:227], v[28:31], v[232:239], v23
    s_waitcnt lgkmcnt(9)
    buffer_load_dwordx4 v21, s[16:19], s26 offen offset:1024 lds
    s_waitcnt vmcnt(8)
    v_mfma_f32_16x16x16_bf16 v[200:203], v[88:89], a[116:117], 0
    v_cvt_pk_bf16_f32 v204, v204, v205
    v_cvt_pk_bf16_f32 v206, v206, v207
    v_mfma_f32_16x16x16_bf16 v[200:203], v[90:91], a[116:117], v[200:203]
    v_accvgpr_write_b32 a114, v204
    v_accvgpr_write_b32 a115, v206
    v_mfma_f32_16x16x32_bf16 v[100:103], a[144:147], v[216:219], v[100:103]
    v_exp_f32 v66, v66
    v_mfma_f32_16x16x32_bf16 v[100:103], a[176:179], v[208:211], v[100:103]
    v_exp_f32 v67, v67
    v_mfma_f32_16x16x32_bf16 v[100:103], a[208:211], v[240:243], v[100:103]
    v_perm_b32 v232, v65, v64, s35
    v_perm_b32 v233, v67, v66, s35
    v_mfma_f32_16x16x32_bf16 v[100:103], a[240:243], v[248:251], v[100:103]
    s_waitcnt lgkmcnt(4)
    s_barrier
    v_mfma_f32_16x16x32_bf16 v[104:107], a[244:247], v[248:251], v[104:107]
    v_exp_f32 v68, v68
    v_mfma_f32_16x16x32_bf16 v[104:107], a[212:215], v[240:243], v[104:107]
    v_exp_f32 v69, v69
    v_mfma_f32_16x16x32_bf16 v[104:107], a[180:183], v[208:211], v[104:107]
    v_exp_f32 v70, v70
    v_mfma_f32_16x16x32_bf16 v[104:107], a[148:151], v[216:219], v[104:107]
    s_waitcnt lgkmcnt(0)
    v_exp_f32 v71, v71
    v_mfma_f32_16x16x16_bf16 v[204:207], v[88:89], a[118:119], 0
    v_cvt_pk_bf16_f32 v200, v200, v201
    v_cvt_pk_bf16_f32 v202, v202, v203
    v_mfma_f32_16x16x16_bf16 v[204:207], v[90:91], a[118:119], v[204:207]
    v_accvgpr_write_b32 a116, v200
    v_accvgpr_write_b32 a117, v202
    v_mfma_f32_16x16x32_bf16 v[72:75], a[64:67], v[48:51], 0
    v_perm_b32 v234, v69, v68, s35
    v_perm_b32 v235, v71, v70, s35
    v_mfma_f32_16x16x32_bf16 v[72:75], a[68:71], v[52:55], v[72:75]
    ds_read_b128 v[32:35], v2 offset:0
    ds_read_b128 v[36:39], v2 offset:512
    v_mfma_f32_16x16x32_bf16 v[72:75], a[72:75], v[56:59], v[72:75]
    ds_read_b128 v[40:43], v2 offset:2048
    ds_read_b128 v[44:47], v2 offset:2560
    v_mfma_f32_16x16x32_bf16 v[72:75], a[76:79], v[60:63], v[72:75]
    ds_write_b128 v3, v[232:235] offset:34816
    v_mfma_f32_16x16x32_bf16 v[76:79], a[92:95], v[60:63], 0
    ds_read_b128 v[216:219], v3 offset:36864
    ds_read_b128 v[208:211], v4 offset:36864
    v_mfma_f32_16x16x32_bf16 v[76:79], a[88:91], v[56:59], v[76:79]
L_s9:
    s_cbranch_execz L_cek3
L_s9_n:
    buffer_load_dwordx4 v21, s[16:19], s26 offen offset:2048 lds
    v_mfma_f32_16x16x32_bf16 v[76:79], a[84:87], v[52:55], v[76:79]
    v_exp_f32 v72, v72
    v_mfma_f32_16x16x32_bf16 v[76:79], a[80:83], v[48:51], v[76:79]
    v_exp_f32 v73, v73
    s_waitcnt vmcnt(8)
    v_mfma_f32_16x16x16_bf16 v[200:203], v[88:89], a[120:121], 0
    v_cvt_pk_bf16_f32 v204, v204, v205
    v_cvt_pk_bf16_f32 v206, v206, v207
    v_mfma_f32_16x16x16_bf16 v[200:203], v[90:91], a[120:121], v[200:203]
    v_accvgpr_write_b32 a118, v204
    v_accvgpr_write_b32 a119, v206
    v_mfma_f32_16x16x32_bf16 v[108:111], a[144:147], v[220:223], v[108:111]
    v_exp_f32 v74, v74
    v_mfma_f32_16x16x32_bf16 v[108:111], a[176:179], v[212:215], v[108:111]
    v_exp_f32 v75, v75
    v_mfma_f32_16x16x32_bf16 v[108:111], a[208:211], v[244:247], v[108:111]
    v_perm_b32 v236, v73, v72, s35
    v_perm_b32 v237, v75, v74, s35
    v_mfma_f32_16x16x32_bf16 v[108:111], a[240:243], v[252:255], v[108:111]
    v_exp_f32 v76, v76
    v_mfma_f32_16x16x16_bf16 v[204:207], v[88:89], a[122:123], 0
    v_cvt_pk_bf16_f32 v200, v200, v201
    v_cvt_pk_bf16_f32 v202, v202, v203
    v_mfma_f32_16x16x16_bf16 v[204:207], v[90:91], a[122:123], v[204:207]
    v_accvgpr_write_b32 a120, v200
    v_accvgpr_write_b32 a121, v202
    v_mfma_f32_16x16x32_bf16 v[112:115], a[244:247], v[252:255], v[112:115]
    v_exp_f32 v77, v77
    v_mfma_f32_16x16x32_bf16 v[112:115], a[212:215], v[244:247], v[112:115]
    v_exp_f32 v78, v78
    v_mfma_f32_16x16x32_bf16 v[112:115], a[180:183], v[212:215], v[112:115]
    v_exp_f32 v79, v79
    v_mfma_f32_16x16x32_bf16 v[112:115], a[148:151], v[220:223], v[112:115]
    s_waitcnt lgkmcnt(3)
    v_perm_b32 v238, v77, v76, s35
    v_perm_b32 v239, v79, v78, s35
    buffer_load_dwordx4 v21, s[16:19], s26 offen offset:3072 lds
    s_waitcnt vmcnt(8)
    v_mfma_f32_16x16x16_bf16 v[200:203], v[88:89], a[124:125], 0
    v_cvt_pk_bf16_f32 v204, v204, v205
    v_cvt_pk_bf16_f32 v206, v206, v207
    v_mfma_f32_16x16x16_bf16 v[200:203], v[90:91], a[124:125], v[200:203]
    v_accvgpr_write_b32 a122, v204
    v_accvgpr_write_b32 a123, v206
    v_mfma_f32_16x16x16_bf16 v[204:207], v[88:89], a[126:127], 0
    s_nop 4
    v_cvt_pk_bf16_f32 v200, v200, v201
    v_cvt_pk_bf16_f32 v202, v202, v203
    v_mfma_f32_16x16x16_bf16 v[204:207], v[90:91], a[126:127], v[204:207]
    v_accvgpr_write_b32 a124, v200
    v_accvgpr_write_b32 a125, v202
    s_nop 5
    v_cvt_pk_bf16_f32 v204, v204, v205
    v_cvt_pk_bf16_f32 v206, v206, v207
    v_accvgpr_write_b32 a126, v204
    v_accvgpr_write_b32 a127, v206
    v_mfma_f32_16x16x32_bf16 v[64:67], a[96:99], v[32:35], 0
    ds_read_b128 v[240:243], v5 offset:36864
    ds_read_b128 v[248:251], v6 offset:36864
    v_mfma_f32_16x16x32_bf16 v[64:67], a[100:103], v[36:39], v[64:67]
    ds_read_b128 v[220:223], v3 offset:37888
    ds_read_b128 v[212:215], v4 offset:37888
    v_mfma_f32_16x16x32_bf16 v[64:67], a[104:107], v[40:43], v[64:67]
    ds_read_b128 v[244:247], v5 offset:37888
    ds_read_b128 v[252:255], v6 offset:37888
    v_mfma_f32_16x16x32_bf16 v[64:67], a[108:111], v[44:47], v[64:67]
    ds_write_b128 v3, v[236:239] offset:35840
    v_mfma_f32_16x16x32_bf16 v[68:71], a[124:127], v[44:47], 0
    ds_read_b128 v[48:51], v2 offset:4096
    ds_read_b128 v[52:55], v2 offset:4608
    v_mfma_f32_16x16x32_bf16 v[68:71], a[120:123], v[40:43], v[68:71]
    ds_read_b128 v[56:59], v2 offset:6144
    ds_read_b128 v[60:63], v2 offset:6656
    v_mfma_f32_16x16x32_bf16 v[68:71], a[116:119], v[36:39], v[68:71]
    v_exp_f32 v64, v64
    v_mfma_f32_16x16x32_bf16 v[68:71], a[112:115], v[32:35], v[68:71]
    v_exp_f32 v65, v65
    v_smfmac_f32_16x16x64_bf16 v[228:231], v[28:31], v[232:239], v23
    s_waitcnt lgkmcnt(9)
    s_add_u32 m0, s24, 16384
    s_mov_b32 s29, 0xc000
    buffer_load_dwordx4 v9, s[8:11], s29 offen lds
    v_mfma_f32_16x16x32_bf16 v[116:119], a[144:147], v[216:219], v[116:119]
    v_exp_f32 v66, v66
    v_mfma_f32_16x16x32_bf16 v[116:119], a[176:179], v[208:211], v[116:119]
    v_exp_f32 v67, v67
    v_mfma_f32_16x16x32_bf16 v[116:119], a[208:211], v[240:243], v[116:119]
    v_perm_b32 v232, v65, v64, s35
    v_perm_b32 v233, v67, v66, s35
    v_mfma_f32_16x16x32_bf16 v[116:119], a[240:243], v[248:251], v[116:119]
    s_waitcnt lgkmcnt(4)
    s_barrier
    v_mfma_f32_16x16x32_bf16 v[120:123], a[244:247], v[248:251], v[120:123]
    v_exp_f32 v68, v68
    v_mfma_f32_16x16x32_bf16 v[120:123], a[212:215], v[240:243], v[120:123]
    v_exp_f32 v69, v69
    v_mfma_f32_16x16x32_bf16 v[120:123], a[180:183], v[208:211], v[120:123]
    v_exp_f32 v70, v70
    v_mfma_f32_16x16x32_bf16 v[120:123], a[148:151], v[216:219], v[120:123]
    s_waitcnt lgkmcnt(0)
    v_exp_f32 v71, v71
    v_mfma_f32_16x16x32_bf16 v[72:75], a[96:99], v[48:51], 0
    v_perm_b32 v234, v69, v68, s35
    v_perm_b32 v235, v71, v70, s35
    v_mfma_f32_16x16x32_bf16 v[72:75], a[100:103], v[52:55], v[72:75]
    ds_read_b128 v[32:35], v2 offset:8192
    ds_read_b128 v[36:39], v2 offset:8704
    v_mfma_f32_16x16x32_bf16 v[72:75], a[104:107], v[56:59], v[72:75]
    ds_read_b128 v[40:43], v2 offset:10240
    ds_read_b128 v[44:47], v2 offset:10752
    v_mfma_f32_16x16x32_bf16 v[72:75], a[108:111], v[60:63], v[72:75]
    ds_write_b128 v3, v[232:235] offset:36864
    v_mfma_f32_16x16x32_bf16 v[76:79], a[124:127], v[60:63], 0
    ds_read_b128 v[216:219], v3 offset:38912
    ds_read_b128 v[208:211], v4 offset:38912
    v_mfma_f32_16x16x32_bf16 v[76:79], a[120:123], v[56:59], v[76:79]
    buffer_load_dwordx4 v9, s[8:11], s29 offen offset:1024 lds
    v_mfma_f32_16x16x32_bf16 v[76:79], a[116:119], v[52:55], v[76:79]
    v_exp_f32 v72, v72
    v_mfma_f32_16x16x32_bf16 v[76:79], a[112:115], v[48:51], v[76:79]
    v_exp_f32 v73, v73
    v_mfma_f32_16x16x32_bf16 v[124:127], a[144:147], v[220:223], v[124:127]
    v_exp_f32 v74, v74
    v_mfma_f32_16x16x32_bf16 v[124:127], a[176:179], v[212:215], v[124:127]
    v_exp_f32 v75, v75
    v_mfma_f32_16x16x32_bf16 v[124:127], a[208:211], v[244:247], v[124:127]
    v_perm_b32 v236, v73, v72, s35
    v_perm_b32 v237, v75, v74, s35
    v_mfma_f32_16x16x32_bf16 v[124:127], a[240:243], v[252:255], v[124:127]
    v_exp_f32 v76, v76
    v_mfma_f32_16x16x32_bf16 v[128:131], a[244:247], v[252:255], v[128:131]
    v_exp_f32 v77, v77
    v_mfma_f32_16x16x32_bf16 v[128:131], a[212:215], v[244:247], v[128:131]
    v_exp_f32 v78, v78
    v_mfma_f32_16x16x32_bf16 v[128:131], a[180:183], v[212:215], v[128:131]
    v_exp_f32 v79, v79
    v_mfma_f32_16x16x32_bf16 v[128:131], a[148:151], v[220:223], v[128:131]
    s_waitcnt lgkmcnt(3)
    v_perm_b32 v238, v77, v76, s35
    v_perm_b32 v239, v79, v78, s35
    v_mfma_f32_16x16x32_bf16 v[64:67], a[96:99], v[32:35], 0
    ds_read_b128 v[240:243], v5 offset:38912
    ds_read_b128 v[248:251], v6 offset:38912
    v_mfma_f32_16x16x32_bf16 v[64:67], a[100:103], v[36:39], v[64:67]
    ds_read_b128 v[220:223], v3 offset:39936
    ds_read_b128 v[212:215], v4 offset:39936
    v_mfma_f32_16x16x32_bf16 v[64:67], a[104:107], v[40:43], v[64:67]
    ds_read_b128 v[244:247], v5 offset:39936
    ds_read_b128 v[252:255], v6 offset:39936
    v_mfma_f32_16x16x32_bf16 v[64:67], a[108:111], v[44:47], v[64:67]
    ds_write_b128 v3, v[236:239] offset:37888
    v_mfma_f32_16x16x32_bf16 v[68:71], a[124:127], v[44:47], 0
    ds_read_b128 v[48:51], v2 offset:12288
    ds_read_b128 v[52:55], v2 offset:12800
    v_mfma_f32_16x16x32_bf16 v[68:71], a[120:123], v[40:43], v[68:71]
    ds_read_b128 v[56:59], v2 offset:14336
    ds_read_b128 v[60:63], v2 offset:14848
    v_mfma_f32_16x16x32_bf16 v[68:71], a[116:119], v[36:39], v[68:71]
    v_exp_f32 v64, v64
    v_mfma_f32_16x16x32_bf16 v[68:71], a[112:115], v[32:35], v[68:71]
    v_exp_f32 v65, v65
    v_smfmac_f32_16x16x64_bf16 v[148:151], v[28:31], v[232:239], v23
    s_waitcnt lgkmcnt(9)
    s_add_u32 m0, s24, 24576
    s_mov_b32 s29, 0xe000
    buffer_load_dwordx4 v9, s[8:11], s29 offen lds
    v_mfma_f32_16x16x32_bf16 v[132:135], a[144:147], v[216:219], v[132:135]
    v_exp_f32 v66, v66
    v_mfma_f32_16x16x32_bf16 v[132:135], a[176:179], v[208:211], v[132:135]
    v_exp_f32 v67, v67
    v_mfma_f32_16x16x32_bf16 v[132:135], a[208:211], v[240:243], v[132:135]
    v_perm_b32 v232, v65, v64, s35
    v_perm_b32 v233, v67, v66, s35
    v_mfma_f32_16x16x32_bf16 v[132:135], a[240:243], v[248:251], v[132:135]
    s_waitcnt lgkmcnt(4)
    s_barrier
    v_add_f32 v150, v148, v149
    v_mfma_f32_16x16x32_bf16 v[136:139], a[244:247], v[248:251], v[136:139]
    v_exp_f32 v68, v68
    v_mfma_f32_16x16x32_bf16 v[136:139], a[212:215], v[240:243], v[136:139]
    v_exp_f32 v69, v69
    v_mfma_f32_16x16x32_bf16 v[136:139], a[180:183], v[208:211], v[136:139]
    v_exp_f32 v70, v70
    v_mfma_f32_16x16x32_bf16 v[136:139], a[148:151], v[216:219], v[136:139]
    s_waitcnt lgkmcnt(0)
    ds_write_b32 v7, v150 offset:28672
    v_exp_f32 v71, v71
    v_mfma_f32_16x16x32_bf16 v[72:75], a[96:99], v[48:51], 0
    v_perm_b32 v234, v69, v68, s35
    v_perm_b32 v235, v71, v70, s35
    v_mfma_f32_16x16x32_bf16 v[72:75], a[100:103], v[52:55], v[72:75]
    ds_read_b128 v[32:35], v2 offset:32768
    ds_read_b128 v[36:39], v2 offset:33280
    v_mfma_f32_16x16x32_bf16 v[72:75], a[104:107], v[56:59], v[72:75]
    ds_read_b128 v[40:43], v2 offset:34816
    ds_read_b128 v[44:47], v2 offset:35328
    v_mfma_f32_16x16x32_bf16 v[72:75], a[108:111], v[60:63], v[72:75]
    ds_write_b128 v3, v[232:235] offset:38912
    v_mfma_f32_16x16x32_bf16 v[76:79], a[124:127], v[60:63], 0
    ds_read_b128 v[216:219], v3 offset:32768
    ds_read_b128 v[208:211], v4 offset:32768
    v_mfma_f32_16x16x32_bf16 v[76:79], a[120:123], v[56:59], v[76:79]
    buffer_load_dwordx4 v9, s[8:11], s29 offen offset:1024 lds
    v_mfma_f32_16x16x32_bf16 v[76:79], a[116:119], v[52:55], v[76:79]
    v_exp_f32 v72, v72
    v_mfma_f32_16x16x32_bf16 v[76:79], a[112:115], v[48:51], v[76:79]
    v_exp_f32 v73, v73
    v_mfma_f32_16x16x32_bf16 v[140:143], a[144:147], v[220:223], v[140:143]
    v_exp_f32 v74, v74
    v_mfma_f32_16x16x32_bf16 v[140:143], a[176:179], v[212:215], v[140:143]
    v_exp_f32 v75, v75
    v_mfma_f32_16x16x32_bf16 v[140:143], a[208:211], v[244:247], v[140:143]
    v_perm_b32 v236, v73, v72, s35
    v_perm_b32 v237, v75, v74, s35
    v_mfma_f32_16x16x32_bf16 v[140:143], a[240:243], v[252:255], v[140:143]
    v_exp_f32 v76, v76
    v_mfma_f32_16x16x32_bf16 v[144:147], a[244:247], v[252:255], v[144:147]
    v_exp_f32 v77, v77
    v_mfma_f32_16x16x32_bf16 v[144:147], a[212:215], v[244:247], v[144:147]
    v_exp_f32 v78, v78
    v_mfma_f32_16x16x32_bf16 v[144:147], a[180:183], v[212:215], v[144:147]
    v_exp_f32 v79, v79
    v_mfma_f32_16x16x32_bf16 v[144:147], a[148:151], v[220:223], v[144:147]
    s_waitcnt lgkmcnt(3)
    v_perm_b32 v238, v77, v76, s35
    v_perm_b32 v239, v79, v78, s35
    v_mfma_f32_16x16x32_bf16 v[64:67], a[96:99], v[32:35], 0
    ds_read_b128 v[240:243], v5 offset:32768
    ds_read_b128 v[248:251], v6 offset:32768
    v_mfma_f32_16x16x32_bf16 v[64:67], a[100:103], v[36:39], v[64:67]
    ds_read_b128 v[220:223], v3 offset:33792
    ds_read_b128 v[212:215], v4 offset:33792
    v_mfma_f32_16x16x32_bf16 v[64:67], a[104:107], v[40:43], v[64:67]
    ds_read_b128 v[244:247], v5 offset:33792
    ds_read_b128 v[252:255], v6 offset:33792
    v_mfma_f32_16x16x32_bf16 v[64:67], a[108:111], v[44:47], v[64:67]
    ds_write_b128 v3, v[236:239] offset:39936
    v_mfma_f32_16x16x32_bf16 v[68:71], a[124:127], v[44:47], 0
    ds_read_b128 v[48:51], v2 offset:36864
    ds_read_b128 v[52:55], v2 offset:37376
    v_mfma_f32_16x16x32_bf16 v[68:71], a[120:123], v[40:43], v[68:71]
    ds_read_b128 v[56:59], v2 offset:38912
    ds_read_b128 v[60:63], v2 offset:39424
    v_mfma_f32_16x16x32_bf16 v[68:71], a[116:119], v[36:39], v[68:71]
    v_exp_f32 v64, v64
    v_mfma_f32_16x16x32_bf16 v[68:71], a[112:115], v[32:35], v[68:71]
    v_exp_f32 v65, v65
    v_smfmac_f32_16x16x64_bf16 v[152:155], v[28:31], v[232:239], v23
    s_waitcnt lgkmcnt(9)
    s_add_u32 m0, s24, 0
    s_mov_b32 s29, 0x10000
    buffer_load_dwordx4 v9, s[8:11], s29 offen lds
    v_mfma_f32_16x16x32_bf16 v[164:167], a[144:147], v[216:219], v[164:167]
    v_exp_f32 v66, v66
    v_mfma_f32_16x16x32_bf16 v[164:167], a[176:179], v[208:211], v[164:167]
    v_exp_f32 v67, v67
    v_mfma_f32_16x16x32_bf16 v[164:167], a[208:211], v[240:243], v[164:167]
    v_perm_b32 v232, v65, v64, s35
    v_perm_b32 v233, v67, v66, s35
    v_mfma_f32_16x16x32_bf16 v[164:167], a[240:243], v[248:251], v[164:167]
    s_waitcnt lgkmcnt(4)
    s_barrier
    v_add_f32 v154, v152, v153
    ds_read_b128 v[200:203], v8 offset:28672
    v_mfma_f32_16x16x32_bf16 v[168:171], a[244:247], v[248:251], v[168:171]
    v_exp_f32 v68, v68
    v_mfma_f32_16x16x32_bf16 v[168:171], a[212:215], v[240:243], v[168:171]
    v_exp_f32 v69, v69
    v_mfma_f32_16x16x32_bf16 v[168:171], a[180:183], v[208:211], v[168:171]
    v_exp_f32 v70, v70
    v_mfma_f32_16x16x32_bf16 v[168:171], a[148:151], v[216:219], v[168:171]
    s_waitcnt lgkmcnt(1)
    ds_write_b32 v7, v154 offset:29184
    v_exp_f32 v71, v71
    s_waitcnt lgkmcnt(1)
    v_add_f32 v200, v200, v201
    v_mfma_f32_16x16x32_bf16 v[72:75], a[96:99], v[48:51], 0
    v_perm_b32 v234, v69, v68, s35
    v_perm_b32 v235, v71, v70, s35
    v_mfma_f32_16x16x32_bf16 v[72:75], a[100:103], v[52:55], v[72:75]
    ds_read_b128 v[32:35], v2 offset:40960
    ds_read_b128 v[36:39], v2 offset:41472
    v_mfma_f32_16x16x32_bf16 v[72:75], a[104:107], v[56:59], v[72:75]
    ds_read_b128 v[40:43], v2 offset:43008
    ds_read_b128 v[44:47], v2 offset:43520
    v_mfma_f32_16x16x32_bf16 v[72:75], a[108:111], v[60:63], v[72:75]
    ds_write_b128 v3, v[232:235] offset:32768
    v_add_f32 v202, v202, v203
    v_mfma_f32_16x16x32_bf16 v[76:79], a[124:127], v[60:63], 0
    ds_read_b128 v[216:219], v3 offset:34816
    ds_read_b128 v[208:211], v4 offset:34816
    v_mfma_f32_16x16x32_bf16 v[76:79], a[120:123], v[56:59], v[76:79]
    v_add_f32 v17, v200, v202
    v_mfma_f32_16x16x32_bf16 v[76:79], a[116:119], v[52:55], v[76:79]
    v_rcp_f32 v148, v17
    v_mfma_f32_16x16x32_bf16 v[76:79], a[112:115], v[48:51], v[76:79]
    v_exp_f32 v72, v72
    v_exp_f32 v73, v73
    v_mov_b32 v149, v148
    v_mfma_f32_16x16x32_bf16 v[172:175], a[144:147], v[220:223], v[172:175]
    v_exp_f32 v74, v74
    v_mfma_f32_16x16x32_bf16 v[172:175], a[176:179], v[212:215], v[172:175]
    v_exp_f32 v75, v75
    v_mfma_f32_16x16x32_bf16 v[172:175], a[208:211], v[244:247], v[172:175]
    v_perm_b32 v236, v73, v72, s35
    v_perm_b32 v237, v75, v74, s35
    v_mfma_f32_16x16x32_bf16 v[172:175], a[240:243], v[252:255], v[172:175]
    v_exp_f32 v76, v76
    v_max3_u32 v11, v11, v17, v148
    buffer_load_dwordx4 v9, s[8:11], s29 offen offset:1024 lds
    v_mfma_f32_16x16x32_bf16 v[176:179], a[244:247], v[252:255], v[176:179]
    v_exp_f32 v77, v77
    v_mfma_f32_16x16x32_bf16 v[176:179], a[212:215], v[244:247], v[176:179]
    v_exp_f32 v78, v78
    v_mfma_f32_16x16x32_bf16 v[176:179], a[180:183], v[212:215], v[176:179]
    v_exp_f32 v79, v79
    v_mfma_f32_16x16x32_bf16 v[176:179], a[148:151], v[220:223], v[176:179]
    s_waitcnt lgkmcnt(3)
    v_perm_b32 v238, v77, v76, s35
    v_perm_b32 v239, v79, v78, s35
    v_permlane32_swap_b32 v148, v149
    v_mfma_f32_16x16x32_bf16 v[64:67], a[96:99], v[32:35], 0
    ds_read_b128 v[240:243], v5 offset:34816
    ds_read_b128 v[248:251], v6 offset:34816
    v_mfma_f32_16x16x32_bf16 v[64:67], a[100:103], v[36:39], v[64:67]
    ds_read_b128 v[220:223], v3 offset:35840
    ds_read_b128 v[212:215], v4 offset:35840
    v_mfma_f32_16x16x32_bf16 v[64:67], a[104:107], v[40:43], v[64:67]
    ds_read_b128 v[244:247], v5 offset:35840
    ds_read_b128 v[252:255], v6 offset:35840
    v_mfma_f32_16x16x32_bf16 v[64:67], a[108:111], v[44:47], v[64:67]
    ds_write_b128 v3, v[236:239] offset:33792
    v_mfma_f32_16x16x32_bf16 v[68:71], a[124:127], v[44:47], 0
    ds_read_b128 v[48:51], v2 offset:45056
    ds_read_b128 v[52:55], v2 offset:45568
    v_mfma_f32_16x16x32_bf16 v[68:71], a[120:123], v[40:43], v[68:71]
    ds_read_b128 v[56:59], v2 offset:47104
    ds_read_b128 v[60:63], v2 offset:47616
    v_mfma_f32_16x16x32_bf16 v[68:71], a[116:119], v[36:39], v[68:71]
    v_exp_f32 v64, v64
    v_mfma_f32_16x16x32_bf16 v[68:71], a[112:115], v[32:35], v[68:71]
    v_exp_f32 v65, v65
    v_smfmac_f32_16x16x64_bf16 v[156:159], v[28:31], v[232:239], v23
    s_waitcnt lgkmcnt(9)
    s_add_u32 m0, s24, 8192
    s_mov_b32 s29, 0x12000
    buffer_load_dwordx4 v9, s[8:11], s29 offen lds
    v_mfma_f32_16x16x32_bf16 v[180:183], a[144:147], v[216:219], v[180:183]
    v_exp_f32 v66, v66
    v_mfma_f32_16x16x32_bf16 v[180:183], a[176:179], v[208:211], v[180:183]
    v_exp_f32 v67, v67
    v_mfma_f32_16x16x32_bf16 v[180:183], a[208:211], v[240:243], v[180:183]
    v_perm_b32 v232, v65, v64, s35
    v_perm_b32 v233, v67, v66, s35
    v_mfma_f32_16x16x32_bf16 v[180:183], a[240:243], v[248:251], v[180:183]
    buffer_load_dwordx4 v9, s[8:11], s29 offen offset:1024 lds
    s_waitcnt vmcnt(8) lgkmcnt(4)
    s_barrier
    v_add_f32 v158, v156, v157
    ds_read_b64_tr_b16 a[152:153], v13 offset:32768
    ds_read_b64_tr_b16 a[154:155], v13 offset:36864
    ds_read_b64_tr_b16 a[156:157], v13 offset:32776
    ds_read_b128 v[200:203], v8 offset:29184
    v_mfma_f32_16x16x32_bf16 v[184:187], a[244:247], v[248:251], v[184:187]
    v_exp_f32 v68, v68
    v_mfma_f32_16x16x32_bf16 v[184:187], a[212:215], v[240:243], v[184:187]
    v_exp_f32 v69, v69
    v_mfma_f32_16x16x32_bf16 v[184:187], a[180:183], v[208:211], v[184:187]
    v_exp_f32 v70, v70
    v_mfma_f32_16x16x32_bf16 v[184:187], a[148:151], v[216:219], v[184:187]
    s_waitcnt lgkmcnt(4)
    ds_write_b32 v7, v158 offset:28672
    ds_read_b64_tr_b16 a[158:159], v13 offset:36872
    ds_read_b64_tr_b16 a[184:185], v14 offset:32768
    ds_read_b64_tr_b16 a[186:187], v14 offset:36864
    v_exp_f32 v71, v71
    s_waitcnt lgkmcnt(4)
    v_add_f32 v200, v200, v201
    v_mfma_f32_16x16x32_bf16 v[72:75], a[96:99], v[48:51], 0
    v_perm_b32 v234, v69, v68, s35
    v_perm_b32 v235, v71, v70, s35
    v_mfma_f32_16x16x32_bf16 v[72:75], a[100:103], v[52:55], v[72:75]
    ds_read_b128 v[32:35], v2 offset:49152
    ds_read_b128 v[36:39], v2 offset:49664
    v_mfma_f32_16x16x32_bf16 v[72:75], a[104:107], v[56:59], v[72:75]
    ds_read_b128 v[40:43], v2 offset:51200
    ds_read_b128 v[44:47], v2 offset:51712
    v_mfma_f32_16x16x32_bf16 v[72:75], a[108:111], v[60:63], v[72:75]
    ds_write_b128 v3, v[232:235] offset:34816
    v_add_f32 v202, v202, v203
    v_mfma_f32_16x16x32_bf16 v[76:79], a[124:127], v[60:63], 0
    ds_read_b128 v[216:219], v3 offset:36864
    ds_read_b128 v[208:211], v4 offset:36864
    v_mfma_f32_16x16x32_bf16 v[76:79], a[120:123], v[56:59], v[76:79]
    ds_read_b64_tr_b16 a[188:189], v14 offset:32776
    ds_read_b64_tr_b16 a[190:191], v14 offset:36872
    v_mfma_f32_16x16x32_bf16 v[76:79], a[116:119], v[52:55], v[76:79]
    v_add_f32 v17, v200, v202
    v_mfma_f32_16x16x32_bf16 v[76:79], a[112:115], v[48:51], v[76:79]
    v_rcp_f32 v152, v17
    v_exp_f32 v72, v72
    ds_read_b64_tr_b16 a[216:217], v15 offset:32768
    ds_read_b64_tr_b16 a[218:219], v15 offset:36864
    ds_read_b64_tr_b16 a[220:221], v15 offset:32776
    v_exp_f32 v73, v73
    v_mov_b32 v153, v152
    v_mfma_f32_16x16x32_bf16 v[188:191], a[144:147], v[220:223], v[188:191]
    v_exp_f32 v74, v74
    v_mfma_f32_16x16x32_bf16 v[188:191], a[176:179], v[212:215], v[188:191]
    v_exp_f32 v75, v75
    v_mfma_f32_16x16x32_bf16 v[188:191], a[208:211], v[244:247], v[188:191]
    v_perm_b32 v236, v73, v72, s35
    v_perm_b32 v237, v75, v74, s35
    v_mfma_f32_16x16x32_bf16 v[188:191], a[240:243], v[252:255], v[188:191]
    ds_read_b64_tr_b16 a[222:223], v15 offset:36872
    ds_read_b64_tr_b16 a[248:249], v16 offset:32768
    ds_read_b64_tr_b16 a[250:251], v16 offset:36864
    v_exp_f32 v76, v76
    v_max3_u32 v11, v11, v17, v152
    v_mfma_f32_16x16x32_bf16 v[192:195], a[244:247], v[252:255], v[192:195]
    v_exp_f32 v77, v77
    v_mfma_f32_16x16x32_bf16 v[192:195], a[212:215], v[244:247], v[192:195]
    v_exp_f32 v78, v78
    v_mfma_f32_16x16x32_bf16 v[192:195], a[180:183], v[212:215], v[192:195]
    v_exp_f32 v79, v79
    v_mfma_f32_16x16x32_bf16 v[192:195], a[148:151], v[220:223], v[192:195]
    s_waitcnt lgkmcnt(11)
    ds_read_b64_tr_b16 a[252:253], v16 offset:32776
    ds_read_b64_tr_b16 a[254:255], v16 offset:36872
    v_perm_b32 v238, v77, v76, s35
    v_perm_b32 v239, v79, v78, s35
    v_permlane32_swap_b32 v152, v153
    v_mfma_f32_16x16x32_bf16 v[64:67], a[96:99], v[32:35], 0
    ds_read_b128 v[240:243], v5 offset:36864
    ds_read_b128 v[248:251], v6 offset:36864
    v_mfma_f32_16x16x32_bf16 v[64:67], a[100:103], v[36:39], v[64:67]
    ds_read_b128 v[220:223], v3 offset:37888
    ds_read_b128 v[212:215], v4 offset:37888
    v_mfma_f32_16x16x32_bf16 v[64:67], a[104:107], v[40:43], v[64:67]
    ds_read_b128 v[244:247], v5 offset:37888
    ds_read_b128 v[252:255], v6 offset:37888
    v_mfma_f32_16x16x32_bf16 v[64:67], a[108:111], v[44:47], v[64:67]
    ds_write_b128 v3, v[236:239] offset:35840
    v_mfma_f32_16x16x32_bf16 v[68:71], a[124:127], v[44:47], 0
    ds_read_b128 v[48:51], v2 offset:53248
    ds_read_b128 v[52:55], v2 offset:53760
    v_mfma_f32_16x16x32_bf16 v[68:71], a[120:123], v[40:43], v[68:71]
    ds_read_b128 v[56:59], v2 offset:55296
    ds_read_b128 v[60:63], v2 offset:55808
    v_mfma_f32_16x16x32_bf16 v[68:71], a[116:119], v[36:39], v[68:71]
    v_exp_f32 v64, v64
    v_mfma_f32_16x16x32_bf16 v[68:71], a[112:115], v[32:35], v[68:71]
    v_exp_f32 v65, v65
    v_smfmac_f32_16x16x64_bf16 v[160:163], v[28:31], v[232:239], v23
    s_waitcnt lgkmcnt(9)
    v_mfma_f32_16x16x32_bf16 v[80:83], a[152:155], v[216:219], v[80:83]
    v_exp_f32 v66, v66
    v_mfma_f32_16x16x32_bf16 v[80:83], a[184:187], v[208:211], v[80:83]
    v_exp_f32 v67, v67
    v_mfma_f32_16x16x32_bf16 v[80:83], a[216:219], v[240:243], v[80:83]
    v_perm_b32 v232, v65, v64, s35
    v_perm_b32 v233, v67, v66, s35
    v_mfma_f32_16x16x32_bf16 v[80:83], a[248:251], v[248:251], v[80:83]
    s_waitcnt lgkmcnt(4)
    s_barrier
    v_add_f32 v162, v160, v161
    ds_read_b128 v[200:203], v8 offset:28672
    v_mfma_f32_16x16x32_bf16 v[84:87], a[252:255], v[248:251], v[84:87]
    v_exp_f32 v68, v68
    v_mfma_f32_16x16x32_bf16 v[84:87], a[220:223], v[240:243], v[84:87]
    v_exp_f32 v69, v69
    v_mfma_f32_16x16x32_bf16 v[84:87], a[188:191], v[208:211], v[84:87]
    v_exp_f32 v70, v70
    v_mfma_f32_16x16x32_bf16 v[84:87], a[156:159], v[216:219], v[84:87]
    s_waitcnt lgkmcnt(1)
    ds_write_b32 v7, v162 offset:29184
    v_exp_f32 v71, v71
    s_waitcnt lgkmcnt(1)
    v_add_f32 v200, v200, v201
    v_mfma_f32_16x16x32_bf16 v[72:75], a[96:99], v[48:51], 0
    v_perm_b32 v234, v69, v68, s35
    v_perm_b32 v235, v71, v70, s35
    v_mfma_f32_16x16x32_bf16 v[72:75], a[100:103], v[52:55], v[72:75]
    ds_read_b128 v[32:35], v2 offset:57344
    ds_read_b128 v[36:39], v2 offset:57856
    v_mfma_f32_16x16x32_bf16 v[72:75], a[104:107], v[56:59], v[72:75]
    ds_read_b128 v[40:43], v2 offset:59392
    ds_read_b128 v[44:47], v2 offset:59904
    v_mfma_f32_16x16x32_bf16 v[72:75], a[108:111], v[60:63], v[72:75]
    ds_write_b128 v3, v[232:235] offset:36864
    v_add_f32 v202, v202, v203
    v_mfma_f32_16x16x32_bf16 v[76:79], a[124:127], v[60:63], 0
    ds_read_b128 v[216:219], v3 offset:38912
    ds_read_b128 v[208:211], v4 offset:38912
    v_mfma_f32_16x16x32_bf16 v[76:79], a[120:123], v[56:59], v[76:79]
    v_add_f32 v17, v200, v202
    v_mfma_f32_16x16x32_bf16 v[76:79], a[116:119], v[52:55], v[76:79]
    v_rcp_f32 v156, v17
    v_mfma_f32_16x16x32_bf16 v[76:79], a[112:115], v[48:51], v[76:79]
    v_exp_f32 v72, v72
    v_exp_f32 v73, v73
    v_mov_b32 v157, v156
    v_mfma_f32_16x16x32_bf16 v[92:95], a[152:155], v[220:223], v[92:95]
    v_exp_f32 v74, v74
    v_mfma_f32_16x16x32_bf16 v[92:95], a[184:187], v[212:215], v[92:95]
    v_exp_f32 v75, v75
    v_mfma_f32_16x16x32_bf16 v[92:95], a[216:219], v[244:247], v[92:95]
    v_perm_b32 v236, v73, v72, s35
    v_perm_b32 v237, v75, v74, s35
    v_mfma_f32_16x16x32_bf16 v[92:95], a[248:251], v[252:255], v[92:95]
    v_exp_f32 v76, v76
    v_max3_u32 v11, v11, v17, v156
    v_mfma_f32_16x16x32_bf16 v[96:99], a[252:255], v[252:255], v[96:99]
    v_exp_f32 v77, v77
    v_mfma_f32_16x16x32_bf16 v[96:99], a[220:223], v[244:247], v[96:99]
    v_exp_f32 v78, v78
    v_mfma_f32_16x16x32_bf16 v[96:99], a[188:191], v[212:215], v[96:99]
    v_exp_f32 v79, v79
    v_mfma_f32_16x16x32_bf16 v[96:99], a[156:159], v[220:223], v[96:99]
    s_waitcnt lgkmcnt(3)
    v_perm_b32 v238, v77, v76, s35
    v_perm_b32 v239, v79, v78, s35
    v_permlane32_swap_b32 v156, v157
    v_mfma_f32_16x16x32_bf16 v[64:67], a[96:99], v[32:35], 0
    ds_read_b128 v[240:243], v5 offset:38912
    ds_read_b128 v[248:251], v6 offset:38912
    v_mfma_f32_16x16x32_bf16 v[64:67], a[100:103], v[36:39], v[64:67]
    ds_read_b128 v[220:223], v3 offset:39936
    ds_read_b128 v[212:215], v4 offset:39936
    v_mfma_f32_16x16x32_bf16 v[64:67], a[104:107], v[40:43], v[64:67]
    ds_read_b128 v[244:247], v5 offset:39936
    ds_read_b128 v[252:255], v6 offset:39936
    v_mfma_f32_16x16x32_bf16 v[64:67], a[108:111], v[44:47], v[64:67]
    ds_write_b128 v3, v[236:239] offset:37888
    v_mfma_f32_16x16x32_bf16 v[68:71], a[124:127], v[44:47], 0
    ds_read_b128 v[48:51], v2 offset:61440
    ds_read_b128 v[52:55], v2 offset:61952
    v_mfma_f32_16x16x32_bf16 v[68:71], a[120:123], v[40:43], v[68:71]
    ds_read_b128 v[56:59], v2 offset:63488
    ds_read_b128 v[60:63], v2 offset:64000
    v_mfma_f32_16x16x32_bf16 v[68:71], a[116:119], v[36:39], v[68:71]
    v_exp_f32 v64, v64
    v_mfma_f32_16x16x32_bf16 v[68:71], a[112:115], v[32:35], v[68:71]
    v_exp_f32 v65, v65
    v_smfmac_f32_16x16x64_bf16 v[224:227], v[28:31], v[232:239], v23
    s_waitcnt lgkmcnt(9)
    v_mfma_f32_16x16x32_bf16 v[100:103], a[152:155], v[216:219], v[100:103]
    v_exp_f32 v66, v66
    v_mfma_f32_16x16x32_bf16 v[100:103], a[184:187], v[208:211], v[100:103]
    v_exp_f32 v67, v67
    v_mfma_f32_16x16x32_bf16 v[100:103], a[216:219], v[240:243], v[100:103]
    v_perm_b32 v232, v65, v64, s35
    v_perm_b32 v233, v67, v66, s35
    v_mfma_f32_16x16x32_bf16 v[100:103], a[248:251], v[248:251], v[100:103]
    s_waitcnt vmcnt(6) lgkmcnt(4)
    s_barrier
    v_add_f32 v226, v224, v225
    ds_read_b128 v[200:203], v8 offset:29184
    v_mfma_f32_16x16x32_bf16 v[104:107], a[252:255], v[248:251], v[104:107]
    v_exp_f32 v68, v68
    v_mfma_f32_16x16x32_bf16 v[104:107], a[220:223], v[240:243], v[104:107]
    v_exp_f32 v69, v69
    v_mfma_f32_16x16x32_bf16 v[104:107], a[188:191], v[208:211], v[104:107]
    v_exp_f32 v70, v70
    v_mfma_f32_16x16x32_bf16 v[104:107], a[156:159], v[216:219], v[104:107]
    s_waitcnt lgkmcnt(1)
    ds_write_b32 v7, v226 offset:28672
    v_exp_f32 v71, v71
    s_waitcnt lgkmcnt(1)
    v_add_f32 v200, v200, v201
    v_add_f32 v202, v202, v203
    v_add_f32 v17, v200, v202
    v_mfma_f32_16x16x32_bf16 v[72:75], a[96:99], v[48:51], 0
    v_perm_b32 v234, v69, v68, s35
    v_perm_b32 v235, v71, v70, s35
    v_mfma_f32_16x16x32_bf16 v[72:75], a[100:103], v[52:55], v[72:75]
    ds_read_b128 v[32:35], v2 offset:16384
    ds_read_b128 v[36:39], v2 offset:16896
    v_mfma_f32_16x16x32_bf16 v[72:75], a[104:107], v[56:59], v[72:75]
    ds_read_b128 v[40:43], v2 offset:18432
    ds_read_b128 v[44:47], v2 offset:18944
    v_mfma_f32_16x16x32_bf16 v[72:75], a[108:111], v[60:63], v[72:75]
    ds_write_b128 v3, v[232:235] offset:38912
    v_rcp_f32 v160, v17
    s_nop 0
    v_mov_b32 v161, v160
    v_max3_u32 v11, v11, v17, v160
    s_nop 0
    v_permlane32_swap_b32 v160, v161
    v_mfma_f32_16x16x32_bf16 v[76:79], a[124:127], v[60:63], 0
    ds_read_b128 v[216:219], v3 offset:32768
    ds_read_b128 v[208:211], v4 offset:32768
    v_mfma_f32_16x16x32_bf16 v[76:79], a[120:123], v[56:59], v[76:79]
L_s10:
    s_cbranch_execz L_s12
L_s10_n:
    s_mov_b32 s31, 0x0
    s_mov_b32 s32, 0x1000
    v_mfma_f32_16x16x32_bf16 v[76:79], a[116:119], v[52:55], v[76:79]
    v_mul_f32 v80, v80, v148
    v_mul_f32 v81, v81, v148
    v_mfma_f32_16x16x32_bf16 v[76:79], a[112:115], v[48:51], v[76:79]
    v_mul_f32 v82, v82, v148
    v_mul_f32 v83, v83, v148
    v_mul_f32 v84, v84, v148
    v_exp_f32 v72, v72
    v_exp_f32 v73, v73
    v_mul_f32 v85, v85, v148
    v_mul_f32 v86, v86, v148
    v_mul_f32 v87, v87, v148
    v_cvt_pk_bf16_f32 v80, v80, v81
    v_mfma_f32_16x16x32_bf16 v[108:111], a[152:155], v[220:223], v[108:111]
    v_exp_f32 v74, v74
    v_mfma_f32_16x16x32_bf16 v[108:111], a[184:187], v[212:215], v[108:111]
    v_exp_f32 v75, v75
    v_mfma_f32_16x16x32_bf16 v[108:111], a[216:219], v[244:247], v[108:111]
    v_perm_b32 v236, v73, v72, s35
    v_perm_b32 v237, v75, v74, s35
    v_mfma_f32_16x16x32_bf16 v[108:111], a[248:251], v[252:255], v[108:111]
    v_exp_f32 v76, v76
    v_cvt_pk_bf16_f32 v81, v82, v83
    v_cvt_pk_bf16_f32 v82, v84, v85
    v_cvt_pk_bf16_f32 v83, v86, v87
    buffer_store_dwordx4 v[80:83], v10, s[20:23], s31 offen
    v_mfma_f32_16x16x32_bf16 v[112:115], a[252:255], v[252:255], v[112:115]
    v_exp_f32 v77, v77
    v_mfma_f32_16x16x32_bf16 v[112:115], a[220:223], v[244:247], v[112:115]
    v_exp_f32 v78, v78
    v_mfma_f32_16x16x32_bf16 v[112:115], a[188:191], v[212:215], v[112:115]
    v_exp_f32 v79, v79
    v_mfma_f32_16x16x32_bf16 v[112:115], a[156:159], v[220:223], v[112:115]
    s_waitcnt lgkmcnt(3)
    v_perm_b32 v238, v77, v76, s35
    v_perm_b32 v239, v79, v78, s35
    v_mul_f32 v92, v92, v149
    v_mul_f32 v93, v93, v149
    v_mul_f32 v94, v94, v149
    v_mfma_f32_16x16x32_bf16 v[64:67], a[0:3], v[32:35], 0
    ds_read_b128 v[240:243], v5 offset:32768
    ds_read_b128 v[248:251], v6 offset:32768
    v_mfma_f32_16x16x32_bf16 v[64:67], a[4:7], v[36:39], v[64:67]
    ds_read_b128 v[220:223], v3 offset:33792
    ds_read_b128 v[212:215], v4 offset:33792
    v_mfma_f32_16x16x32_bf16 v[64:67], a[8:11], v[40:43], v[64:67]
    ds_read_b128 v[244:247], v5 offset:33792
    ds_read_b128 v[252:255], v6 offset:33792
    v_mfma_f32_16x16x32_bf16 v[64:67], a[12:15], v[44:47], v[64:67]
    ds_write_b128 v3, v[236:239] offset:39936
    v_mul_f32 v95, v95, v149
    v_mul_f32 v96, v96, v149
    v_mfma_f32_16x16x32_bf16 v[68:71], a[28:31], v[44:47], 0
    ds_read_b128 v[48:51], v2 offset:20480
    ds_read_b128 v[52:55], v2 offset:20992
    v_mfma_f32_16x16x32_bf16 v[68:71], a[24:27], v[40:43], v[68:71]
    ds_read_b128 v[56:59], v2 offset:22528
    ds_read_b128 v[60:63], v2 offset:23040
    v_mfma_f32_16x16x32_bf16 v[68:71], a[20:23], v[36:39], v[68:71]
    v_exp_f32 v64, v64
    v_mfma_f32_16x16x32_bf16 v[68:71], a[16:19], v[32:35], v[68:71]
    v_exp_f32 v65, v65
    v_exp_f32 v66, v66
    v_exp_f32 v67, v67
    v_mul_f32 v97, v97, v149
    v_smfmac_f32_16x16x64_bf16 v[228:231], v[28:31], v[232:239], v23
    s_waitcnt lgkmcnt(9)
    v_perm_b32 v80, v65, v64, s35
    v_perm_b32 v81, v67, v66, s35
    v_mul_f32 v98, v98, v149
    v_mul_f32 v99, v99, v149
    v_cvt_pk_bf16_f32 v92, v92, v93
    v_cvt_pk_bf16_f32 v93, v94, v95
    v_mfma_f32_16x16x32_bf16 v[116:119], a[152:155], v[216:219], v[116:119]
    v_cvt_pk_bf16_f32 v94, v96, v97
    v_cvt_pk_bf16_f32 v95, v98, v99
    v_mfma_f32_16x16x32_bf16 v[116:119], a[184:187], v[208:211], v[116:119]
    v_exp_f32 v68, v68
    v_mfma_f32_16x16x32_bf16 v[116:119], a[216:219], v[240:243], v[116:119]
    v_add_f32 v230, v228, v229
    s_mov_b32 s31, 0x2000
    v_mfma_f32_16x16x32_bf16 v[116:119], a[248:251], v[248:251], v[116:119]
    s_waitcnt lgkmcnt(0)
    s_barrier
    ds_read_b128 v[200:203], v8 offset:28672
    ds_write_b32 v7, v230 offset:29184
    v_mfma_f32_16x16x32_bf16 v[120:123], a[252:255], v[248:251], v[120:123]
    v_mov_b32_dpp v28, v24 row_ror:8 row_mask:0xf bank_mask:0xf
    v_mov_b32_dpp v29, v24 row_ror:8 row_mask:0xf bank_mask:0xf
    v_mfma_f32_16x16x32_bf16 v[120:123], a[220:223], v[240:243], v[120:123]
    v_mov_b64 v[30:31], v[28:29]
    v_mul_f32 v100, v100, v152
    v_mfma_f32_16x16x32_bf16 v[120:123], a[188:191], v[208:211], v[120:123]
    v_exp_f32 v69, v69
    v_mfma_f32_16x16x32_bf16 v[120:123], a[156:159], v[216:219], v[120:123]
    buffer_store_dwordx4 v[92:95], v10, s[20:23], s32 offen
    s_waitcnt lgkmcnt(1)
    v_mfma_f32_16x16x32_bf16 v[72:75], a[32:35], v[32:35], 0
    ds_read_b128 v[216:219], v3 offset:34816
    ds_read_b128 v[208:211], v4 offset:34816
    v_mfma_f32_16x16x32_bf16 v[72:75], a[36:39], v[36:39], v[72:75]
    ds_read_b128 v[240:243], v5 offset:34816
    ds_read_b128 v[248:251], v6 offset:34816
    v_mfma_f32_16x16x32_bf16 v[72:75], a[40:43], v[40:43], v[72:75]
    v_exp_f32 v70, v70
    v_mfma_f32_16x16x32_bf16 v[72:75], a[44:47], v[44:47], v[72:75]
    v_exp_f32 v71, v71
    v_perm_b32 v82, v69, v68, s35
    v_mul_f32 v101, v101, v152
    v_mul_f32 v102, v102, v152
    v_mul_f32 v103, v103, v152
    v_mul_f32 v104, v104, v152
    v_mfma_f32_16x16x32_bf16 v[76:79], a[60:63], v[44:47], 0
    v_perm_b32 v83, v71, v70, s35
    v_mul_f32 v105, v105, v152
    v_mfma_f32_16x16x32_bf16 v[76:79], a[56:59], v[40:43], v[76:79]
    v_mul_f32 v106, v106, v152
    v_mul_f32 v107, v107, v152
    v_mfma_f32_16x16x32_bf16 v[76:79], a[52:55], v[36:39], v[76:79]
    v_exp_f32 v72, v72
    v_mfma_f32_16x16x32_bf16 v[76:79], a[48:51], v[32:35], v[76:79]
    s_waitcnt vmcnt(6) lgkmcnt(0)
    s_barrier
    v_cvt_pk_bf16_f32 v100, v100, v101
    v_mfma_f32_16x16x32_bf16 v[124:127], a[152:155], v[220:223], v[124:127]
    v_exp_f32 v73, v73
    v_mfma_f32_16x16x32_bf16 v[124:127], a[184:187], v[212:215], v[124:127]
    s_add_u32 s29, s29, 0x2000
    v_perm_b32 v84, v73, v72, s35
    v_mfma_f32_16x16x32_bf16 v[124:127], a[216:219], v[244:247], v[124:127]
    s_add_u32 s30, s30, 0x2000
    v_cvt_pk_bf16_f32 v101, v102, v103
    v_mfma_f32_16x16x32_bf16 v[124:127], a[248:251], v[252:255], v[124:127]
    s_and_b32 s30, s30, 0x7fff
    ds_write_b128 v3, v[80:83] offset:0
    v_cvt_pk_bf16_f32 v102, v104, v105
    v_mfma_f32_16x16x32_bf16 v[128:131], a[252:255], v[252:255], v[128:131]
    s_mov_b32 m0, s30
    v_cvt_pk_bf16_f32 v103, v106, v107
    v_mfma_f32_16x16x32_bf16 v[128:131], a[220:223], v[244:247], v[128:131]
    buffer_load_dwordx4 v9, s[8:11], s29 offen lds
    v_mfma_f32_16x16x32_bf16 v[128:131], a[188:191], v[212:215], v[128:131]
    v_exp_f32 v74, v74
    v_mfma_f32_16x16x32_bf16 v[128:131], a[156:159], v[220:223], v[128:131]
    buffer_store_dwordx4 v[100:103], v10, s[20:23], s31 offen
    v_mfma_f32_16x16x32_bf16 v[64:67], a[64:67], v[32:35], 0
    ds_read_b128 v[220:223], v3 offset:35840
    ds_read_b128 v[212:215], v4 offset:35840
    v_mfma_f32_16x16x32_bf16 v[64:67], a[68:71], v[36:39], v[64:67]
    ds_read_b128 v[244:247], v5 offset:35840
    ds_read_b128 v[252:255], v6 offset:35840
    buffer_load_dwordx4 v9, s[8:11], s29 offen offset:1024 lds
    v_mfma_f32_16x16x32_bf16 v[64:67], a[72:75], v[40:43], v[64:67]
    v_exp_f32 v75, v75
    v_mfma_f32_16x16x32_bf16 v[64:67], a[76:79], v[44:47], v[64:67]
    v_perm_b32 v85, v75, v74, s35
    v_exp_f32 v76, v76
    v_exp_f32 v77, v77
    v_exp_f32 v78, v78
    v_mfma_f32_16x16x32_bf16 v[68:71], a[92:95], v[44:47], 0
    v_exp_f32 v79, v79
    v_mfma_f32_16x16x32_bf16 v[68:71], a[88:91], v[40:43], v[68:71]
    v_perm_b32 v86, v77, v76, s35
    v_perm_b32 v87, v79, v78, s35
    v_mfma_f32_16x16x32_bf16 v[68:71], a[84:87], v[36:39], v[68:71]
    v_exp_f32 v64, v64
    v_mfma_f32_16x16x32_bf16 v[68:71], a[80:83], v[32:35], v[68:71]
    ds_write_b128 v3, v[84:87] offset:1024
    v_exp_f32 v65, v65
    v_smfmac_f32_16x16x64_bf16 v[196:199], v[24:27], v[80:87], v23
    v_exp_f32 v66, v66
    v_exp_f32 v67, v67
    v_perm_b32 v92, v65, v64, s35
    s_mov_b32 s32, 0x3000
    v_mfma_f32_16x16x32_bf16 v[132:135], a[152:155], v[216:219], v[132:135]
    v_perm_b32 v93, v67, v66, s35
    v_mul_f32 v108, v108, v153
    v_mfma_f32_16x16x32_bf16 v[132:135], a[184:187], v[208:211], v[132:135]
    v_exp_f32 v68, v68
    v_mfma_f32_16x16x32_bf16 v[132:135], a[216:219], v[240:243], v[132:135]
    v_exp_f32 v69, v69
    v_mfma_f32_16x16x32_bf16 v[132:135], a[248:251], v[248:251], v[132:135]
    v_exp_f32 v70, v70
    v_exp_f32 v71, v71
    v_perm_b32 v94, v69, v68, s35
    v_mul_f32 v109, v109, v153
    v_mul_f32 v110, v110, v153
    v_mfma_f32_16x16x32_bf16 v[136:139], a[252:255], v[248:251], v[136:139]
    v_perm_b32 v95, v71, v70, s35
    v_mul_f32 v111, v111, v153
    v_mfma_f32_16x16x32_bf16 v[136:139], a[220:223], v[240:243], v[136:139]
    v_mul_f32 v112, v112, v153
    v_mul_f32 v113, v113, v153
    v_mfma_f32_16x16x32_bf16 v[136:139], a[188:191], v[208:211], v[136:139]
    v_mul_f32 v114, v114, v153
    v_mul_f32 v115, v115, v153
    v_mfma_f32_16x16x32_bf16 v[136:139], a[156:159], v[216:219], v[136:139]
    ds_write_b128 v3, v[92:95] offset:2048
    v_cvt_pk_bf16_f32 v108, v108, v109
    v_cvt_pk_bf16_f32 v109, v110, v111
    v_mfma_f32_16x16x32_bf16 v[72:75], a[96:99], v[32:35], 0
    ds_read_b128 v[216:219], v3 offset:36864
    ds_read_b128 v[208:211], v4 offset:36864
    v_mfma_f32_16x16x32_bf16 v[72:75], a[100:103], v[36:39], v[72:75]
    ds_read_b128 v[240:243], v5 offset:36864
    ds_read_b128 v[248:251], v6 offset:36864
    v_mfma_f32_16x16x32_bf16 v[72:75], a[104:107], v[40:43], v[72:75]
    v_cvt_pk_bf16_f32 v110, v112, v113
    v_cvt_pk_bf16_f32 v111, v114, v115
    v_mfma_f32_16x16x32_bf16 v[72:75], a[108:111], v[44:47], v[72:75]
    buffer_store_dwordx4 v[108:111], v10, s[20:23], s32 offen
    v_mfma_f32_16x16x32_bf16 v[76:79], a[124:127], v[44:47], 0
    v_add_f32 v200, v200, v201
    v_add_f32 v202, v202, v203
    v_mfma_f32_16x16x32_bf16 v[76:79], a[120:123], v[40:43], v[76:79]
    v_add_f32 v17, v200, v202
    s_mov_b32 s31, 0x4000
    v_mfma_f32_16x16x32_bf16 v[76:79], a[116:119], v[36:39], v[76:79]
    v_exp_f32 v72, v72
    v_mfma_f32_16x16x32_bf16 v[76:79], a[112:115], v[32:35], v[76:79]
    s_waitcnt lgkmcnt(6)
    v_exp_f32 v73, v73
    v_exp_f32 v74, v74
    v_exp_f32 v75, v75
    s_mov_b32 s32, 0x5000
    v_mfma_f32_16x16x32_bf16 v[140:143], a[152:155], v[220:223], v[140:143]
    v_perm_b32 v96, v73, v72, s35
    v_perm_b32 v97, v75, v74, s35
    v_mfma_f32_16x16x32_bf16 v[140:143], a[184:187], v[212:215], v[140:143]
    v_rcp_f32 v224, v17
    v_mfma_f32_16x16x32_bf16 v[140:143], a[216:219], v[244:247], v[140:143]
    v_exp_f32 v76, v76
    v_mfma_f32_16x16x32_bf16 v[140:143], a[248:251], v[252:255], v[140:143]
    v_exp_f32 v77, v77
    v_exp_f32 v78, v78
    v_exp_f32 v79, v79
    v_mov_b32 v225, v224
    v_mfma_f32_16x16x32_bf16 v[144:147], a[252:255], v[252:255], v[144:147]
    v_perm_b32 v98, v77, v76, s35
    v_perm_b32 v99, v79, v78, s35
    v_mfma_f32_16x16x32_bf16 v[144:147], a[220:223], v[244:247], v[144:147]
    v_max3_u32 v11, v11, v17, v224
    v_mul_f32 v116, v116, v156
    v_mfma_f32_16x16x32_bf16 v[144:147], a[188:191], v[212:215], v[144:147]
    v_permlane32_swap_b32 v224, v225
    v_mfma_f32_16x16x32_bf16 v[144:147], a[156:159], v[220:223], v[144:147]
    ds_write_b128 v3, v[96:99] offset:3072
    v_mul_f32 v117, v117, v156
    v_mul_f32 v118, v118, v156
    v_mfma_f32_16x16x32_bf16 v[64:67], a[0:3], v[48:51], 0
    ds_read_b128 v[220:223], v3 offset:37888
    ds_read_b128 v[212:215], v4 offset:37888
    v_mfma_f32_16x16x32_bf16 v[64:67], a[4:7], v[52:55], v[64:67]
    ds_read_b128 v[244:247], v5 offset:37888
    ds_read_b128 v[252:255], v6 offset:37888
    v_mfma_f32_16x16x32_bf16 v[64:67], a[8:11], v[56:59], v[64:67]
    v_mul_f32 v119, v119, v156
    v_mul_f32 v120, v120, v156
    v_mfma_f32_16x16x32_bf16 v[64:67], a[12:15], v[60:63], v[64:67]
    v_mul_f32 v121, v121, v156
    v_mul_f32 v122, v122, v156
    v_mul_f32 v123, v123, v156
    v_cvt_pk_bf16_f32 v116, v116, v117
    v_cvt_pk_bf16_f32 v117, v118, v119
    v_cvt_pk_bf16_f32 v118, v120, v121
    v_cvt_pk_bf16_f32 v119, v122, v123
    v_mfma_f32_16x16x32_bf16 v[68:71], a[28:31], v[60:63], 0
    v_mul_f32 v124, v124, v157
    v_mul_f32 v125, v125, v157
    v_mfma_f32_16x16x32_bf16 v[68:71], a[24:27], v[56:59], v[68:71]
    v_mul_f32 v126, v126, v157
    v_mul_f32 v127, v127, v157
    v_mfma_f32_16x16x32_bf16 v[68:71], a[20:23], v[52:55], v[68:71]
    v_exp_f32 v64, v64
    v_mfma_f32_16x16x32_bf16 v[68:71], a[16:19], v[48:51], v[68:71]
    buffer_store_dwordx4 v[116:119], v10, s[20:23], s31 offen
    v_smfmac_f32_16x16x64_bf16 v[196:199], v[24:27], v[92:99], v23
    s_waitcnt lgkmcnt(5)
    v_exp_f32 v65, v65
    v_exp_f32 v66, v66
    v_exp_f32 v67, v67
    v_mfma_f32_16x16x32_bf16 v[164:167], a[152:155], v[216:219], v[164:167]
    v_perm_b32 v100, v65, v64, s35
    v_perm_b32 v101, v67, v66, s35
    v_mfma_f32_16x16x32_bf16 v[164:167], a[184:187], v[208:211], v[164:167]
    v_exp_f32 v68, v68
    v_mfma_f32_16x16x32_bf16 v[164:167], a[216:219], v[240:243], v[164:167]
    v_exp_f32 v69, v69
    v_mfma_f32_16x16x32_bf16 v[164:167], a[248:251], v[248:251], v[164:167]
    v_exp_f32 v70, v70
    v_exp_f32 v71, v71
    v_perm_b32 v102, v69, v68, s35
    v_mul_f32 v128, v128, v157
    v_mul_f32 v129, v129, v157
    v_mfma_f32_16x16x32_bf16 v[168:171], a[252:255], v[248:251], v[168:171]
    v_perm_b32 v103, v71, v70, s35
    v_mul_f32 v130, v130, v157
    v_mfma_f32_16x16x32_bf16 v[168:171], a[220:223], v[240:243], v[168:171]
    v_mul_f32 v131, v131, v157
    v_cvt_pk_bf16_f32 v124, v124, v125
    v_mfma_f32_16x16x32_bf16 v[168:171], a[188:191], v[208:211], v[168:171]
    v_cvt_pk_bf16_f32 v125, v126, v127
    v_cvt_pk_bf16_f32 v126, v128, v129
    v_mfma_f32_16x16x32_bf16 v[168:171], a[156:159], v[216:219], v[168:171]
    ds_write_b128 v3, v[100:103] offset:4096
    v_cvt_pk_bf16_f32 v127, v130, v131
    s_mov_b32 s31, 0x6000
    v_mfma_f32_16x16x32_bf16 v[72:75], a[32:35], v[48:51], 0
    ds_read_b128 v[216:219], v3 offset:38912
    ds_read_b128 v[208:211], v4 offset:38912
    v_mfma_f32_16x16x32_bf16 v[72:75], a[36:39], v[52:55], v[72:75]
    ds_read_b128 v[240:243], v5 offset:38912
    ds_read_b128 v[248:251], v6 offset:38912
    v_mfma_f32_16x16x32_bf16 v[72:75], a[40:43], v[56:59], v[72:75]
    v_mul_f32 v132, v132, v160
    v_mul_f32 v133, v133, v160
    v_mfma_f32_16x16x32_bf16 v[72:75], a[44:47], v[60:63], v[72:75]
    buffer_store_dwordx4 v[124:127], v10, s[20:23], s32 offen
    v_mfma_f32_16x16x32_bf16 v[76:79], a[60:63], v[60:63], 0
    s_mov_b32 s32, 0x7000
    v_mul_f32 v134, v134, v160
    v_mfma_f32_16x16x32_bf16 v[76:79], a[56:59], v[56:59], v[76:79]
    v_mul_f32 v135, v135, v160
    v_mul_f32 v136, v136, v160
    v_mfma_f32_16x16x32_bf16 v[76:79], a[52:55], v[52:55], v[76:79]
    v_exp_f32 v72, v72
    v_mfma_f32_16x16x32_bf16 v[76:79], a[48:51], v[48:51], v[76:79]
    s_waitcnt lgkmcnt(5)
    v_exp_f32 v73, v73
    v_exp_f32 v74, v74
    v_exp_f32 v75, v75
    v_mul_f32 v137, v137, v160
    v_mfma_f32_16x16x32_bf16 v[172:175], a[152:155], v[220:223], v[172:175]
    v_perm_b32 v104, v73, v72, s35
    v_perm_b32 v105, v75, v74, s35
    v_mfma_f32_16x16x32_bf16 v[172:175], a[184:187], v[212:215], v[172:175]
    v_mul_f32 v138, v138, v160
    v_mul_f32 v139, v139, v160
    v_mfma_f32_16x16x32_bf16 v[172:175], a[216:219], v[244:247], v[172:175]
    v_exp_f32 v76, v76
    v_mfma_f32_16x16x32_bf16 v[172:175], a[248:251], v[252:255], v[172:175]
    v_exp_f32 v77, v77
    v_exp_f32 v78, v78
    v_exp_f32 v79, v79
    v_cvt_pk_bf16_f32 v132, v132, v133
    v_mfma_f32_16x16x32_bf16 v[176:179], a[252:255], v[252:255], v[176:179]
    v_perm_b32 v106, v77, v76, s35
    v_perm_b32 v107, v79, v78, s35
    v_mfma_f32_16x16x32_bf16 v[176:179], a[220:223], v[244:247], v[176:179]
    v_cvt_pk_bf16_f32 v133, v134, v135
    v_cvt_pk_bf16_f32 v134, v136, v137
    v_mfma_f32_16x16x32_bf16 v[176:179], a[188:191], v[212:215], v[176:179]
    v_xor_b32 v2, 0x4000, v2
    v_cvt_pk_bf16_f32 v135, v138, v139
    v_mfma_f32_16x16x32_bf16 v[176:179], a[156:159], v[220:223], v[176:179]
    ds_write_b128 v3, v[104:107] offset:5120
    v_mul_f32 v140, v140, v161
    v_mul_f32 v141, v141, v161
    v_mfma_f32_16x16x32_bf16 v[64:67], a[64:67], v[48:51], 0
    ds_read_b128 v[220:223], v3 offset:39936
    ds_read_b128 v[212:215], v4 offset:39936
    ds_read_b128 v[32:35], v2 offset:8192
    v_mfma_f32_16x16x32_bf16 v[64:67], a[68:71], v[52:55], v[64:67]
    ds_read_b128 v[244:247], v5 offset:39936
    ds_read_b128 v[252:255], v6 offset:39936
    v_mfma_f32_16x16x32_bf16 v[64:67], a[72:75], v[56:59], v[64:67]
    ds_read_b128 v[36:39], v2 offset:8704
    v_mul_f32 v142, v142, v161
    v_mfma_f32_16x16x32_bf16 v[64:67], a[76:79], v[60:63], v[64:67]
    buffer_store_dwordx4 v[132:135], v10, s[20:23], s31 offen
    v_mfma_f32_16x16x32_bf16 v[68:71], a[92:95], v[60:63], 0
    ds_read_b128 v[40:43], v2 offset:10240
    v_mul_f32 v143, v143, v161
    v_mfma_f32_16x16x32_bf16 v[68:71], a[88:91], v[56:59], v[68:71]
    v_mul_f32 v144, v144, v161
    v_mul_f32 v145, v145, v161
    v_mfma_f32_16x16x32_bf16 v[68:71], a[84:87], v[52:55], v[68:71]
    ds_read_b128 v[44:47], v2 offset:10752
    v_mul_f32 v146, v146, v161
    v_mfma_f32_16x16x32_bf16 v[68:71], a[80:83], v[48:51], v[68:71]
    v_exp_f32 v64, v64
    v_exp_f32 v65, v65
    v_exp_f32 v66, v66
    v_mul_f32 v147, v147, v161
    v_smfmac_f32_16x16x64_bf16 v[196:199], v[28:31], v[100:107], v23
    s_waitcnt lgkmcnt(9)
    v_exp_f32 v67, v67
    v_perm_b32 v108, v65, v64, s35
    v_cvt_pk_bf16_f32 v140, v140, v141
    v_cvt_pk_bf16_f32 v141, v142, v143
    v_cvt_pk_bf16_f32 v142, v144, v145
    v_mfma_f32_16x16x32_bf16 v[180:183], a[152:155], v[216:219], v[180:183]
    v_perm_b32 v109, v67, v66, s35
    v_cvt_pk_bf16_f32 v143, v146, v147
    v_mfma_f32_16x16x32_bf16 v[180:183], a[184:187], v[208:211], v[180:183]
    v_exp_f32 v68, v68
    v_mfma_f32_16x16x32_bf16 v[180:183], a[216:219], v[240:243], v[180:183]
    v_exp_f32 v69, v69
    v_mfma_f32_16x16x32_bf16 v[180:183], a[248:251], v[248:251], v[180:183]
    buffer_store_dwordx4 v[140:143], v10, s[20:23], s32 offen
    v_mfma_f32_16x16x32_bf16 v[184:187], a[252:255], v[248:251], v[184:187]
    v_exp_f32 v70, v70
    v_mfma_f32_16x16x32_bf16 v[184:187], a[220:223], v[240:243], v[184:187]
    v_exp_f32 v71, v71
    v_mfma_f32_16x16x32_bf16 v[184:187], a[188:191], v[208:211], v[184:187]
    v_perm_b32 v110, v69, v68, s35
    v_perm_b32 v111, v71, v70, s35
    v_mfma_f32_16x16x32_bf16 v[184:187], a[156:159], v[216:219], v[184:187]
    ds_write_b128 v3, v[108:111] offset:6144
    s_mov_b32 s31, 0x8000
    s_mov_b32 s32, 0x9000
    v_mfma_f32_16x16x32_bf16 v[72:75], a[96:99], v[48:51], 0
    v_mul_f32 v164, v164, v224
    v_mul_f32 v165, v165, v224
    v_mfma_f32_16x16x32_bf16 v[72:75], a[100:103], v[52:55], v[72:75]
    v_mul_f32 v166, v166, v224
    v_mul_f32 v167, v167, v224
    v_mfma_f32_16x16x32_bf16 v[72:75], a[104:107], v[56:59], v[72:75]
    v_mul_f32 v168, v168, v224
    v_mul_f32 v169, v169, v224
    v_mfma_f32_16x16x32_bf16 v[72:75], a[108:111], v[60:63], v[72:75]
    v_mul_f32 v170, v170, v224
    v_mul_f32 v171, v171, v224
    v_cvt_pk_bf16_f32 v164, v164, v165
    v_cvt_pk_bf16_f32 v165, v166, v167
    v_cvt_pk_bf16_f32 v166, v168, v169
    v_cvt_pk_bf16_f32 v167, v170, v171
    v_mul_f32 v172, v172, v225
    v_mfma_f32_16x16x32_bf16 v[76:79], a[124:127], v[60:63], 0
    v_mul_f32 v173, v173, v225
    v_mul_f32 v174, v174, v225
    v_mfma_f32_16x16x32_bf16 v[76:79], a[120:123], v[56:59], v[76:79]
    v_mul_f32 v175, v175, v225
    v_mul_f32 v176, v176, v225
    v_mfma_f32_16x16x32_bf16 v[76:79], a[116:119], v[52:55], v[76:79]
    ds_read_b128 v[200:203], v8 offset:29184
    v_mul_f32 v177, v177, v225
    v_mfma_f32_16x16x32_bf16 v[76:79], a[112:115], v[48:51], v[76:79]
    s_waitcnt lgkmcnt(5)
    buffer_store_dwordx4 v[164:167], v10, s[20:23], s31 offen
    v_mfma_f32_16x16x32_bf16 v[188:191], a[152:155], v[220:223], v[188:191]
    v_exp_f32 v72, v72
    v_mfma_f32_16x16x32_bf16 v[188:191], a[184:187], v[212:215], v[188:191]
    v_exp_f32 v73, v73
    v_mfma_f32_16x16x32_bf16 v[188:191], a[216:219], v[244:247], v[188:191]
    v_exp_f32 v74, v74
    v_mfma_f32_16x16x32_bf16 v[188:191], a[248:251], v[252:255], v[188:191]
    v_exp_f32 v75, v75
    v_perm_b32 v112, v73, v72, s35
    v_exp_f32 v76, v76
    v_exp_f32 v77, v77
    v_mfma_f32_16x16x32_bf16 v[192:195], a[252:255], v[252:255], v[192:195]
    v_perm_b32 v113, v75, v74, s35
    v_mul_f32 v178, v178, v225
    v_mfma_f32_16x16x32_bf16 v[192:195], a[220:223], v[244:247], v[192:195]
    ds_read_b128 v[48:51], v2 offset:12288
    ds_read_b128 v[52:55], v2 offset:12800
    v_mfma_f32_16x16x32_bf16 v[192:195], a[188:191], v[212:215], v[192:195]
    ds_read_b128 v[56:59], v2 offset:14336
    ds_read_b128 v[60:63], v2 offset:14848
    v_mfma_f32_16x16x32_bf16 v[192:195], a[156:159], v[220:223], v[192:195]
    s_waitcnt lgkmcnt(4)
    v_mul_f32 v179, v179, v225
    v_cvt_pk_bf16_f32 v172, v172, v173
    v_cvt_pk_bf16_f32 v173, v174, v175
    v_cvt_pk_bf16_f32 v174, v176, v177
    v_cvt_pk_bf16_f32 v175, v178, v179
    buffer_store_dwordx4 v[172:175], v10, s[20:23], s32 offen
    s_mov_b32 s33, 18
L_loopB0:
    v_mfma_f32_16x16x32_bf16 v[64:67], a[0:3], v[32:35], 0
    v_exp_f32 v78, v78
    v_mfma_f32_16x16x32_bf16 v[64:67], a[4:7], v[36:39], v[64:67]
    v_exp_f32 v79, v79
    v_mfma_f32_16x16x32_bf16 v[64:67], a[8:11], v[40:43], v[64:67]
    v_perm_b32 v114, v77, v76, s35
    v_perm_b32 v115, v79, v78, s35
    v_mfma_f32_16x16x32_bf16 v[64:67], a[12:15], v[44:47], v[64:67]
    v_add_f32 v200, v200, v201
    v_add_f32 v202, v202, v203
    v_smfmac_f32_16x16x64_bf16 v[196:199], v[28:31], v[108:115], v23
    v_add_f32 v17, v200, v202
    v_mfma_f32_16x16x32_bf16 v[68:71], a[28:31], v[44:47], 0
    v_rcp_f32 v19, v17
    v_mfma_f32_16x16x32_bf16 v[68:71], a[24:27], v[40:43], v[68:71]
    v_max3_u32 v11, v11, v17, v19
    v_mov_b32 v20, v19
    v_mfma_f32_16x16x32_bf16 v[68:71], a[20:23], v[36:39], v[68:71]
    v_add_f32 v198, v196, v197
    v_mov_b64 v[196:197], 0
    v_mfma_f32_16x16x32_bf16 v[68:71], a[16:19], v[32:35], v[68:71]
    ds_write_b128 v3, v[112:115] offset:7168
    v_mfma_f32_16x16x32_bf16 v[164:167], a[128:131], v[80:83], 0
    ds_write_b32 v7, v198 offset:28672
    v_mfma_f32_16x16x32_bf16 v[164:167], a[136:139], v[84:87], v[164:167]
    v_exp_f32 v64, v64
    v_mfma_f32_16x16x32_bf16 v[164:167], a[144:147], v[92:95], v[164:167]
    v_exp_f32 v65, v65
    v_mfma_f32_16x16x32_bf16 v[164:167], a[152:155], v[96:99], v[164:167]
    v_exp_f32 v66, v66
    v_mfma_f32_16x16x32_bf16 v[168:171], a[156:159], v[96:99], 0
    v_exp_f32 v67, v67
    v_mfma_f32_16x16x32_bf16 v[168:171], a[148:151], v[92:95], v[168:171]
    v_perm_b32 v88, v65, v64, s35
    v_perm_b32 v89, v67, v66, s35
    v_mfma_f32_16x16x32_bf16 v[168:171], a[140:143], v[84:87], v[168:171]
    v_exp_f32 v68, v68
    v_mfma_f32_16x16x32_bf16 v[168:171], a[132:135], v[80:83], v[168:171]
    v_exp_f32 v69, v69
    v_mfma_f32_16x16x32_bf16 v[72:75], a[32:35], v[32:35], 0
    v_exp_f32 v70, v70
    v_mfma_f32_16x16x32_bf16 v[72:75], a[36:39], v[36:39], v[72:75]
    v_exp_f32 v71, v71
    v_mfma_f32_16x16x32_bf16 v[72:75], a[40:43], v[40:43], v[72:75]
    s_waitcnt vmcnt(9) lgkmcnt(0)
    v_perm_b32 v90, v69, v68, s35
    v_perm_b32 v91, v71, v70, s35
    v_mfma_f32_16x16x32_bf16 v[72:75], a[44:47], v[44:47], v[72:75]
    s_barrier
    v_mfma_f32_16x16x32_bf16 v[76:79], a[60:63], v[44:47], 0
    v_permlane32_swap_b32 v19, v20
    v_mfma_f32_16x16x32_bf16 v[76:79], a[56:59], v[40:43], v[76:79]
    ds_read_b128 v[116:119], v4 offset:0
    ds_read_b128 v[120:123], v4 offset:1024
    v_mfma_f32_16x16x32_bf16 v[76:79], a[52:55], v[36:39], v[76:79]
    ds_read_b128 v[124:127], v4 offset:2048
    ds_read_b128 v[128:131], v4 offset:3072
    v_mfma_f32_16x16x32_bf16 v[76:79], a[48:51], v[32:35], v[76:79]
    ds_write_b128 v3, v[88:91] offset:32768
    v_mfma_f32_16x16x32_bf16 v[172:175], a[128:131], v[100:103], 0
    v_exp_f32 v72, v72
    v_mfma_f32_16x16x32_bf16 v[172:175], a[136:139], v[104:107], v[172:175]
    s_add_u32 s29, s29, 0x2000
    v_exp_f32 v73, v73
    v_mfma_f32_16x16x32_bf16 v[172:175], a[144:147], v[108:111], v[172:175]
    v_exp_f32 v74, v74
    v_mfma_f32_16x16x32_bf16 v[172:175], a[152:155], v[112:115], v[172:175]
    s_add_u32 s30, s30, 0x2000
    v_exp_f32 v75, v75
    v_mfma_f32_16x16x32_bf16 v[176:179], a[156:159], v[112:115], 0
    v_perm_b32 v84, v73, v72, s35
    v_perm_b32 v85, v75, v74, s35
    v_mfma_f32_16x16x32_bf16 v[176:179], a[148:151], v[108:111], v[176:179]
    s_add_u32 s31, s31, 0x2000
    ds_read_b128 v[132:135], v5 offset:0
    ds_read_b128 v[136:139], v5 offset:1024
    v_mfma_f32_16x16x32_bf16 v[176:179], a[140:143], v[104:107], v[176:179]
    s_and_b32 s30, s30, 0x7fff
    v_exp_f32 v76, v76
    v_mfma_f32_16x16x32_bf16 v[176:179], a[132:135], v[100:103], v[176:179]
    v_exp_f32 v77, v77
    v_mfma_f32_16x16x32_bf16 v[64:67], a[64:67], v[32:35], 0
    v_exp_f32 v78, v78
    v_mfma_f32_16x16x32_bf16 v[64:67], a[68:71], v[36:39], v[64:67]
    s_add_u32 s32, s32, 0x2000
    v_exp_f32 v79, v79
    v_mfma_f32_16x16x32_bf16 v[64:67], a[72:75], v[40:43], v[64:67]
    v_perm_b32 v86, v77, v76, s35
    v_perm_b32 v87, v79, v78, s35
    v_mfma_f32_16x16x32_bf16 v[64:67], a[76:79], v[44:47], v[64:67]
    ds_write_b128 v3, v[84:87] offset:33792
    v_mfma_f32_16x16x32_bf16 v[68:71], a[92:95], v[44:47], 0
    ds_read_b128 v[140:143], v5 offset:2048
    ds_read_b128 v[144:147], v5 offset:3072
    v_mfma_f32_16x16x32_bf16 v[68:71], a[88:91], v[40:43], v[68:71]
    s_mov_b32 m0, s30
    v_mul_f32 v180, v180, v19
    v_mul_f32 v181, v181, v19
    v_mfma_f32_16x16x32_bf16 v[68:71], a[84:87], v[36:39], v[68:71]
    v_exp_f32 v64, v64
    v_mfma_f32_16x16x32_bf16 v[68:71], a[80:83], v[32:35], v[68:71]
    v_exp_f32 v65, v65
    v_smfmac_f32_16x16x64_bf16 v[196:199], v[24:27], v[84:91], v23
    v_mul_f32 v182, v182, v19
    v_mfma_f32_16x16x32_bf16 v[72:75], a[96:99], v[32:35], 0
    v_exp_f32 v66, v66
    v_mfma_f32_16x16x32_bf16 v[72:75], a[100:103], v[36:39], v[72:75]
    ds_read_b128 v[148:151], v6 offset:0
    ds_read_b128 v[152:155], v6 offset:1024
    v_mfma_f32_16x16x32_bf16 v[72:75], a[104:107], v[40:43], v[72:75]
    ds_read_b128 v[156:159], v6 offset:2048
    ds_read_b128 v[160:163], v6 offset:3072
    v_mfma_f32_16x16x32_bf16 v[72:75], a[108:111], v[44:47], v[72:75]
    s_waitcnt lgkmcnt(10)
    buffer_load_dwordx4 v9, s[8:11], s29 offen lds
    v_mfma_f32_16x16x32_bf16 v[164:167], a[160:163], v[116:119], v[164:167]
    v_exp_f32 v67, v67
    v_mfma_f32_16x16x32_bf16 v[164:167], a[168:171], v[120:123], v[164:167]
    v_perm_b32 v92, v65, v64, s35
    v_perm_b32 v93, v67, v66, s35
    v_mfma_f32_16x16x32_bf16 v[164:167], a[176:179], v[124:127], v[164:167]
    v_exp_f32 v68, v68
    v_mfma_f32_16x16x32_bf16 v[164:167], a[184:187], v[128:131], v[164:167]
    s_waitcnt lgkmcnt(4)
    v_exp_f32 v69, v69
    v_mfma_f32_16x16x32_bf16 v[164:167], a[192:195], v[132:135], v[164:167]
    v_mfma_f32_16x16x32_bf16 v[164:167], a[200:203], v[136:139], v[164:167]
    v_exp_f32 v70, v70
    v_mfma_f32_16x16x32_bf16 v[164:167], a[208:211], v[140:143], v[164:167]
    v_exp_f32 v71, v71
    v_mfma_f32_16x16x32_bf16 v[164:167], a[216:219], v[144:147], v[164:167]
    s_waitcnt lgkmcnt(0)
    v_perm_b32 v94, v69, v68, s35
    v_perm_b32 v95, v71, v70, s35
    v_mfma_f32_16x16x32_bf16 v[164:167], a[224:227], v[148:151], v[164:167]
    v_exp_f32 v72, v72
    v_mfma_f32_16x16x32_bf16 v[164:167], a[232:235], v[152:155], v[164:167]
    v_exp_f32 v73, v73
    v_mfma_f32_16x16x32_bf16 v[164:167], a[240:243], v[156:159], v[164:167]
    v_exp_f32 v74, v74
    v_mfma_f32_16x16x32_bf16 v[164:167], a[248:251], v[160:163], v[164:167]
    ds_write_b128 v3, v[92:95] offset:34816
    v_mfma_f32_16x16x32_bf16 v[76:79], a[112:115], v[32:35], 0
    v_exp_f32 v75, v75
    v_mfma_f32_16x16x32_bf16 v[76:79], a[116:119], v[36:39], v[76:79]
    v_perm_b32 v96, v73, v72, s35
    v_perm_b32 v97, v75, v74, s35
    v_mfma_f32_16x16x32_bf16 v[76:79], a[120:123], v[40:43], v[76:79]
    v_mul_f32 v183, v183, v19
    v_mul_f32 v184, v184, v19
    v_mfma_f32_16x16x32_bf16 v[76:79], a[124:127], v[44:47], v[76:79]
L_s11:
    s_cbranch_execz L_ce4B
L_s11_n:
    v_mul_f32 v185, v185, v19
    v_mul_f32 v186, v186, v19
    v_mfma_f32_16x16x32_bf16 v[64:67], a[0:3], v[48:51], 0
    v_mul_f32 v187, v187, v19
    v_cvt_pk_bf16_f32 v208, v180, v181
    v_mfma_f32_16x16x32_bf16 v[64:67], a[4:7], v[52:55], v[64:67]
    v_cvt_pk_bf16_f32 v209, v182, v183
    v_cvt_pk_bf16_f32 v210, v184, v185
    v_mfma_f32_16x16x32_bf16 v[64:67], a[8:11], v[56:59], v[64:67]
    v_exp_f32 v76, v76
    v_mfma_f32_16x16x32_bf16 v[64:67], a[12:15], v[60:63], v[64:67]
    v_exp_f32 v77, v77
    v_mfma_f32_16x16x32_bf16 v[68:71], a[28:31], v[60:63], 0
    v_exp_f32 v78, v78
    v_mfma_f32_16x16x32_bf16 v[68:71], a[24:27], v[56:59], v[68:71]
    v_exp_f32 v79, v79
    v_mfma_f32_16x16x32_bf16 v[68:71], a[20:23], v[52:55], v[68:71]
    v_perm_b32 v98, v77, v76, s35
    v_perm_b32 v99, v79, v78, s35
    v_mfma_f32_16x16x32_bf16 v[68:71], a[16:19], v[48:51], v[68:71]
    ds_write_b128 v3, v[96:99] offset:35840
    v_mfma_f32_16x16x32_bf16 v[168:171], a[164:167], v[116:119], v[168:171]
    v_exp_f32 v64, v64
    v_mfma_f32_16x16x32_bf16 v[168:171], a[172:175], v[120:123], v[168:171]
    v_exp_f32 v65, v65
    v_mfma_f32_16x16x32_bf16 v[168:171], a[180:183], v[124:127], v[168:171]
    v_exp_f32 v66, v66
    v_mfma_f32_16x16x32_bf16 v[168:171], a[188:191], v[128:131], v[168:171]
    v_exp_f32 v67, v67
    v_mfma_f32_16x16x32_bf16 v[168:171], a[196:199], v[132:135], v[168:171]
    v_perm_b32 v100, v65, v64, s35
    v_perm_b32 v101, v67, v66, s35
    v_mfma_f32_16x16x32_bf16 v[168:171], a[204:207], v[136:139], v[168:171]
    ds_read_b128 v[116:119], v4 offset:4096
    ds_read_b128 v[120:123], v4 offset:5120
    v_mfma_f32_16x16x32_bf16 v[168:171], a[212:215], v[140:143], v[168:171]
    ds_read_b128 v[124:127], v4 offset:6144
    ds_read_b128 v[128:131], v4 offset:7168
    v_mfma_f32_16x16x32_bf16 v[168:171], a[220:223], v[144:147], v[168:171]
    ds_read_b128 v[132:135], v5 offset:4096
    ds_read_b128 v[136:139], v5 offset:5120
    v_mfma_f32_16x16x32_bf16 v[168:171], a[228:231], v[148:151], v[168:171]
    ds_read_b128 v[140:143], v5 offset:6144
    ds_read_b128 v[144:147], v5 offset:7168
    v_mfma_f32_16x16x32_bf16 v[168:171], a[236:239], v[152:155], v[168:171]
    v_exp_f32 v68, v68
    v_mfma_f32_16x16x32_bf16 v[168:171], a[244:247], v[156:159], v[168:171]
    v_exp_f32 v69, v69
    v_mfma_f32_16x16x32_bf16 v[168:171], a[252:255], v[160:163], v[168:171]
    v_exp_f32 v70, v70
    v_smfmac_f32_16x16x64_bf16 v[196:199], v[24:27], v[92:99], v23
    v_cvt_pk_bf16_f32 v211, v186, v187
    v_mfma_f32_16x16x32_bf16 v[72:75], a[32:35], v[48:51], 0
    v_exp_f32 v71, v71
    v_mfma_f32_16x16x32_bf16 v[72:75], a[36:39], v[52:55], v[72:75]
    v_perm_b32 v102, v69, v68, s35
    v_perm_b32 v103, v71, v70, s35
    v_mfma_f32_16x16x32_bf16 v[72:75], a[40:43], v[56:59], v[72:75]
    ds_read_b128 v[148:151], v6 offset:4096
    ds_read_b128 v[152:155], v6 offset:5120
    v_mfma_f32_16x16x32_bf16 v[72:75], a[44:47], v[60:63], v[72:75]
    ds_write_b128 v3, v[100:103] offset:36864
    v_mfma_f32_16x16x32_bf16 v[76:79], a[60:63], v[60:63], 0
    ds_read_b128 v[156:159], v6 offset:6144
    ds_read_b128 v[160:163], v6 offset:7168
    v_mfma_f32_16x16x32_bf16 v[76:79], a[56:59], v[56:59], v[76:79]
    v_mul_f32 v188, v188, v20
    v_mul_f32 v189, v189, v20
    v_mfma_f32_16x16x32_bf16 v[76:79], a[52:55], v[52:55], v[76:79]
    v_exp_f32 v72, v72
    v_mfma_f32_16x16x32_bf16 v[76:79], a[48:51], v[48:51], v[76:79]
    v_exp_f32 v73, v73
    v_mfma_f32_16x16x32_bf16 v[64:67], a[64:67], v[48:51], 0
    v_exp_f32 v74, v74
    v_mfma_f32_16x16x32_bf16 v[64:67], a[68:71], v[52:55], v[64:67]
    v_exp_f32 v75, v75
    v_mfma_f32_16x16x32_bf16 v[64:67], a[72:75], v[56:59], v[64:67]
    v_perm_b32 v104, v73, v72, s35
    v_perm_b32 v105, v75, v74, s35
    v_mfma_f32_16x16x32_bf16 v[64:67], a[76:79], v[60:63], v[64:67]
    s_waitcnt lgkmcnt(9)
    buffer_store_dwordx4 v[208:211], v10, s[20:23], s31 offen sc1 nt
    v_mfma_f32_16x16x32_bf16 v[172:175], a[160:163], v[116:119], v[172:175]
    v_exp_f32 v76, v76
    v_mfma_f32_16x16x32_bf16 v[172:175], a[168:171], v[120:123], v[172:175]
    v_exp_f32 v77, v77
    v_mfma_f32_16x16x32_bf16 v[172:175], a[176:179], v[124:127], v[172:175]
    v_exp_f32 v78, v78
    v_mfma_f32_16x16x32_bf16 v[172:175], a[184:187], v[128:131], v[172:175]
    s_waitcnt lgkmcnt(5)
    v_exp_f32 v79, v79
    v_mfma_f32_16x16x32_bf16 v[172:175], a[192:195], v[132:135], v[172:175]
    v_perm_b32 v106, v77, v76, s35
    v_perm_b32 v107, v79, v78, s35
    v_mfma_f32_16x16x32_bf16 v[172:175], a[200:203], v[136:139], v[172:175]
    v_exp_f32 v64, v64
    v_mfma_f32_16x16x32_bf16 v[172:175], a[208:211], v[140:143], v[172:175]
    v_exp_f32 v65, v65
    v_mfma_f32_16x16x32_bf16 v[172:175], a[216:219], v[144:147], v[172:175]
    s_waitcnt lgkmcnt(0)
    v_exp_f32 v66, v66
    v_mfma_f32_16x16x32_bf16 v[172:175], a[224:227], v[148:151], v[172:175]
    v_exp_f32 v67, v67
    v_mfma_f32_16x16x32_bf16 v[172:175], a[232:235], v[152:155], v[172:175]
    v_perm_b32 v108, v65, v64, s35
    v_perm_b32 v109, v67, v66, s35
    v_mfma_f32_16x16x32_bf16 v[172:175], a[240:243], v[156:159], v[172:175]
    v_mul_f32 v190, v190, v20
    v_mul_f32 v191, v191, v20
    v_mfma_f32_16x16x32_bf16 v[172:175], a[248:251], v[160:163], v[172:175]
    ds_write_b128 v3, v[104:107] offset:37888
    v_mfma_f32_16x16x32_bf16 v[68:71], a[80:83], v[48:51], 0
    ds_read_b128 v[200:203], v8 offset:28672
    v_mul_f32 v192, v192, v20
    v_mfma_f32_16x16x32_bf16 v[68:71], a[84:87], v[52:55], v[68:71]
    v_mul_f32 v193, v193, v20
    v_mul_f32 v194, v194, v20
    v_mfma_f32_16x16x32_bf16 v[68:71], a[88:91], v[56:59], v[68:71]
    v_mul_f32 v195, v195, v20
    v_cvt_pk_bf16_f32 v212, v188, v189
    v_mfma_f32_16x16x32_bf16 v[68:71], a[92:95], v[60:63], v[68:71]
    v_cvt_pk_bf16_f32 v213, v190, v191
    v_smfmac_f32_16x16x64_bf16 v[196:199], v[28:31], v[100:107], v23
    v_xor_b32 v2, 0x4000, v2
    v_mfma_f32_16x16x32_bf16 v[72:75], a[108:111], v[60:63], 0
    v_cvt_pk_bf16_f32 v214, v192, v193
    v_cvt_pk_bf16_f32 v215, v194, v195
    v_mfma_f32_16x16x32_bf16 v[72:75], a[104:107], v[56:59], v[72:75]
    ds_read_b128 v[32:35], v2 offset:0
    ds_read_b128 v[36:39], v2 offset:512
    v_mfma_f32_16x16x32_bf16 v[72:75], a[100:103], v[52:55], v[72:75]
    v_exp_f32 v68, v68
    v_mfma_f32_16x16x32_bf16 v[72:75], a[96:99], v[48:51], v[72:75]
    v_exp_f32 v69, v69
    v_mfma_f32_16x16x32_bf16 v[76:79], a[112:115], v[48:51], 0
    v_exp_f32 v70, v70
    v_mfma_f32_16x16x32_bf16 v[76:79], a[116:119], v[52:55], v[76:79]
    v_exp_f32 v71, v71
    v_mfma_f32_16x16x32_bf16 v[76:79], a[120:123], v[56:59], v[76:79]
    v_perm_b32 v110, v69, v68, s35
    v_perm_b32 v111, v71, v70, s35
    v_mfma_f32_16x16x32_bf16 v[76:79], a[124:127], v[60:63], v[76:79]
    ds_write_b128 v3, v[108:111] offset:38912
    v_mfma_f32_16x16x32_bf16 v[176:179], a[164:167], v[116:119], v[176:179]
    ds_read_b128 v[40:43], v2 offset:2048
    ds_read_b128 v[44:47], v2 offset:2560
    v_mfma_f32_16x16x32_bf16 v[176:179], a[172:175], v[120:123], v[176:179]
    v_exp_f32 v72, v72
    v_mfma_f32_16x16x32_bf16 v[176:179], a[180:183], v[124:127], v[176:179]
    v_exp_f32 v73, v73
    v_mfma_f32_16x16x32_bf16 v[176:179], a[188:191], v[128:131], v[176:179]
    v_exp_f32 v74, v74
    v_mfma_f32_16x16x32_bf16 v[176:179], a[196:199], v[132:135], v[176:179]
    v_exp_f32 v75, v75
    v_mfma_f32_16x16x32_bf16 v[176:179], a[204:207], v[136:139], v[176:179]
    v_perm_b32 v112, v73, v72, s35
    v_perm_b32 v113, v75, v74, s35
    v_mfma_f32_16x16x32_bf16 v[176:179], a[212:215], v[140:143], v[176:179]
    v_exp_f32 v76, v76
    v_mfma_f32_16x16x32_bf16 v[176:179], a[220:223], v[144:147], v[176:179]
    v_exp_f32 v77, v77
    v_mfma_f32_16x16x32_bf16 v[176:179], a[228:231], v[148:151], v[176:179]
    buffer_load_dwordx4 v9, s[8:11], s29 offen offset:1024 lds
    v_mfma_f32_16x16x32_bf16 v[176:179], a[236:239], v[152:155], v[176:179]
    ds_read_b128 v[48:51], v2 offset:4096
    ds_read_b128 v[52:55], v2 offset:4608
    v_mfma_f32_16x16x32_bf16 v[176:179], a[244:247], v[156:159], v[176:179]
    ds_read_b128 v[56:59], v2 offset:6144
    ds_read_b128 v[60:63], v2 offset:6656
    v_mfma_f32_16x16x32_bf16 v[176:179], a[252:255], v[160:163], v[176:179]
    s_waitcnt lgkmcnt(4)
    buffer_store_dwordx4 v[212:215], v10, s[20:23], s32 offen sc1 nt
    v_mfma_f32_16x16x32_bf16 v[64:67], a[0:3], v[32:35], 0
    v_exp_f32 v78, v78
    v_mfma_f32_16x16x32_bf16 v[64:67], a[4:7], v[36:39], v[64:67]
    v_exp_f32 v79, v79
    v_mfma_f32_16x16x32_bf16 v[64:67], a[8:11], v[40:43], v[64:67]
    v_perm_b32 v114, v77, v76, s35
    v_perm_b32 v115, v79, v78, s35
    v_mfma_f32_16x16x32_bf16 v[64:67], a[12:15], v[44:47], v[64:67]
    v_add_f32 v200, v200, v201
    v_add_f32 v202, v202, v203
    v_smfmac_f32_16x16x64_bf16 v[196:199], v[28:31], v[108:115], v23
    v_add_f32 v17, v200, v202
    v_mfma_f32_16x16x32_bf16 v[68:71], a[28:31], v[44:47], 0
    v_rcp_f32 v19, v17
    v_mfma_f32_16x16x32_bf16 v[68:71], a[24:27], v[40:43], v[68:71]
    v_max3_u32 v11, v11, v17, v19
    v_mov_b32 v20, v19
    v_mfma_f32_16x16x32_bf16 v[68:71], a[20:23], v[36:39], v[68:71]
    v_add_f32 v198, v196, v197
    v_mov_b64 v[196:197], 0
    v_mfma_f32_16x16x32_bf16 v[68:71], a[16:19], v[32:35], v[68:71]
    ds_write_b128 v3, v[112:115] offset:39936
    v_mfma_f32_16x16x32_bf16 v[180:183], a[128:131], v[88:91], 0
    ds_write_b32 v7, v198 offset:29184
    v_mfma_f32_16x16x32_bf16 v[180:183], a[136:139], v[84:87], v[180:183]
    v_exp_f32 v64, v64
    v_mfma_f32_16x16x32_bf16 v[180:183], a[144:147], v[92:95], v[180:183]
    v_exp_f32 v65, v65
    v_mfma_f32_16x16x32_bf16 v[180:183], a[152:155], v[96:99], v[180:183]
    v_exp_f32 v66, v66
    v_mfma_f32_16x16x32_bf16 v[184:187], a[156:159], v[96:99], 0
    v_exp_f32 v67, v67
    v_mfma_f32_16x16x32_bf16 v[184:187], a[148:151], v[92:95], v[184:187]
    v_perm_b32 v80, v65, v64, s35
    v_perm_b32 v81, v67, v66, s35
    v_mfma_f32_16x16x32_bf16 v[184:187], a[140:143], v[84:87], v[184:187]
    v_exp_f32 v68, v68
    v_mfma_f32_16x16x32_bf16 v[184:187], a[132:135], v[88:91], v[184:187]
    v_exp_f32 v69, v69
    v_mfma_f32_16x16x32_bf16 v[72:75], a[32:35], v[32:35], 0
    v_exp_f32 v70, v70
    v_mfma_f32_16x16x32_bf16 v[72:75], a[36:39], v[36:39], v[72:75]
    v_exp_f32 v71, v71
    v_mfma_f32_16x16x32_bf16 v[72:75], a[40:43], v[40:43], v[72:75]
    s_waitcnt vmcnt(9) lgkmcnt(0)
    v_perm_b32 v82, v69, v68, s35
    v_perm_b32 v83, v71, v70, s35
    v_mfma_f32_16x16x32_bf16 v[72:75], a[44:47], v[44:47], v[72:75]
    s_barrier
    v_mfma_f32_16x16x32_bf16 v[76:79], a[60:63], v[44:47], 0
    v_permlane32_swap_b32 v19, v20
    v_mfma_f32_16x16x32_bf16 v[76:79], a[56:59], v[40:43], v[76:79]
    ds_read_b128 v[116:119], v4 offset:32768
    ds_read_b128 v[120:123], v4 offset:33792
    v_mfma_f32_16x16x32_bf16 v[76:79], a[52:55], v[36:39], v[76:79]
    ds_read_b128 v[124:127], v4 offset:34816
    ds_read_b128 v[128:131], v4 offset:35840
    v_mfma_f32_16x16x32_bf16 v[76:79], a[48:51], v[32:35], v[76:79]
    ds_write_b128 v3, v[80:83] offset:0
    v_mfma_f32_16x16x32_bf16 v[188:191], a[128:131], v[100:103], 0
    v_exp_f32 v72, v72
    v_mfma_f32_16x16x32_bf16 v[188:191], a[136:139], v[104:107], v[188:191]
    s_add_u32 s29, s29, 0x2000
    v_exp_f32 v73, v73
    v_mfma_f32_16x16x32_bf16 v[188:191], a[144:147], v[108:111], v[188:191]
    v_exp_f32 v74, v74
    v_mfma_f32_16x16x32_bf16 v[188:191], a[152:155], v[112:115], v[188:191]
    s_add_u32 s30, s30, 0x2000
    v_exp_f32 v75, v75
    v_mfma_f32_16x16x32_bf16 v[192:195], a[156:159], v[112:115], 0
    v_perm_b32 v84, v73, v72, s35
    v_perm_b32 v85, v75, v74, s35
    v_mfma_f32_16x16x32_bf16 v[192:195], a[148:151], v[108:111], v[192:195]
    s_add_u32 s31, s31, 0x2000
    ds_read_b128 v[132:135], v5 offset:32768
    ds_read_b128 v[136:139], v5 offset:33792
    v_mfma_f32_16x16x32_bf16 v[192:195], a[140:143], v[104:107], v[192:195]
    s_and_b32 s30, s30, 0x7fff
    v_exp_f32 v76, v76
    v_mfma_f32_16x16x32_bf16 v[192:195], a[132:135], v[100:103], v[192:195]
    v_exp_f32 v77, v77
    v_mfma_f32_16x16x32_bf16 v[64:67], a[64:67], v[32:35], 0
    v_exp_f32 v78, v78
    v_mfma_f32_16x16x32_bf16 v[64:67], a[68:71], v[36:39], v[64:67]
    s_add_u32 s32, s32, 0x2000
    v_exp_f32 v79, v79
    v_mfma_f32_16x16x32_bf16 v[64:67], a[72:75], v[40:43], v[64:67]
    v_perm_b32 v86, v77, v76, s35
    v_perm_b32 v87, v79, v78, s35
    v_mfma_f32_16x16x32_bf16 v[64:67], a[76:79], v[44:47], v[64:67]
    ds_write_b128 v3, v[84:87] offset:1024
    v_mfma_f32_16x16x32_bf16 v[68:71], a[92:95], v[44:47], 0
    ds_read_b128 v[140:143], v5 offset:34816
    ds_read_b128 v[144:147], v5 offset:35840
    v_mfma_f32_16x16x32_bf16 v[68:71], a[88:91], v[40:43], v[68:71]
    s_mov_b32 m0, s30
    v_mul_f32 v164, v164, v19
    v_mul_f32 v165, v165, v19
    v_mfma_f32_16x16x32_bf16 v[68:71], a[84:87], v[36:39], v[68:71]
    v_exp_f32 v64, v64
    v_mfma_f32_16x16x32_bf16 v[68:71], a[80:83], v[32:35], v[68:71]
    v_exp_f32 v65, v65
    v_smfmac_f32_16x16x64_bf16 v[196:199], v[24:27], v[80:87], v23
    v_mul_f32 v166, v166, v19
    v_mfma_f32_16x16x32_bf16 v[72:75], a[96:99], v[32:35], 0
    v_exp_f32 v66, v66
    v_mfma_f32_16x16x32_bf16 v[72:75], a[100:103], v[36:39], v[72:75]
    ds_read_b128 v[148:151], v6 offset:32768
    ds_read_b128 v[152:155], v6 offset:33792
    v_mfma_f32_16x16x32_bf16 v[72:75], a[104:107], v[40:43], v[72:75]
    ds_read_b128 v[156:159], v6 offset:34816
    ds_read_b128 v[160:163], v6 offset:35840
    v_mfma_f32_16x16x32_bf16 v[72:75], a[108:111], v[44:47], v[72:75]
    s_waitcnt lgkmcnt(10)
    buffer_load_dwordx4 v9, s[8:11], s29 offen lds
    v_mfma_f32_16x16x32_bf16 v[180:183], a[160:163], v[116:119], v[180:183]
    v_exp_f32 v67, v67
    v_mfma_f32_16x16x32_bf16 v[180:183], a[168:171], v[120:123], v[180:183]
    v_perm_b32 v92, v65, v64, s35
    v_perm_b32 v93, v67, v66, s35
    v_mfma_f32_16x16x32_bf16 v[180:183], a[176:179], v[124:127], v[180:183]
    v_exp_f32 v68, v68
    v_mfma_f32_16x16x32_bf16 v[180:183], a[184:187], v[128:131], v[180:183]
    s_waitcnt lgkmcnt(4)
    v_exp_f32 v69, v69
    v_mfma_f32_16x16x32_bf16 v[180:183], a[192:195], v[132:135], v[180:183]
    v_mfma_f32_16x16x32_bf16 v[180:183], a[200:203], v[136:139], v[180:183]
    v_exp_f32 v70, v70
    v_mfma_f32_16x16x32_bf16 v[180:183], a[208:211], v[140:143], v[180:183]
    v_exp_f32 v71, v71
    v_mfma_f32_16x16x32_bf16 v[180:183], a[216:219], v[144:147], v[180:183]
    s_waitcnt lgkmcnt(0)
    v_perm_b32 v94, v69, v68, s35
    v_perm_b32 v95, v71, v70, s35
    v_mfma_f32_16x16x32_bf16 v[180:183], a[224:227], v[148:151], v[180:183]
    v_exp_f32 v72, v72
    v_mfma_f32_16x16x32_bf16 v[180:183], a[232:235], v[152:155], v[180:183]
    v_exp_f32 v73, v73
    v_mfma_f32_16x16x32_bf16 v[180:183], a[240:243], v[156:159], v[180:183]
    v_exp_f32 v74, v74
    v_mfma_f32_16x16x32_bf16 v[180:183], a[248:251], v[160:163], v[180:183]
    ds_write_b128 v3, v[92:95] offset:2048
    v_mfma_f32_16x16x32_bf16 v[76:79], a[112:115], v[32:35], 0
    v_exp_f32 v75, v75
    v_mfma_f32_16x16x32_bf16 v[76:79], a[116:119], v[36:39], v[76:79]
    v_perm_b32 v96, v73, v72, s35
    v_perm_b32 v97, v75, v74, s35
    v_mfma_f32_16x16x32_bf16 v[76:79], a[120:123], v[40:43], v[76:79]
    v_mul_f32 v167, v167, v19
    v_mul_f32 v168, v168, v19
    v_mfma_f32_16x16x32_bf16 v[76:79], a[124:127], v[44:47], v[76:79]
    v_mul_f32 v169, v169, v19
    v_mul_f32 v170, v170, v19
    v_mfma_f32_16x16x32_bf16 v[64:67], a[0:3], v[48:51], 0
    v_mul_f32 v171, v171, v19
    v_cvt_pk_bf16_f32 v208, v164, v165
    v_mfma_f32_16x16x32_bf16 v[64:67], a[4:7], v[52:55], v[64:67]
    v_cvt_pk_bf16_f32 v209, v166, v167
    v_cvt_pk_bf16_f32 v210, v168, v169
    v_mfma_f32_16x16x32_bf16 v[64:67], a[8:11], v[56:59], v[64:67]
    v_exp_f32 v76, v76
    v_mfma_f32_16x16x32_bf16 v[64:67], a[12:15], v[60:63], v[64:67]
    v_exp_f32 v77, v77
    v_mfma_f32_16x16x32_bf16 v[68:71], a[28:31], v[60:63], 0
    v_exp_f32 v78, v78
    v_mfma_f32_16x16x32_bf16 v[68:71], a[24:27], v[56:59], v[68:71]
    v_exp_f32 v79, v79
    v_mfma_f32_16x16x32_bf16 v[68:71], a[20:23], v[52:55], v[68:71]
    v_perm_b32 v98, v77, v76, s35
    v_perm_b32 v99, v79, v78, s35
    v_mfma_f32_16x16x32_bf16 v[68:71], a[16:19], v[48:51], v[68:71]
    ds_write_b128 v3, v[96:99] offset:3072
    v_mfma_f32_16x16x32_bf16 v[184:187], a[164:167], v[116:119], v[184:187]
    v_exp_f32 v64, v64
    v_mfma_f32_16x16x32_bf16 v[184:187], a[172:175], v[120:123], v[184:187]
    v_exp_f32 v65, v65
    v_mfma_f32_16x16x32_bf16 v[184:187], a[180:183], v[124:127], v[184:187]
    v_exp_f32 v66, v66
    v_mfma_f32_16x16x32_bf16 v[184:187], a[188:191], v[128:131], v[184:187]
    v_exp_f32 v67, v67
    v_mfma_f32_16x16x32_bf16 v[184:187], a[196:199], v[132:135], v[184:187]
    v_perm_b32 v100, v65, v64, s35
    v_perm_b32 v101, v67, v66, s35
    v_mfma_f32_16x16x32_bf16 v[184:187], a[204:207], v[136:139], v[184:187]
    ds_read_b128 v[116:119], v4 offset:36864
    ds_read_b128 v[120:123], v4 offset:37888
    v_mfma_f32_16x16x32_bf16 v[184:187], a[212:215], v[140:143], v[184:187]
    ds_read_b128 v[124:127], v4 offset:38912
    ds_read_b128 v[128:131], v4 offset:39936
    v_mfma_f32_16x16x32_bf16 v[184:187], a[220:223], v[144:147], v[184:187]
    ds_read_b128 v[132:135], v5 offset:36864
    ds_read_b128 v[136:139], v5 offset:37888
    v_mfma_f32_16x16x32_bf16 v[184:187], a[228:231], v[148:151], v[184:187]
    ds_read_b128 v[140:143], v5 offset:38912
    ds_read_b128 v[144:147], v5 offset:39936
    v_mfma_f32_16x16x32_bf16 v[184:187], a[236:239], v[152:155], v[184:187]
    v_exp_f32 v68, v68
    v_mfma_f32_16x16x32_bf16 v[184:187], a[244:247], v[156:159], v[184:187]
    v_exp_f32 v69, v69
    v_mfma_f32_16x16x32_bf16 v[184:187], a[252:255], v[160:163], v[184:187]
    v_exp_f32 v70, v70
    v_smfmac_f32_16x16x64_bf16 v[196:199], v[24:27], v[92:99], v23
    v_cvt_pk_bf16_f32 v211, v170, v171
    v_mfma_f32_16x16x32_bf16 v[72:75], a[32:35], v[48:51], 0
    v_exp_f32 v71, v71
    v_mfma_f32_16x16x32_bf16 v[72:75], a[36:39], v[52:55], v[72:75]
    v_perm_b32 v102, v69, v68, s35
    v_perm_b32 v103, v71, v70, s35
    v_mfma_f32_16x16x32_bf16 v[72:75], a[40:43], v[56:59], v[72:75]
    ds_read_b128 v[148:151], v6 offset:36864
    ds_read_b128 v[152:155], v6 offset:37888
    v_mfma_f32_16x16x32_bf16 v[72:75], a[44:47], v[60:63], v[72:75]
    ds_write_b128 v3, v[100:103] offset:4096
    v_mfma_f32_16x16x32_bf16 v[76:79], a[60:63], v[60:63], 0
    ds_read_b128 v[156:159], v6 offset:38912
    ds_read_b128 v[160:163], v6 offset:39936
    v_mfma_f32_16x16x32_bf16 v[76:79], a[56:59], v[56:59], v[76:79]
    v_mul_f32 v172, v172, v20
    v_mul_f32 v173, v173, v20
    v_mfma_f32_16x16x32_bf16 v[76:79], a[52:55], v[52:55], v[76:79]
    v_exp_f32 v72, v72
    v_mfma_f32_16x16x32_bf16 v[76:79], a[48:51], v[48:51], v[76:79]
    v_exp_f32 v73, v73
    v_mfma_f32_16x16x32_bf16 v[64:67], a[64:67], v[48:51], 0
    v_exp_f32 v74, v74
    v_mfma_f32_16x16x32_bf16 v[64:67], a[68:71], v[52:55], v[64:67]
    v_exp_f32 v75, v75
    v_mfma_f32_16x16x32_bf16 v[64:67], a[72:75], v[56:59], v[64:67]
    v_perm_b32 v104, v73, v72, s35
    v_perm_b32 v105, v75, v74, s35
    v_mfma_f32_16x16x32_bf16 v[64:67], a[76:79], v[60:63], v[64:67]
    s_waitcnt lgkmcnt(9)
    buffer_store_dwordx4 v[208:211], v10, s[20:23], s31 offen sc1 nt
    v_mfma_f32_16x16x32_bf16 v[188:191], a[160:163], v[116:119], v[188:191]
    v_exp_f32 v76, v76
    v_mfma_f32_16x16x32_bf16 v[188:191], a[168:171], v[120:123], v[188:191]
    v_exp_f32 v77, v77
    v_mfma_f32_16x16x32_bf16 v[188:191], a[176:179], v[124:127], v[188:191]
    v_exp_f32 v78, v78
    v_mfma_f32_16x16x32_bf16 v[188:191], a[184:187], v[128:131], v[188:191]
    s_waitcnt lgkmcnt(5)
    v_exp_f32 v79, v79
    v_mfma_f32_16x16x32_bf16 v[188:191], a[192:195], v[132:135], v[188:191]
    v_perm_b32 v106, v77, v76, s35
    v_perm_b32 v107, v79, v78, s35
    v_mfma_f32_16x16x32_bf16 v[188:191], a[200:203], v[136:139], v[188:191]
    v_exp_f32 v64, v64
    v_mfma_f32_16x16x32_bf16 v[188:191], a[208:211], v[140:143], v[188:191]
    v_exp_f32 v65, v65
    v_mfma_f32_16x16x32_bf16 v[188:191], a[216:219], v[144:147], v[188:191]
    s_waitcnt lgkmcnt(0)
    v_exp_f32 v66, v66
    v_mfma_f32_16x16x32_bf16 v[188:191], a[224:227], v[148:151], v[188:191]
    v_exp_f32 v67, v67
    v_mfma_f32_16x16x32_bf16 v[188:191], a[232:235], v[152:155], v[188:191]
    v_perm_b32 v108, v65, v64, s35
    v_perm_b32 v109, v67, v66, s35
    v_mfma_f32_16x16x32_bf16 v[188:191], a[240:243], v[156:159], v[188:191]
    v_mul_f32 v174, v174, v20
    v_mul_f32 v175, v175, v20
    v_mfma_f32_16x16x32_bf16 v[188:191], a[248:251], v[160:163], v[188:191]
    ds_write_b128 v3, v[104:107] offset:5120
    v_mfma_f32_16x16x32_bf16 v[68:71], a[80:83], v[48:51], 0
    ds_read_b128 v[200:203], v8 offset:29184
    v_mul_f32 v176, v176, v20
    v_mfma_f32_16x16x32_bf16 v[68:71], a[84:87], v[52:55], v[68:71]
    v_mul_f32 v177, v177, v20
    v_mul_f32 v178, v178, v20
    v_mfma_f32_16x16x32_bf16 v[68:71], a[88:91], v[56:59], v[68:71]
    v_mul_f32 v179, v179, v20
    v_cvt_pk_bf16_f32 v212, v172, v173
    v_mfma_f32_16x16x32_bf16 v[68:71], a[92:95], v[60:63], v[68:71]
    v_cvt_pk_bf16_f32 v213, v174, v175
    v_smfmac_f32_16x16x64_bf16 v[196:199], v[28:31], v[100:107], v23
    v_mfma_f32_16x16x32_bf16 v[72:75], a[108:111], v[60:63], 0
    v_cvt_pk_bf16_f32 v214, v176, v177
    v_cvt_pk_bf16_f32 v215, v178, v179
    v_mfma_f32_16x16x32_bf16 v[72:75], a[104:107], v[56:59], v[72:75]
    ds_read_b128 v[32:35], v2 offset:8192
    ds_read_b128 v[36:39], v2 offset:8704
    v_mfma_f32_16x16x32_bf16 v[72:75], a[100:103], v[52:55], v[72:75]
    v_exp_f32 v68, v68
    v_mfma_f32_16x16x32_bf16 v[72:75], a[96:99], v[48:51], v[72:75]
    v_exp_f32 v69, v69
    v_mfma_f32_16x16x32_bf16 v[76:79], a[112:115], v[48:51], 0
    s_sub_u32 s33, s33, 1
    v_exp_f32 v70, v70
    v_mfma_f32_16x16x32_bf16 v[76:79], a[116:119], v[52:55], v[76:79]
    v_exp_f32 v71, v71
    v_mfma_f32_16x16x32_bf16 v[76:79], a[120:123], v[56:59], v[76:79]
    v_perm_b32 v110, v69, v68, s35
    v_perm_b32 v111, v71, v70, s35
    v_mfma_f32_16x16x32_bf16 v[76:79], a[124:127], v[60:63], v[76:79]
    ds_write_b128 v3, v[108:111] offset:6144
    v_mfma_f32_16x16x32_bf16 v[192:195], a[164:167], v[116:119], v[192:195]
    ds_read_b128 v[40:43], v2 offset:10240
    ds_read_b128 v[44:47], v2 offset:10752
    v_mfma_f32_16x16x32_bf16 v[192:195], a[172:175], v[120:123], v[192:195]
    v_exp_f32 v72, v72
    v_mfma_f32_16x16x32_bf16 v[192:195], a[180:183], v[124:127], v[192:195]
    v_exp_f32 v73, v73
    v_mfma_f32_16x16x32_bf16 v[192:195], a[188:191], v[128:131], v[192:195]
    v_exp_f32 v74, v74
    v_mfma_f32_16x16x32_bf16 v[192:195], a[196:199], v[132:135], v[192:195]
    v_exp_f32 v75, v75
    v_mfma_f32_16x16x32_bf16 v[192:195], a[204:207], v[136:139], v[192:195]
    v_perm_b32 v112, v73, v72, s35
    v_perm_b32 v113, v75, v74, s35
    v_mfma_f32_16x16x32_bf16 v[192:195], a[212:215], v[140:143], v[192:195]
    v_exp_f32 v76, v76
    v_mfma_f32_16x16x32_bf16 v[192:195], a[220:223], v[144:147], v[192:195]
    v_exp_f32 v77, v77
    v_mfma_f32_16x16x32_bf16 v[192:195], a[228:231], v[148:151], v[192:195]
    buffer_load_dwordx4 v9, s[8:11], s29 offen offset:1024 lds
    v_mfma_f32_16x16x32_bf16 v[192:195], a[236:239], v[152:155], v[192:195]
    ds_read_b128 v[48:51], v2 offset:12288
    ds_read_b128 v[52:55], v2 offset:12800
    v_mfma_f32_16x16x32_bf16 v[192:195], a[244:247], v[156:159], v[192:195]
    ds_read_b128 v[56:59], v2 offset:14336
    ds_read_b128 v[60:63], v2 offset:14848
    v_mfma_f32_16x16x32_bf16 v[192:195], a[252:255], v[160:163], v[192:195]
    s_waitcnt lgkmcnt(4)
    buffer_store_dwordx4 v[212:215], v10, s[20:23], s32 offen sc1 nt
    s_cbranch_scc0 L_loopB0
L_tailB:
    v_mfma_f32_16x16x32_bf16 v[64:67], a[0:3], v[32:35], 0
    v_exp_f32 v78, v78
    v_mfma_f32_16x16x32_bf16 v[64:67], a[4:7], v[36:39], v[64:67]
    v_exp_f32 v79, v79
    v_mfma_f32_16x16x32_bf16 v[64:67], a[8:11], v[40:43], v[64:67]
    v_perm_b32 v114, v77, v76, s35
    v_perm_b32 v115, v79, v78, s35
    v_mfma_f32_16x16x32_bf16 v[64:67], a[12:15], v[44:47], v[64:67]
    v_add_f32 v200, v200, v201
    v_add_f32 v202, v202, v203
    v_smfmac_f32_16x16x64_bf16 v[196:199], v[28:31], v[108:115], v23
    v_add_f32 v17, v200, v202
    v_mfma_f32_16x16x32_bf16 v[68:71], a[28:31], v[44:47], 0
    v_rcp_f32 v19, v17
    v_mfma_f32_16x16x32_bf16 v[68:71], a[24:27], v[40:43], v[68:71]
    v_max3_u32 v11, v11, v17, v19
    v_mov_b32 v20, v19
    v_mfma_f32_16x16x32_bf16 v[68:71], a[20:23], v[36:39], v[68:71]
    v_add_f32 v198, v196, v197
    v_mov_b64 v[196:197], 0
    v_mfma_f32_16x16x32_bf16 v[68:71], a[16:19], v[32:35], v[68:71]
    ds_write_b128 v3, v[112:115] offset:7168
    v_mfma_f32_16x16x32_bf16 v[164:167], a[128:131], v[80:83], 0
    ds_write_b32 v7, v198 offset:28672
    v_mfma_f32_16x16x32_bf16 v[164:167], a[136:139], v[84:87], v[164:167]
    v_exp_f32 v64, v64
    v_mfma_f32_16x16x32_bf16 v[164:167], a[144:147], v[92:95], v[164:167]
    v_exp_f32 v65, v65
    v_mfma_f32_16x16x32_bf16 v[164:167], a[152:155], v[96:99], v[164:167]
    v_exp_f32 v66, v66
    v_mfma_f32_16x16x32_bf16 v[168:171], a[156:159], v[96:99], 0
    v_exp_f32 v67, v67
    v_mfma_f32_16x16x32_bf16 v[168:171], a[148:151], v[92:95], v[168:171]
    v_perm_b32 v88, v65, v64, s35
    v_perm_b32 v89, v67, v66, s35
    v_mfma_f32_16x16x32_bf16 v[168:171], a[140:143], v[84:87], v[168:171]
    v_exp_f32 v68, v68
    v_mfma_f32_16x16x32_bf16 v[168:171], a[132:135], v[80:83], v[168:171]
    v_exp_f32 v69, v69
    v_mfma_f32_16x16x32_bf16 v[72:75], a[32:35], v[32:35], 0
    v_exp_f32 v70, v70
    v_mfma_f32_16x16x32_bf16 v[72:75], a[36:39], v[36:39], v[72:75]
    v_exp_f32 v71, v71
    v_mfma_f32_16x16x32_bf16 v[72:75], a[40:43], v[40:43], v[72:75]
    s_waitcnt lgkmcnt(0)
    v_perm_b32 v90, v69, v68, s35
    v_perm_b32 v91, v71, v70, s35
    v_mfma_f32_16x16x32_bf16 v[72:75], a[44:47], v[44:47], v[72:75]
    s_barrier
    v_mfma_f32_16x16x32_bf16 v[76:79], a[60:63], v[44:47], 0
    v_permlane32_swap_b32 v19, v20
    v_mfma_f32_16x16x32_bf16 v[76:79], a[56:59], v[40:43], v[76:79]
    ds_read_b128 v[116:119], v4 offset:0
    ds_read_b128 v[120:123], v4 offset:1024
    v_mfma_f32_16x16x32_bf16 v[76:79], a[52:55], v[36:39], v[76:79]
    ds_read_b128 v[124:127], v4 offset:2048
    ds_read_b128 v[128:131], v4 offset:3072
    v_mfma_f32_16x16x32_bf16 v[76:79], a[48:51], v[32:35], v[76:79]
    ds_write_b128 v3, v[88:91] offset:32768
    v_mfma_f32_16x16x32_bf16 v[172:175], a[128:131], v[100:103], 0
    v_exp_f32 v72, v72
    v_mfma_f32_16x16x32_bf16 v[172:175], a[136:139], v[104:107], v[172:175]
    v_exp_f32 v73, v73
    v_mfma_f32_16x16x32_bf16 v[172:175], a[144:147], v[108:111], v[172:175]
    v_exp_f32 v74, v74
    v_mfma_f32_16x16x32_bf16 v[172:175], a[152:155], v[112:115], v[172:175]
    v_exp_f32 v75, v75
    v_mfma_f32_16x16x32_bf16 v[176:179], a[156:159], v[112:115], 0
    v_perm_b32 v84, v73, v72, s35
    v_perm_b32 v85, v75, v74, s35
    v_mfma_f32_16x16x32_bf16 v[176:179], a[148:151], v[108:111], v[176:179]
    s_add_u32 s31, s31, 0x2000
    ds_read_b128 v[132:135], v5 offset:0
    ds_read_b128 v[136:139], v5 offset:1024
    v_mfma_f32_16x16x32_bf16 v[176:179], a[140:143], v[104:107], v[176:179]
    v_exp_f32 v76, v76
    v_mfma_f32_16x16x32_bf16 v[176:179], a[132:135], v[100:103], v[176:179]
    v_exp_f32 v77, v77
    v_mfma_f32_16x16x32_bf16 v[64:67], a[64:67], v[32:35], 0
    v_exp_f32 v78, v78
    v_mfma_f32_16x16x32_bf16 v[64:67], a[68:71], v[36:39], v[64:67]
    s_add_u32 s32, s32, 0x2000
    v_exp_f32 v79, v79
    v_mfma_f32_16x16x32_bf16 v[64:67], a[72:75], v[40:43], v[64:67]
    v_perm_b32 v86, v77, v76, s35
    v_perm_b32 v87, v79, v78, s35
    v_mfma_f32_16x16x32_bf16 v[64:67], a[76:79], v[44:47], v[64:67]
    ds_write_b128 v3, v[84:87] offset:33792
    v_mfma_f32_16x16x32_bf16 v[68:71], a[92:95], v[44:47], 0
    ds_read_b128 v[140:143], v5 offset:2048
    ds_read_b128 v[144:147], v5 offset:3072
    v_mfma_f32_16x16x32_bf16 v[68:71], a[88:91], v[40:43], v[68:71]
    v_mul_f32 v180, v180, v19
    v_mul_f32 v181, v181, v19
    v_mfma_f32_16x16x32_bf16 v[68:71], a[84:87], v[36:39], v[68:71]
    v_exp_f32 v64, v64
    v_mfma_f32_16x16x32_bf16 v[68:71], a[80:83], v[32:35], v[68:71]
    v_exp_f32 v65, v65
    v_smfmac_f32_16x16x64_bf16 v[196:199], v[24:27], v[84:91], v23
    v_mul_f32 v182, v182, v19
    v_mfma_f32_16x16x32_bf16 v[72:75], a[96:99], v[32:35], 0
    v_exp_f32 v66, v66
    v_mfma_f32_16x16x32_bf16 v[72:75], a[100:103], v[36:39], v[72:75]
    ds_read_b128 v[148:151], v6 offset:0
    ds_read_b128 v[152:155], v6 offset:1024
    v_mfma_f32_16x16x32_bf16 v[72:75], a[104:107], v[40:43], v[72:75]
    ds_read_b128 v[156:159], v6 offset:2048
    ds_read_b128 v[160:163], v6 offset:3072
    v_mfma_f32_16x16x32_bf16 v[72:75], a[108:111], v[44:47], v[72:75]
L_s12:
    s_cbranch_execz L_ce4B
L_s12_n:
    s_waitcnt lgkmcnt(10)
    v_mfma_f32_16x16x32_bf16 v[164:167], a[160:163], v[116:119], v[164:167]
    v_exp_f32 v67, v67
    v_mfma_f32_16x16x32_bf16 v[164:167], a[168:171], v[120:123], v[164:167]
    v_perm_b32 v92, v65, v64, s35
    v_perm_b32 v93, v67, v66, s35
    v_mfma_f32_16x16x32_bf16 v[164:167], a[176:179], v[124:127], v[164:167]
    v_exp_f32 v68, v68
    v_mfma_f32_16x16x32_bf16 v[164:167], a[184:187], v[128:131], v[164:167]
    s_waitcnt lgkmcnt(4)
    v_exp_f32 v69, v69
    v_mfma_f32_16x16x32_bf16 v[164:167], a[192:195], v[132:135], v[164:167]
    v_mfma_f32_16x16x32_bf16 v[164:167], a[200:203], v[136:139], v[164:167]
    v_exp_f32 v70, v70
    v_mfma_f32_16x16x32_bf16 v[164:167], a[208:211], v[140:143], v[164:167]
    v_exp_f32 v71, v71
    v_mfma_f32_16x16x32_bf16 v[164:167], a[216:219], v[144:147], v[164:167]
    s_waitcnt lgkmcnt(0)
    v_perm_b32 v94, v69, v68, s35
    v_perm_b32 v95, v71, v70, s35
    v_mfma_f32_16x16x32_bf16 v[164:167], a[224:227], v[148:151], v[164:167]
    v_exp_f32 v72, v72
    v_mfma_f32_16x16x32_bf16 v[164:167], a[232:235], v[152:155], v[164:167]
    v_exp_f32 v73, v73
    v_mfma_f32_16x16x32_bf16 v[164:167], a[240:243], v[156:159], v[164:167]
    v_exp_f32 v74, v74
    v_mfma_f32_16x16x32_bf16 v[164:167], a[248:251], v[160:163], v[164:167]
    ds_write_b128 v3, v[92:95] offset:34816
    v_mfma_f32_16x16x32_bf16 v[76:79], a[112:115], v[32:35], 0
    v_exp_f32 v75, v75
    v_mfma_f32_16x16x32_bf16 v[76:79], a[116:119], v[36:39], v[76:79]
    v_perm_b32 v96, v73, v72, s35
    v_perm_b32 v97, v75, v74, s35
    v_mfma_f32_16x16x32_bf16 v[76:79], a[120:123], v[40:43], v[76:79]
    v_mul_f32 v183, v183, v19
    v_mul_f32 v184, v184, v19
    v_mfma_f32_16x16x32_bf16 v[76:79], a[124:127], v[44:47], v[76:79]
    v_mul_f32 v185, v185, v19
    v_mul_f32 v186, v186, v19
    v_mfma_f32_16x16x32_bf16 v[64:67], a[0:3], v[48:51], 0
    v_mul_f32 v187, v187, v19
    v_cvt_pk_bf16_f32 v208, v180, v181
    v_mfma_f32_16x16x32_bf16 v[64:67], a[4:7], v[52:55], v[64:67]
    v_cvt_pk_bf16_f32 v209, v182, v183
    v_cvt_pk_bf16_f32 v210, v184, v185
    v_mfma_f32_16x16x32_bf16 v[64:67], a[8:11], v[56:59], v[64:67]
    v_exp_f32 v76, v76
    v_mfma_f32_16x16x32_bf16 v[64:67], a[12:15], v[60:63], v[64:67]
    v_exp_f32 v77, v77
    v_mfma_f32_16x16x32_bf16 v[68:71], a[28:31], v[60:63], 0
    v_exp_f32 v78, v78
    v_mfma_f32_16x16x32_bf16 v[68:71], a[24:27], v[56:59], v[68:71]
    v_exp_f32 v79, v79
    v_mfma_f32_16x16x32_bf16 v[68:71], a[20:23], v[52:55], v[68:71]
    v_perm_b32 v98, v77, v76, s35
    v_perm_b32 v99, v79, v78, s35
    v_mfma_f32_16x16x32_bf16 v[68:71], a[16:19], v[48:51], v[68:71]
    ds_write_b128 v3, v[96:99] offset:35840
    v_mfma_f32_16x16x32_bf16 v[168:171], a[164:167], v[116:119], v[168:171]
    v_exp_f32 v64, v64
    v_mfma_f32_16x16x32_bf16 v[168:171], a[172:175], v[120:123], v[168:171]
    v_exp_f32 v65, v65
    v_mfma_f32_16x16x32_bf16 v[168:171], a[180:183], v[124:127], v[168:171]
    v_exp_f32 v66, v66
    v_mfma_f32_16x16x32_bf16 v[168:171], a[188:191], v[128:131], v[168:171]
    v_exp_f32 v67, v67
    v_mfma_f32_16x16x32_bf16 v[168:171], a[196:199], v[132:135], v[168:171]
    v_perm_b32 v100, v65, v64, s35
    v_perm_b32 v101, v67, v66, s35
    v_mfma_f32_16x16x32_bf16 v[168:171], a[204:207], v[136:139], v[168:171]
    ds_read_b128 v[116:119], v4 offset:4096
    ds_read_b128 v[120:123], v4 offset:5120
    v_mfma_f32_16x16x32_bf16 v[168:171], a[212:215], v[140:143], v[168:171]
    ds_read_b128 v[124:127], v4 offset:6144
    ds_read_b128 v[128:131], v4 offset:7168
    v_mfma_f32_16x16x32_bf16 v[168:171], a[220:223], v[144:147], v[168:171]
    ds_read_b128 v[132:135], v5 offset:4096
    ds_read_b128 v[136:139], v5 offset:5120
    v_mfma_f32_16x16x32_bf16 v[168:171], a[228:231], v[148:151], v[168:171]
    ds_read_b128 v[140:143], v5 offset:6144
    ds_read_b128 v[144:147], v5 offset:7168
    v_mfma_f32_16x16x32_bf16 v[168:171], a[236:239], v[152:155], v[168:171]
    v_exp_f32 v68, v68
    v_mfma_f32_16x16x32_bf16 v[168:171], a[244:247], v[156:159], v[168:171]
    v_exp_f32 v69, v69
    v_mfma_f32_16x16x32_bf16 v[168:171], a[252:255], v[160:163], v[168:171]
    v_exp_f32 v70, v70
    v_smfmac_f32_16x16x64_bf16 v[196:199], v[24:27], v[92:99], v23
    v_cvt_pk_bf16_f32 v211, v186, v187
    v_mfma_f32_16x16x32_bf16 v[72:75], a[32:35], v[48:51], 0
    v_exp_f32 v71, v71
    v_mfma_f32_16x16x32_bf16 v[72:75], a[36:39], v[52:55], v[72:75]
    v_perm_b32 v102, v69, v68, s35
    v_perm_b32 v103, v71, v70, s35
    v_mfma_f32_16x16x32_bf16 v[72:75], a[40:43], v[56:59], v[72:75]
    ds_read_b128 v[148:151], v6 offset:4096
    ds_read_b128 v[152:155], v6 offset:5120
    v_mfma_f32_16x16x32_bf16 v[72:75], a[44:47], v[60:63], v[72:75]
    ds_write_b128 v3, v[100:103] offset:36864
    v_mfma_f32_16x16x32_bf16 v[76:79], a[60:63], v[60:63], 0
    ds_read_b128 v[156:159], v6 offset:6144
    ds_read_b128 v[160:163], v6 offset:7168
    v_mfma_f32_16x16x32_bf16 v[76:79], a[56:59], v[56:59], v[76:79]
    v_mul_f32 v188, v188, v20
    v_mul_f32 v189, v189, v20
    v_mfma_f32_16x16x32_bf16 v[76:79], a[52:55], v[52:55], v[76:79]
    v_exp_f32 v72, v72
    v_mfma_f32_16x16x32_bf16 v[76:79], a[48:51], v[48:51], v[76:79]
    v_exp_f32 v73, v73
    v_mfma_f32_16x16x32_bf16 v[64:67], a[64:67], v[48:51], 0
    v_exp_f32 v74, v74
    v_mfma_f32_16x16x32_bf16 v[64:67], a[68:71], v[52:55], v[64:67]
    v_exp_f32 v75, v75
    v_mfma_f32_16x16x32_bf16 v[64:67], a[72:75], v[56:59], v[64:67]
    v_perm_b32 v104, v73, v72, s35
    v_perm_b32 v105, v75, v74, s35
    v_mfma_f32_16x16x32_bf16 v[64:67], a[76:79], v[60:63], v[64:67]
    s_waitcnt lgkmcnt(9)
    buffer_store_dwordx4 v[208:211], v10, s[20:23], s31 offen sc1 nt
    v_mfma_f32_16x16x32_bf16 v[172:175], a[160:163], v[116:119], v[172:175]
    v_exp_f32 v76, v76
    v_mfma_f32_16x16x32_bf16 v[172:175], a[168:171], v[120:123], v[172:175]
    v_exp_f32 v77, v77
    v_mfma_f32_16x16x32_bf16 v[172:175], a[176:179], v[124:127], v[172:175]
    v_exp_f32 v78, v78
    v_mfma_f32_16x16x32_bf16 v[172:175], a[184:187], v[128:131], v[172:175]
    s_waitcnt lgkmcnt(5)
    v_exp_f32 v79, v79
    v_mfma_f32_16x16x32_bf16 v[172:175], a[192:195], v[132:135], v[172:175]
    v_perm_b32 v106, v77, v76, s35
    v_perm_b32 v107, v79, v78, s35
    v_mfma_f32_16x16x32_bf16 v[172:175], a[200:203], v[136:139], v[172:175]
    v_exp_f32 v64, v64
    v_mfma_f32_16x16x32_bf16 v[172:175], a[208:211], v[140:143], v[172:175]
    v_exp_f32 v65, v65
    v_mfma_f32_16x16x32_bf16 v[172:175], a[216:219], v[144:147], v[172:175]
    s_waitcnt lgkmcnt(0)
    v_exp_f32 v66, v66
    v_mfma_f32_16x16x32_bf16 v[172:175], a[224:227], v[148:151], v[172:175]
    v_exp_f32 v67, v67
    v_mfma_f32_16x16x32_bf16 v[172:175], a[232:235], v[152:155], v[172:175]
    v_perm_b32 v108, v65, v64, s35
    v_perm_b32 v109, v67, v66, s35
    v_mfma_f32_16x16x32_bf16 v[172:175], a[240:243], v[156:159], v[172:175]
    v_mul_f32 v190, v190, v20
    v_mul_f32 v191, v191, v20
    v_mfma_f32_16x16x32_bf16 v[172:175], a[248:251], v[160:163], v[172:175]
    ds_write_b128 v3, v[104:107] offset:37888
    v_mfma_f32_16x16x32_bf16 v[68:71], a[80:83], v[48:51], 0
    ds_read_b128 v[200:203], v8 offset:28672
    v_mul_f32 v192, v192, v20
    v_mfma_f32_16x16x32_bf16 v[68:71], a[84:87], v[52:55], v[68:71]
    v_mul_f32 v193, v193, v20
    v_mul_f32 v194, v194, v20
    v_mfma_f32_16x16x32_bf16 v[68:71], a[88:91], v[56:59], v[68:71]
    v_mul_f32 v195, v195, v20
    v_cvt_pk_bf16_f32 v212, v188, v189
    v_mfma_f32_16x16x32_bf16 v[68:71], a[92:95], v[60:63], v[68:71]
    v_cvt_pk_bf16_f32 v213, v190, v191
    v_smfmac_f32_16x16x64_bf16 v[196:199], v[28:31], v[100:107], v23
    v_mfma_f32_16x16x32_bf16 v[72:75], a[108:111], v[60:63], 0
    v_cvt_pk_bf16_f32 v214, v192, v193
    v_cvt_pk_bf16_f32 v215, v194, v195
    v_mfma_f32_16x16x32_bf16 v[72:75], a[104:107], v[56:59], v[72:75]
    v_exp_f32 v68, v68
    v_mfma_f32_16x16x32_bf16 v[72:75], a[100:103], v[52:55], v[72:75]
    v_exp_f32 v69, v69
    v_mfma_f32_16x16x32_bf16 v[72:75], a[96:99], v[48:51], v[72:75]
    buffer_store_dwordx4 v[212:215], v10, s[20:23], s32 offen sc1 nt
    v_mfma_f32_16x16x32_bf16 v[76:79], a[112:115], v[48:51], 0
    v_exp_f32 v70, v70
    v_mfma_f32_16x16x32_bf16 v[76:79], a[116:119], v[52:55], v[76:79]
    v_exp_f32 v71, v71
    v_mfma_f32_16x16x32_bf16 v[76:79], a[120:123], v[56:59], v[76:79]
    v_perm_b32 v110, v69, v68, s35
    v_perm_b32 v111, v71, v70, s35
    v_mfma_f32_16x16x32_bf16 v[76:79], a[124:127], v[60:63], v[76:79]
    ds_write_b128 v3, v[108:111] offset:38912
    v_mfma_f32_16x16x32_bf16 v[176:179], a[164:167], v[116:119], v[176:179]
    v_mfma_f32_16x16x32_bf16 v[176:179], a[172:175], v[120:123], v[176:179]
    v_exp_f32 v72, v72
    v_mfma_f32_16x16x32_bf16 v[176:179], a[180:183], v[124:127], v[176:179]
    v_exp_f32 v73, v73
    v_mfma_f32_16x16x32_bf16 v[176:179], a[188:191], v[128:131], v[176:179]
    v_exp_f32 v74, v74
    v_mfma_f32_16x16x32_bf16 v[176:179], a[196:199], v[132:135], v[176:179]
    v_exp_f32 v75, v75
    v_mfma_f32_16x16x32_bf16 v[176:179], a[204:207], v[136:139], v[176:179]
    v_perm_b32 v112, v73, v72, s35
    v_perm_b32 v113, v75, v74, s35
    v_mfma_f32_16x16x32_bf16 v[176:179], a[212:215], v[140:143], v[176:179]
    v_exp_f32 v76, v76
    v_mfma_f32_16x16x32_bf16 v[176:179], a[220:223], v[144:147], v[176:179]
    v_exp_f32 v77, v77
    v_mfma_f32_16x16x32_bf16 v[176:179], a[228:231], v[148:151], v[176:179]
    v_exp_f32 v78, v78
    v_mfma_f32_16x16x32_bf16 v[176:179], a[236:239], v[152:155], v[176:179]
    v_exp_f32 v79, v79
    v_mfma_f32_16x16x32_bf16 v[176:179], a[244:247], v[156:159], v[176:179]
    v_perm_b32 v114, v77, v76, s35
    v_perm_b32 v115, v79, v78, s35
    v_mfma_f32_16x16x32_bf16 v[176:179], a[252:255], v[160:163], v[176:179]
    ds_write_b128 v3, v[112:115] offset:39936
    v_smfmac_f32_16x16x64_bf16 v[196:199], v[28:31], v[108:115], v23
    s_waitcnt lgkmcnt(2)
    v_add_f32 v200, v200, v201
    v_mfma_f32_16x16x32_bf16 v[180:183], a[128:131], v[88:91], 0
    v_add_f32 v202, v202, v203
    v_add_f32 v17, v200, v202
    v_mfma_f32_16x16x32_bf16 v[180:183], a[136:139], v[84:87], v[180:183]
    v_rcp_f32 v19, v17
    v_mfma_f32_16x16x32_bf16 v[180:183], a[144:147], v[92:95], v[180:183]
    v_add_f32 v198, v196, v197
    v_max3_u32 v11, v11, v17, v19
    v_mfma_f32_16x16x32_bf16 v[180:183], a[152:155], v[96:99], v[180:183]
    ds_write_b32 v7, v198 offset:29184
    v_mfma_f32_16x16x32_bf16 v[184:187], a[156:159], v[96:99], 0
    v_mov_b32 v20, v19
    s_add_u32 s31, s31, 0x2000
    v_mfma_f32_16x16x32_bf16 v[184:187], a[148:151], v[92:95], v[184:187]
    v_permlane32_swap_b32 v19, v20
    v_mfma_f32_16x16x32_bf16 v[184:187], a[140:143], v[84:87], v[184:187]
    s_add_u32 s32, s32, 0x2000
    v_mul_f32 v164, v164, v19
    v_mfma_f32_16x16x32_bf16 v[184:187], a[132:135], v[88:91], v[184:187]
    s_waitcnt lgkmcnt(0)
    s_barrier
    v_mfma_f32_16x16x32_bf16 v[188:191], a[128:131], v[100:103], 0
    v_mul_f32 v165, v165, v19
    v_mul_f32 v166, v166, v19
    v_mfma_f32_16x16x32_bf16 v[188:191], a[136:139], v[104:107], v[188:191]
    v_mul_f32 v167, v167, v19
    v_cvt_pk_bf16_f32 v208, v164, v165
    v_mfma_f32_16x16x32_bf16 v[188:191], a[144:147], v[108:111], v[188:191]
    v_cvt_pk_bf16_f32 v209, v166, v167
    v_mul_f32 v168, v168, v19
    v_mfma_f32_16x16x32_bf16 v[188:191], a[152:155], v[112:115], v[188:191]
    ds_read_b128 v[116:119], v4 offset:32768
    v_mul_f32 v169, v169, v19
    v_mfma_f32_16x16x32_bf16 v[192:195], a[156:159], v[112:115], 0
    ds_read_b128 v[120:123], v4 offset:33792
    ds_read_b128 v[200:203], v8 offset:29184
    v_mfma_f32_16x16x32_bf16 v[192:195], a[148:151], v[108:111], v[192:195]
    ds_read_b128 v[124:127], v4 offset:34816
    v_mul_f32 v170, v170, v19
    v_mfma_f32_16x16x32_bf16 v[192:195], a[140:143], v[104:107], v[192:195]
    ds_read_b128 v[128:131], v4 offset:35840
    v_mul_f32 v171, v171, v19
    v_mfma_f32_16x16x32_bf16 v[192:195], a[132:135], v[100:103], v[192:195]
    s_waitcnt lgkmcnt(3)
    v_cvt_pk_bf16_f32 v210, v168, v169
    v_cvt_pk_bf16_f32 v211, v170, v171
    v_mfma_f32_16x16x32_bf16 v[180:183], a[160:163], v[116:119], v[180:183]
    v_mul_f32 v172, v172, v20
    v_mul_f32 v173, v173, v20
    v_mfma_f32_16x16x32_bf16 v[180:183], a[168:171], v[120:123], v[180:183]
    s_waitcnt lgkmcnt(0)
    v_mul_f32 v174, v174, v20
    v_mul_f32 v175, v175, v20
    v_mfma_f32_16x16x32_bf16 v[180:183], a[176:179], v[124:127], v[180:183]
    v_cvt_pk_bf16_f32 v212, v172, v173
    v_cvt_pk_bf16_f32 v213, v174, v175
    v_mfma_f32_16x16x32_bf16 v[180:183], a[184:187], v[128:131], v[180:183]
    ds_read_b128 v[132:135], v5 offset:32768
    buffer_store_dwordx4 v[208:211], v10, s[20:23], s31 offen sc1 nt
    v_mfma_f32_16x16x32_bf16 v[184:187], a[188:191], v[128:131], v[184:187]
    ds_read_b128 v[136:139], v5 offset:33792
    v_mul_f32 v176, v176, v20
    v_mfma_f32_16x16x32_bf16 v[184:187], a[180:183], v[124:127], v[184:187]
    ds_read_b128 v[140:143], v5 offset:34816
    v_mul_f32 v177, v177, v20
    v_mfma_f32_16x16x32_bf16 v[184:187], a[172:175], v[120:123], v[184:187]
    ds_read_b128 v[144:147], v5 offset:35840
    v_mul_f32 v178, v178, v20
    v_mfma_f32_16x16x32_bf16 v[184:187], a[164:167], v[116:119], v[184:187]
    s_waitcnt lgkmcnt(2)
    v_mul_f32 v179, v179, v20
    v_cvt_pk_bf16_f32 v214, v176, v177
    v_mfma_f32_16x16x32_bf16 v[184:187], a[196:199], v[132:135], v[184:187]
    v_cvt_pk_bf16_f32 v215, v178, v179
    v_add_f32 v200, v200, v201
    v_mfma_f32_16x16x32_bf16 v[184:187], a[204:207], v[136:139], v[184:187]
    s_waitcnt lgkmcnt(0)
    v_add_f32 v202, v202, v203
    v_add_f32 v17, v200, v202
    v_mfma_f32_16x16x32_bf16 v[184:187], a[212:215], v[140:143], v[184:187]
    v_rcp_f32 v19, v17
    v_mfma_f32_16x16x32_bf16 v[184:187], a[220:223], v[144:147], v[184:187]
    ds_read_b128 v[148:151], v6 offset:32768
    buffer_store_dwordx4 v[212:215], v10, s[20:23], s32 offen sc1 nt
    v_mfma_f32_16x16x32_bf16 v[180:183], a[216:219], v[144:147], v[180:183]
    ds_read_b128 v[152:155], v6 offset:33792
    v_max3_u32 v11, v11, v17, v19
    v_mfma_f32_16x16x32_bf16 v[180:183], a[208:211], v[140:143], v[180:183]
    ds_read_b128 v[156:159], v6 offset:34816
    v_mov_b32 v20, v19
    v_mfma_f32_16x16x32_bf16 v[180:183], a[200:203], v[136:139], v[180:183]
    ds_read_b128 v[160:163], v6 offset:35840
    s_add_u32 s31, s31, 0x2000
    v_mfma_f32_16x16x32_bf16 v[180:183], a[192:195], v[132:135], v[180:183]
    s_waitcnt lgkmcnt(2)
    v_permlane32_swap_b32 v19, v20
    v_mfma_f32_16x16x32_bf16 v[180:183], a[224:227], v[148:151], v[180:183]
    s_add_u32 s32, s32, 0x2000
    v_mfma_f32_16x16x32_bf16 v[180:183], a[232:235], v[152:155], v[180:183]
    s_waitcnt lgkmcnt(0)
    v_mfma_f32_16x16x32_bf16 v[180:183], a[240:243], v[156:159], v[180:183]
    v_mfma_f32_16x16x32_bf16 v[180:183], a[248:251], v[160:163], v[180:183]
    ds_read_b128 v[216:219], v4 offset:36864
    v_mfma_f32_16x16x32_bf16 v[184:187], a[252:255], v[160:163], v[184:187]
    ds_read_b128 v[220:223], v4 offset:37888
    v_mfma_f32_16x16x32_bf16 v[184:187], a[244:247], v[156:159], v[184:187]
    ds_read_b128 v[224:227], v4 offset:38912
    v_mfma_f32_16x16x32_bf16 v[184:187], a[236:239], v[152:155], v[184:187]
    ds_read_b128 v[228:231], v4 offset:39936
    v_mul_f32 v180, v180, v19
    v_mfma_f32_16x16x32_bf16 v[184:187], a[228:231], v[148:151], v[184:187]
    s_waitcnt lgkmcnt(2)
    v_mul_f32 v181, v181, v19
    v_mul_f32 v182, v182, v19
    v_mfma_f32_16x16x32_bf16 v[188:191], a[160:163], v[216:219], v[188:191]
    v_mul_f32 v183, v183, v19
    v_cvt_pk_bf16_f32 v248, v180, v181
    v_mfma_f32_16x16x32_bf16 v[188:191], a[168:171], v[220:223], v[188:191]
    s_waitcnt lgkmcnt(0)
    v_cvt_pk_bf16_f32 v249, v182, v183
    v_mfma_f32_16x16x32_bf16 v[188:191], a[176:179], v[224:227], v[188:191]
    v_mul_f32 v184, v184, v19
    v_mul_f32 v185, v185, v19
    v_mfma_f32_16x16x32_bf16 v[188:191], a[184:187], v[228:231], v[188:191]
    ds_read_b128 v[232:235], v5 offset:36864
    v_mul_f32 v186, v186, v19
    v_mfma_f32_16x16x32_bf16 v[192:195], a[188:191], v[228:231], v[192:195]
    ds_read_b128 v[236:239], v5 offset:37888
    v_mul_f32 v187, v187, v19
    v_mfma_f32_16x16x32_bf16 v[192:195], a[180:183], v[224:227], v[192:195]
    ds_read_b128 v[240:243], v5 offset:38912
    v_cvt_pk_bf16_f32 v250, v184, v185
    v_mfma_f32_16x16x32_bf16 v[192:195], a[172:175], v[220:223], v[192:195]
    ds_read_b128 v[244:247], v5 offset:39936
    v_cvt_pk_bf16_f32 v251, v186, v187
    v_mfma_f32_16x16x32_bf16 v[192:195], a[164:167], v[216:219], v[192:195]
    s_waitcnt lgkmcnt(2)
    v_mfma_f32_16x16x32_bf16 v[192:195], a[196:199], v[232:235], v[192:195]
    v_mfma_f32_16x16x32_bf16 v[192:195], a[204:207], v[236:239], v[192:195]
    s_waitcnt lgkmcnt(0)
    v_mfma_f32_16x16x32_bf16 v[192:195], a[212:215], v[240:243], v[192:195]
    v_mfma_f32_16x16x32_bf16 v[192:195], a[220:223], v[244:247], v[192:195]
    ds_read_b128 v[32:35], v6 offset:36864
    buffer_store_dwordx4 v[248:251], v10, s[20:23], s31 offen sc1 nt
    v_mfma_f32_16x16x32_bf16 v[188:191], a[216:219], v[244:247], v[188:191]
    ds_read_b128 v[36:39], v6 offset:37888
    v_mfma_f32_16x16x32_bf16 v[188:191], a[208:211], v[240:243], v[188:191]
    ds_read_b128 v[40:43], v6 offset:38912
    v_mfma_f32_16x16x32_bf16 v[188:191], a[200:203], v[236:239], v[188:191]
    ds_read_b128 v[44:47], v6 offset:39936
    v_mfma_f32_16x16x32_bf16 v[188:191], a[192:195], v[232:235], v[188:191]
    s_waitcnt lgkmcnt(2)
    v_mfma_f32_16x16x32_bf16 v[188:191], a[224:227], v[32:35], v[188:191]
    v_mfma_f32_16x16x32_bf16 v[188:191], a[232:235], v[36:39], v[188:191]
    s_waitcnt lgkmcnt(0)
    v_mfma_f32_16x16x32_bf16 v[188:191], a[240:243], v[40:43], v[188:191]
    v_mfma_f32_16x16x32_bf16 v[188:191], a[248:251], v[44:47], v[188:191]
    v_mfma_f32_16x16x32_bf16 v[192:195], a[252:255], v[44:47], v[192:195]
    v_mfma_f32_16x16x32_bf16 v[192:195], a[244:247], v[40:43], v[192:195]
    v_mfma_f32_16x16x32_bf16 v[192:195], a[236:239], v[36:39], v[192:195]
    v_mul_f32 v188, v188, v20
    v_mul_f32 v189, v189, v20
    v_mfma_f32_16x16x32_bf16 v[192:195], a[228:231], v[32:35], v[192:195]
    v_mul_f32 v190, v190, v20
    v_mul_f32 v191, v191, v20
    v_cvt_pk_bf16_f32 v252, v188, v189
    v_cvt_pk_bf16_f32 v253, v190, v191
    s_nop 3
    v_mul_f32 v192, v192, v20
    v_mul_f32 v193, v193, v20
    v_mul_f32 v194, v194, v20
    v_mul_f32 v195, v195, v20
    v_cvt_pk_bf16_f32 v254, v192, v193
    v_cvt_pk_bf16_f32 v255, v194, v195
    buffer_store_dwordx4 v[252:255], v10, s[20:23], s32 offen sc1 nt
    v_cmp_lt_u32 vcc, 0x53800000, v11
    s_nop 4
    s_cmp_lg_u64 vcc, 0
    s_cbranch_scc1 L_slow0
    s_endpgm
L_slow0:
    s_waitcnt vmcnt(0) lgkmcnt(0)
    s_mov_b32 s29, 0
    s_lshl_b32 s30, s28, 11
    v_and_b32 v2, 0x3fff, v2
    s_mov_b32 s31, 0xffffe000
    s_mov_b32 s32, 0xfffff000
    v_and_b32 v14, 15, v0
    v_lshlrev_b32 v14, 7, v14
    v_add_u32 v14, 99328, v14
    v_lshrrev_b32 v13, 4, v0
    s_lshl_b32 s34, s28, 2
    v_add_u32 v13, s34, v13
    v_lshl_add_u32 v13, v13, 2, v14
    s_mov_b32 s33, 46
L_slow:
    s_barrier
    s_mov_b32 m0, s30
    s_nop 0
    buffer_load_dwordx4 v9, s[8:11], s29 offen lds
    buffer_load_dwordx4 v9, s[8:11], s29 offen offset:1024 lds
    s_waitcnt vmcnt(0)
    s_barrier
    ds_read_b128 v[32:35], v2 offset:0
    ds_read_b128 v[36:39], v2 offset:512
    ds_read_b128 v[40:43], v2 offset:2048
    ds_read_b128 v[44:47], v2 offset:2560
    ds_read_b128 v[48:51], v2 offset:4096
    ds_read_b128 v[52:55], v2 offset:4608
    ds_read_b128 v[56:59], v2 offset:6144
    ds_read_b128 v[60:63], v2 offset:6656
    s_waitcnt lgkmcnt(0)
    v_mfma_f32_16x16x32_bf16 v[192:195], a[0:3], v[32:35], 0
    v_mfma_f32_16x16x32_bf16 v[192:195], a[4:7], v[36:39], v[192:195]
    v_mfma_f32_16x16x32_bf16 v[192:195], a[8:11], v[40:43], v[192:195]
    v_mfma_f32_16x16x32_bf16 v[192:195], a[12:15], v[44:47], v[192:195]
    v_mfma_f32_16x16x32_bf16 v[196:199], a[16:19], v[32:35], 0
    v_mfma_f32_16x16x32_bf16 v[196:199], a[20:23], v[36:39], v[196:199]
    v_mfma_f32_16x16x32_bf16 v[196:199], a[24:27], v[40:43], v[196:199]
    v_mfma_f32_16x16x32_bf16 v[196:199], a[28:31], v[44:47], v[196:199]
    v_mfma_f32_16x16x32_bf16 v[200:203], a[32:35], v[32:35], 0
    v_mfma_f32_16x16x32_bf16 v[200:203], a[36:39], v[36:39], v[200:203]
    v_mfma_f32_16x16x32_bf16 v[200:203], a[40:43], v[40:43], v[200:203]
    v_mfma_f32_16x16x32_bf16 v[200:203], a[44:47], v[44:47], v[200:203]
    v_mfma_f32_16x16x32_bf16 v[204:207], a[48:51], v[32:35], 0
    v_mfma_f32_16x16x32_bf16 v[204:207], a[52:55], v[36:39], v[204:207]
    v_mfma_f32_16x16x32_bf16 v[204:207], a[56:59], v[40:43], v[204:207]
    v_mfma_f32_16x16x32_bf16 v[204:207], a[60:63], v[44:47], v[204:207]
    v_mfma_f32_16x16x32_bf16 v[208:211], a[64:67], v[32:35], 0
    v_mfma_f32_16x16x32_bf16 v[208:211], a[68:71], v[36:39], v[208:211]
    v_mfma_f32_16x16x32_bf16 v[208:211], a[72:75], v[40:43], v[208:211]
    v_mfma_f32_16x16x32_bf16 v[208:211], a[76:79], v[44:47], v[208:211]
    v_mfma_f32_16x16x32_bf16 v[212:215], a[80:83], v[32:35], 0
    v_mfma_f32_16x16x32_bf16 v[212:215], a[84:87], v[36:39], v[212:215]
    v_mfma_f32_16x16x32_bf16 v[212:215], a[88:91], v[40:43], v[212:215]
    v_mfma_f32_16x16x32_bf16 v[212:215], a[92:95], v[44:47], v[212:215]
    v_mfma_f32_16x16x32_bf16 v[216:219], a[96:99], v[32:35], 0
    v_mfma_f32_16x16x32_bf16 v[216:219], a[100:103], v[36:39], v[216:219]
    v_mfma_f32_16x16x32_bf16 v[216:219], a[104:107], v[40:43], v[216:219]
    v_mfma_f32_16x16x32_bf16 v[216:219], a[108:111], v[44:47], v[216:219]
    v_mfma_f32_16x16x32_bf16 v[220:223], a[112:115], v[32:35], 0
    v_mfma_f32_16x16x32_bf16 v[220:223], a[116:119], v[36:39], v[220:223]
    v_mfma_f32_16x16x32_bf16 v[220:223], a[120:123], v[40:43], v[220:223]
    v_mfma_f32_16x16x32_bf16 v[220:223], a[124:127], v[44:47], v[220:223]
    v_mfma_f32_16x16x32_bf16 v[224:227], a[0:3], v[48:51], 0
    v_mfma_f32_16x16x32_bf16 v[224:227], a[4:7], v[52:55], v[224:227]
    v_mfma_f32_16x16x32_bf16 v[224:227], a[8:11], v[56:59], v[224:227]
    v_mfma_f32_16x16x32_bf16 v[224:227], a[12:15], v[60:63], v[224:227]
    v_mfma_f32_16x16x32_bf16 v[228:231], a[16:19], v[48:51], 0
    v_mfma_f32_16x16x32_bf16 v[228:231], a[20:23], v[52:55], v[228:231]
    v_mfma_f32_16x16x32_bf16 v[228:231], a[24:27], v[56:59], v[228:231]
    v_mfma_f32_16x16x32_bf16 v[228:231], a[28:31], v[60:63], v[228:231]
    v_mfma_f32_16x16x32_bf16 v[232:235], a[32:35], v[48:51], 0
    v_mfma_f32_16x16x32_bf16 v[232:235], a[36:39], v[52:55], v[232:235]
    v_mfma_f32_16x16x32_bf16 v[232:235], a[40:43], v[56:59], v[232:235]
    v_mfma_f32_16x16x32_bf16 v[232:235], a[44:47], v[60:63], v[232:235]
    v_mfma_f32_16x16x32_bf16 v[236:239], a[48:51], v[48:51], 0
    v_mfma_f32_16x16x32_bf16 v[236:239], a[52:55], v[52:55], v[236:239]
    v_mfma_f32_16x16x32_bf16 v[236:239], a[56:59], v[56:59], v[236:239]
    v_mfma_f32_16x16x32_bf16 v[236:239], a[60:63], v[60:63], v[236:239]
    v_mfma_f32_16x16x32_bf16 v[240:243], a[64:67], v[48:51], 0
    v_mfma_f32_16x16x32_bf16 v[240:243], a[68:71], v[52:55], v[240:243]
    v_mfma_f32_16x16x32_bf16 v[240:243], a[72:75], v[56:59], v[240:243]
    v_mfma_f32_16x16x32_bf16 v[240:243], a[76:79], v[60:63], v[240:243]
    v_mfma_f32_16x16x32_bf16 v[244:247], a[80:83], v[48:51], 0
    v_mfma_f32_16x16x32_bf16 v[244:247], a[84:87], v[52:55], v[244:247]
    v_mfma_f32_16x16x32_bf16 v[244:247], a[88:91], v[56:59], v[244:247]
    v_mfma_f32_16x16x32_bf16 v[244:247], a[92:95], v[60:63], v[244:247]
    v_mfma_f32_16x16x32_bf16 v[248:251], a[96:99], v[48:51], 0
    v_mfma_f32_16x16x32_bf16 v[248:251], a[100:103], v[52:55], v[248:251]
    v_mfma_f32_16x16x32_bf16 v[248:251], a[104:107], v[56:59], v[248:251]
    v_mfma_f32_16x16x32_bf16 v[248:251], a[108:111], v[60:63], v[248:251]
    v_mfma_f32_16x16x32_bf16 v[252:255], a[112:115], v[48:51], 0
    v_mfma_f32_16x16x32_bf16 v[252:255], a[116:119], v[52:55], v[252:255]
    v_mfma_f32_16x16x32_bf16 v[252:255], a[120:123], v[56:59], v[252:255]
    v_mfma_f32_16x16x32_bf16 v[252:255], a[124:127], v[60:63], v[252:255]
    v_max_f32 v17, v192, v193
    v_max3_f32 v17, v17, v194, v195
    v_max3_f32 v17, v17, v196, v197
    v_max3_f32 v17, v17, v198, v199
    v_max3_f32 v17, v17, v200, v201
    v_max3_f32 v17, v17, v202, v203
    v_max3_f32 v17, v17, v204, v205
    v_max3_f32 v17, v17, v206, v207
    v_max3_f32 v17, v17, v208, v209
    v_max3_f32 v17, v17, v210, v211
    v_max3_f32 v17, v17, v212, v213
    v_max3_f32 v17, v17, v214, v215
    v_max3_f32 v17, v17, v216, v217
    v_max3_f32 v17, v17, v218, v219
    v_max3_f32 v17, v17, v220, v221
    v_max3_f32 v17, v17, v222, v223
    v_max_f32 v18, v224, v225
    v_max3_f32 v18, v18, v226, v227
    v_max3_f32 v18, v18, v228, v229
    v_max3_f32 v18, v18, v230, v231
    v_max3_f32 v18, v18, v232, v233
    v_max3_f32 v18, v18, v234, v235
    v_max3_f32 v18, v18, v236, v237
    v_max3_f32 v18, v18, v238, v239
    v_max3_f32 v18, v18, v240, v241
    v_max3_f32 v18, v18, v242, v243
    v_max3_f32 v18, v18, v244, v245
    v_max3_f32 v18, v18, v246, v247
    v_max3_f32 v18, v18, v248, v249
    v_max3_f32 v18, v18, v250, v251
    v_max3_f32 v18, v18, v252, v253
    v_max3_f32 v18, v18, v254, v255
    ds_write2_b32 v13, v17, v18 offset0:0 offset1:16
    s_waitcnt lgkmcnt(0)
    s_barrier
    ds_read_b128 v[116:119], v14 offset:0
    ds_read_b128 v[120:123], v14 offset:16
    ds_read_b128 v[124:127], v14 offset:32
    ds_read_b128 v[128:131], v14 offset:48
    ds_read_b128 v[132:135], v14 offset:64
    ds_read_b128 v[136:139], v14 offset:80
    ds_read_b128 v[140:143], v14 offset:96
    ds_read_b128 v[144:147], v14 offset:112
    s_waitcnt lgkmcnt(0)
    v_max_f32 v17, v116, v117
    v_max3_f32 v17, v17, v118, v119
    v_max3_f32 v17, v17, v120, v121
    v_max3_f32 v17, v17, v122, v123
    v_max3_f32 v17, v17, v124, v125
    v_max3_f32 v17, v17, v126, v127
    v_max3_f32 v17, v17, v128, v129
    v_max3_f32 v17, v17, v130, v131
    v_max_f32 v18, v132, v133
    v_max3_f32 v18, v18, v134, v135
    v_max3_f32 v18, v18, v136, v137
    v_max3_f32 v18, v18, v138, v139
    v_max3_f32 v18, v18, v140, v141
    v_max3_f32 v18, v18, v142, v143
    v_max3_f32 v18, v18, v144, v145
    v_max3_f32 v18, v18, v146, v147
    v_sub_f32 v192, v192, v17
    v_sub_f32 v193, v193, v17
    v_sub_f32 v194, v194, v17
    v_sub_f32 v195, v195, v17
    v_exp_f32 v192, v192
    v_exp_f32 v193, v193
    v_exp_f32 v194, v194
    v_exp_f32 v195, v195
    v_perm_b32 v80, v193, v192, s35
    v_perm_b32 v81, v195, v194, s35
    v_sub_f32 v196, v196, v17
    v_sub_f32 v197, v197, v17
    v_sub_f32 v198, v198, v17
    v_sub_f32 v199, v199, v17
    v_exp_f32 v196, v196
    v_exp_f32 v197, v197
    v_exp_f32 v198, v198
    v_exp_f32 v199, v199
    v_perm_b32 v82, v197, v196, s35
    v_perm_b32 v83, v199, v198, s35
    ds_write_b128 v3, v[80:83] offset:0
    v_sub_f32 v200, v200, v17
    v_sub_f32 v201, v201, v17
    v_sub_f32 v202, v202, v17
    v_sub_f32 v203, v203, v17
    v_exp_f32 v200, v200
    v_exp_f32 v201, v201
    v_exp_f32 v202, v202
    v_exp_f32 v203, v203
    v_perm_b32 v84, v201, v200, s35
    v_perm_b32 v85, v203, v202, s35
    v_sub_f32 v204, v204, v17
    v_sub_f32 v205, v205, v17
    v_sub_f32 v206, v206, v17
    v_sub_f32 v207, v207, v17
    v_exp_f32 v204, v204
    v_exp_f32 v205, v205
    v_exp_f32 v206, v206
    v_exp_f32 v207, v207
    v_perm_b32 v86, v205, v204, s35
    v_perm_b32 v87, v207, v206, s35
    ds_write_b128 v3, v[84:87] offset:1024
    v_sub_f32 v208, v208, v17
    v_sub_f32 v209, v209, v17
    v_sub_f32 v210, v210, v17
    v_sub_f32 v211, v211, v17
    v_exp_f32 v208, v208
    v_exp_f32 v209, v209
    v_exp_f32 v210, v210
    v_exp_f32 v211, v211
    v_perm_b32 v92, v209, v208, s35
    v_perm_b32 v93, v211, v210, s35
    v_sub_f32 v212, v212, v17
    v_sub_f32 v213, v213, v17
    v_sub_f32 v214, v214, v17
    v_sub_f32 v215, v215, v17
    v_exp_f32 v212, v212
    v_exp_f32 v213, v213
    v_exp_f32 v214, v214
    v_exp_f32 v215, v215
    v_perm_b32 v94, v213, v212, s35
    v_perm_b32 v95, v215, v214, s35
    ds_write_b128 v3, v[92:95] offset:2048
    v_sub_f32 v216, v216, v17
    v_sub_f32 v217, v217, v17
    v_sub_f32 v218, v218, v17
    v_sub_f32 v219, v219, v17
    v_exp_f32 v216, v216
    v_exp_f32 v217, v217
    v_exp_f32 v218, v218
    v_exp_f32 v219, v219
    v_perm_b32 v96, v217, v216, s35
    v_perm_b32 v97, v219, v218, s35
    v_sub_f32 v220, v220, v17
    v_sub_f32 v221, v221, v17
    v_sub_f32 v222, v222, v17
    v_sub_f32 v223, v223, v17
    v_exp_f32 v220, v220
    v_exp_f32 v221, v221
    v_exp_f32 v222, v222
    v_exp_f32 v223, v223
    v_perm_b32 v98, v221, v220, s35
    v_perm_b32 v99, v223, v222, s35
    ds_write_b128 v3, v[96:99] offset:3072
    v_sub_f32 v224, v224, v18
    v_sub_f32 v225, v225, v18
    v_sub_f32 v226, v226, v18
    v_sub_f32 v227, v227, v18
    v_exp_f32 v224, v224
    v_exp_f32 v225, v225
    v_exp_f32 v226, v226
    v_exp_f32 v227, v227
    v_perm_b32 v100, v225, v224, s35
    v_perm_b32 v101, v227, v226, s35
    v_sub_f32 v228, v228, v18
    v_sub_f32 v229, v229, v18
    v_sub_f32 v230, v230, v18
    v_sub_f32 v231, v231, v18
    v_exp_f32 v228, v228
    v_exp_f32 v229, v229
    v_exp_f32 v230, v230
    v_exp_f32 v231, v231
    v_perm_b32 v102, v229, v228, s35
    v_perm_b32 v103, v231, v230, s35
    ds_write_b128 v3, v[100:103] offset:4096
    v_sub_f32 v232, v232, v18
    v_sub_f32 v233, v233, v18
    v_sub_f32 v234, v234, v18
    v_sub_f32 v235, v235, v18
    v_exp_f32 v232, v232
    v_exp_f32 v233, v233
    v_exp_f32 v234, v234
    v_exp_f32 v235, v235
    v_perm_b32 v104, v233, v232, s35
    v_perm_b32 v105, v235, v234, s35
    v_sub_f32 v236, v236, v18
    v_sub_f32 v237, v237, v18
    v_sub_f32 v238, v238, v18
    v_sub_f32 v239, v239, v18
    v_exp_f32 v236, v236
    v_exp_f32 v237, v237
    v_exp_f32 v238, v238
    v_exp_f32 v239, v239
    v_perm_b32 v106, v237, v236, s35
    v_perm_b32 v107, v239, v238, s35
    ds_write_b128 v3, v[104:107] offset:5120
    v_sub_f32 v240, v240, v18
    v_sub_f32 v241, v241, v18
    v_sub_f32 v242, v242, v18
    v_sub_f32 v243, v243, v18
    v_exp_f32 v240, v240
    v_exp_f32 v241, v241
    v_exp_f32 v242, v242
    v_exp_f32 v243, v243
    v_perm_b32 v108, v241, v240, s35
    v_perm_b32 v109, v243, v242, s35
    v_sub_f32 v244, v244, v18
    v_sub_f32 v245, v245, v18
    v_sub_f32 v246, v246, v18
    v_sub_f32 v247, v247, v18
    v_exp_f32 v244, v244
    v_exp_f32 v245, v245
    v_exp_f32 v246, v246
    v_exp_f32 v247, v247
    v_perm_b32 v110, v245, v244, s35
    v_perm_b32 v111, v247, v246, s35
    ds_write_b128 v3, v[108:111] offset:6144
    v_sub_f32 v248, v248, v18
    v_sub_f32 v249, v249, v18
    v_sub_f32 v250, v250, v18
    v_sub_f32 v251, v251, v18
    v_exp_f32 v248, v248
    v_exp_f32 v249, v249
    v_exp_f32 v250, v250
    v_exp_f32 v251, v251
    v_perm_b32 v112, v249, v248, s35
    v_perm_b32 v113, v251, v250, s35
    v_sub_f32 v252, v252, v18
    v_sub_f32 v253, v253, v18
    v_sub_f32 v254, v254, v18
    v_sub_f32 v255, v255, v18
    v_exp_f32 v252, v252
    v_exp_f32 v253, v253
    v_exp_f32 v254, v254
    v_exp_f32 v255, v255
    v_perm_b32 v114, v253, v252, s35
    v_perm_b32 v115, v255, v254, s35
    ds_write_b128 v3, v[112:115] offset:7168
    v_mfma_f32_16x16x32_bf16 v[196:199], v[24:27], v[80:83], 0
    v_mfma_f32_16x16x32_bf16 v[196:199], v[24:27], v[84:87], v[196:199]
    v_mfma_f32_16x16x32_bf16 v[196:199], v[24:27], v[92:95], v[196:199]
    v_mfma_f32_16x16x32_bf16 v[196:199], v[24:27], v[96:99], v[196:199]
    v_mfma_f32_16x16x32_bf16 v[196:199], v[28:31], v[100:103], v[196:199]
    v_mfma_f32_16x16x32_bf16 v[196:199], v[28:31], v[104:107], v[196:199]
    v_mfma_f32_16x16x32_bf16 v[196:199], v[28:31], v[108:111], v[196:199]
    v_mfma_f32_16x16x32_bf16 v[196:199], v[28:31], v[112:115], v[196:199]
    s_nop 7
    ds_write_b32 v7, v196 offset:28672
    s_waitcnt lgkmcnt(0)
    s_barrier
    ds_read_b128 v[200:203], v8 offset:28672
    v_mfma_f32_16x16x32_bf16 v[164:167], a[128:131], v[80:83], 0
    v_mfma_f32_16x16x32_bf16 v[164:167], a[136:139], v[84:87], v[164:167]
    v_mfma_f32_16x16x32_bf16 v[164:167], a[144:147], v[92:95], v[164:167]
    v_mfma_f32_16x16x32_bf16 v[164:167], a[152:155], v[96:99], v[164:167]
    v_mfma_f32_16x16x32_bf16 v[168:171], a[132:135], v[80:83], 0
    v_mfma_f32_16x16x32_bf16 v[168:171], a[140:143], v[84:87], v[168:171]
    v_mfma_f32_16x16x32_bf16 v[168:171], a[148:151], v[92:95], v[168:171]
    v_mfma_f32_16x16x32_bf16 v[168:171], a[156:159], v[96:99], v[168:171]
    v_mfma_f32_16x16x32_bf16 v[172:175], a[128:131], v[100:103], 0
    v_mfma_f32_16x16x32_bf16 v[172:175], a[136:139], v[104:107], v[172:175]
    v_mfma_f32_16x16x32_bf16 v[172:175], a[144:147], v[108:111], v[172:175]
    v_mfma_f32_16x16x32_bf16 v[172:175], a[152:155], v[112:115], v[172:175]
    v_mfma_f32_16x16x32_bf16 v[176:179], a[132:135], v[100:103], 0
    v_mfma_f32_16x16x32_bf16 v[176:179], a[140:143], v[104:107], v[176:179]
    v_mfma_f32_16x16x32_bf16 v[176:179], a[148:151], v[108:111], v[176:179]
    v_mfma_f32_16x16x32_bf16 v[176:179], a[156:159], v[112:115], v[176:179]
    ds_read_b128 v[116:119], v4 offset:0
    ds_read_b128 v[120:123], v4 offset:1024
    ds_read_b128 v[124:127], v4 offset:2048
    ds_read_b128 v[128:131], v4 offset:3072
    s_waitcnt lgkmcnt(0)
    v_mfma_f32_16x16x32_bf16 v[164:167], a[160:163], v[116:119], v[164:167]
    v_mfma_f32_16x16x32_bf16 v[164:167], a[168:171], v[120:123], v[164:167]
    v_mfma_f32_16x16x32_bf16 v[164:167], a[176:179], v[124:127], v[164:167]
    v_mfma_f32_16x16x32_bf16 v[164:167], a[184:187], v[128:131], v[164:167]
    v_mfma_f32_16x16x32_bf16 v[168:171], a[164:167], v[116:119], v[168:171]
    v_mfma_f32_16x16x32_bf16 v[168:171], a[172:175], v[120:123], v[168:171]
    v_mfma_f32_16x16x32_bf16 v[168:171], a[180:183], v[124:127], v[168:171]
    v_mfma_f32_16x16x32_bf16 v[168:171], a[188:191], v[128:131], v[168:171]
    ds_read_b128 v[116:119], v4 offset:4096
    ds_read_b128 v[120:123], v4 offset:5120
    ds_read_b128 v[124:127], v4 offset:6144
    ds_read_b128 v[128:131], v4 offset:7168
    s_waitcnt lgkmcnt(0)
    v_mfma_f32_16x16x32_bf16 v[172:175], a[160:163], v[116:119], v[172:175]
    v_mfma_f32_16x16x32_bf16 v[172:175], a[168:171], v[120:123], v[172:175]
    v_mfma_f32_16x16x32_bf16 v[172:175], a[176:179], v[124:127], v[172:175]
    v_mfma_f32_16x16x32_bf16 v[172:175], a[184:187], v[128:131], v[172:175]
    v_mfma_f32_16x16x32_bf16 v[176:179], a[164:167], v[116:119], v[176:179]
    v_mfma_f32_16x16x32_bf16 v[176:179], a[172:175], v[120:123], v[176:179]
    v_mfma_f32_16x16x32_bf16 v[176:179], a[180:183], v[124:127], v[176:179]
    v_mfma_f32_16x16x32_bf16 v[176:179], a[188:191], v[128:131], v[176:179]
    ds_read_b128 v[132:135], v5 offset:0
    ds_read_b128 v[136:139], v5 offset:1024
    ds_read_b128 v[140:143], v5 offset:2048
    ds_read_b128 v[144:147], v5 offset:3072
    s_waitcnt lgkmcnt(0)
    v_mfma_f32_16x16x32_bf16 v[164:167], a[192:195], v[132:135], v[164:167]
    v_mfma_f32_16x16x32_bf16 v[164:167], a[200:203], v[136:139], v[164:167]
    v_mfma_f32_16x16x32_bf16 v[164:167], a[208:211], v[140:143], v[164:167]
    v_mfma_f32_16x16x32_bf16 v[164:167], a[216:219], v[144:147], v[164:167]
    v_mfma_f32_16x16x32_bf16 v[168:171], a[196:199], v[132:135], v[168:171]
    v_mfma_f32_16x16x32_bf16 v[168:171], a[204:207], v[136:139], v[168:171]
    v_mfma_f32_16x16x32_bf16 v[168:171], a[212:215], v[140:143], v[168:171]
    v_mfma_f32_16x16x32_bf16 v[168:171], a[220:223], v[144:147], v[168:171]
    ds_read_b128 v[132:135], v5 offset:4096
    ds_read_b128 v[136:139], v5 offset:5120
    ds_read_b128 v[140:143], v5 offset:6144
    ds_read_b128 v[144:147], v5 offset:7168
    s_waitcnt lgkmcnt(0)
    v_mfma_f32_16x16x32_bf16 v[172:175], a[192:195], v[132:135], v[172:175]
    v_mfma_f32_16x16x32_bf16 v[172:175], a[200:203], v[136:139], v[172:175]
    v_mfma_f32_16x16x32_bf16 v[172:175], a[208:211], v[140:143], v[172:175]
    v_mfma_f32_16x16x32_bf16 v[172:175], a[216:219], v[144:147], v[172:175]
    v_mfma_f32_16x16x32_bf16 v[176:179], a[196:199], v[132:135], v[176:179]
    v_mfma_f32_16x16x32_bf16 v[176:179], a[204:207], v[136:139], v[176:179]
    v_mfma_f32_16x16x32_bf16 v[176:179], a[212:215], v[140:143], v[176:179]
    v_mfma_f32_16x16x32_bf16 v[176:179], a[220:223], v[144:147], v[176:179]
    ds_read_b128 v[148:151], v6 offset:0
    ds_read_b128 v[152:155], v6 offset:1024
    ds_read_b128 v[156:159], v6 offset:2048
    ds_read_b128 v[160:163], v6 offset:3072
    s_waitcnt lgkmcnt(0)
    v_mfma_f32_16x16x32_bf16 v[164:167], a[224:227], v[148:151], v[164:167]
    v_mfma_f32_16x16x32_bf16 v[164:167], a[232:235], v[152:155], v[164:167]
    v_mfma_f32_16x16x32_bf16 v[164:167], a[240:243], v[156:159], v[164:167]
    v_mfma_f32_16x16x32_bf16 v[164:167], a[248:251], v[160:163], v[164:167]
    v_mfma_f32_16x16x32_bf16 v[168:171], a[228:231], v[148:151], v[168:171]
    v_mfma_f32_16x16x32_bf16 v[168:171], a[236:239], v[152:155], v[168:171]
    v_mfma_f32_16x16x32_bf16 v[168:171], a[244:247], v[156:159], v[168:171]
    v_mfma_f32_16x16x32_bf16 v[168:171], a[252:255], v[160:163], v[168:171]
    ds_read_b128 v[148:151], v6 offset:4096
    ds_read_b128 v[152:155], v6 offset:5120
    ds_read_b128 v[156:159], v6 offset:6144
    ds_read_b128 v[160:163], v6 offset:7168
    s_waitcnt lgkmcnt(0)
    v_mfma_f32_16x16x32_bf16 v[172:175], a[224:227], v[148:151], v[172:175]
    v_mfma_f32_16x16x32_bf16 v[172:175], a[232:235], v[152:155], v[172:175]
    v_mfma_f32_16x16x32_bf16 v[172:175], a[240:243], v[156:159], v[172:175]
    v_mfma_f32_16x16x32_bf16 v[172:175], a[248:251], v[160:163], v[172:175]
    v_mfma_f32_16x16x32_bf16 v[176:179], a[228:231], v[148:151], v[176:179]
    v_mfma_f32_16x16x32_bf16 v[176:179], a[236:239], v[152:155], v[176:179]
    v_mfma_f32_16x16x32_bf16 v[176:179], a[244:247], v[156:159], v[176:179]
    v_mfma_f32_16x16x32_bf16 v[176:179], a[252:255], v[160:163], v[176:179]
    v_add_f32 v200, v200, v201
    v_add_f32 v202, v202, v203
    v_add_f32 v17, v200, v202
    v_rcp_f32 v19, v17
    s_nop 0
    v_mov_b32 v20, v19
    s_nop 1
    v_permlane32_swap_b32 v19, v20
    s_add_u32 s31, s31, 0x2000
    v_mul_f32 v164, v164, v19
    v_mul_f32 v165, v165, v19
    v_mul_f32 v166, v166, v19
    v_mul_f32 v167, v167, v19
    v_cvt_pk_bf16_f32 v208, v164, v165
    v_cvt_pk_bf16_f32 v209, v166, v167
    v_mul_f32 v168, v168, v19
    v_mul_f32 v169, v169, v19
    v_mul_f32 v170, v170, v19
    v_mul_f32 v171, v171, v19
    v_cvt_pk_bf16_f32 v210, v168, v169
    v_cvt_pk_bf16_f32 v211, v170, v171
    buffer_store_dwordx4 v[208:211], v10, s[20:23], s31 offen sc1 nt
    s_add_u32 s32, s32, 0x2000
    v_mul_f32 v172, v172, v20
    v_mul_f32 v173, v173, v20
    v_mul_f32 v174, v174, v20
    v_mul_f32 v175, v175, v20
    v_cvt_pk_bf16_f32 v212, v172, v173
    v_cvt_pk_bf16_f32 v213, v174, v175
    v_mul_f32 v176, v176, v20
    v_mul_f32 v177, v177, v20
    v_mul_f32 v178, v178, v20
    v_mul_f32 v179, v179, v20
    v_cvt_pk_bf16_f32 v214, v176, v177
    v_cvt_pk_bf16_f32 v215, v178, v179
    buffer_store_dwordx4 v[212:215], v10, s[20:23], s32 offen sc1 nt
    s_add_u32 s29, s29, 0x2000
    s_sub_u32 s33, s33, 1
    s_cmp_lg_u32 s33, 0
    s_cbranch_scc1 L_slow
    s_endpgm
.section .rodata,"a"
.p2align 6
.amdhsa_kernel standalone__gqa_softmax__near_ridge_kernel
  .amdhsa_next_free_vgpr 512
  .amdhsa_next_free_sgpr 102
  .amdhsa_accum_offset 256
  .amdhsa_group_segment_fixed_size 0
  .amdhsa_kernarg_size 48
  .amdhsa_user_sgpr_count 2
  .amdhsa_user_sgpr_kernarg_segment_ptr 1
  .amdhsa_system_sgpr_workgroup_id_x 1
.end_amdhsa_kernel
```
